```python
import torch

def _softmax(x, axis=-1):
    return torch.softmax(x, dim=axis)
def _gelu(x):
    return torch.nn.functional.gelu(x, approximate="tanh")
def _silu(x):
    return torch.nn.functional.silu(x)
def _sigmoid(x):
    return torch.sigmoid(x)
def _layernorm(x, axis=-1, eps=1e-5):
    m = x.mean(dim=axis, keepdim=True)
    v = x.var(dim=axis, keepdim=True, unbiased=False)
    return (x - m) / torch.sqrt(v + eps)
def _scatter_add(tgt, idx, src, axis=0):
    return tgt.clone().index_add_(axis, idx, src)
def _segment_sum(src, seg, n):
    out = torch.zeros((n,) + src.shape[1:], dtype=src.dtype)
    return out.index_add_(0, seg, src)
def _pad(x, pw):
    flat = tuple(v for pair in reversed(pw) for v in pair)
    return torch.nn.functional.pad(x, flat)

kernel_name = 'recurrent_scan__linear_attn_block__glu_gated_glu__prompt'

def setup_inputs():

    _w = (lambda a: (lambda t: t.to(torch.bfloat16) if t.is_floating_point() else t)(torch.as_tensor(a)))
    def _A_setup():
        B, S, D = 1, 2048, 640
        return {
            "x": _w((lambda *s: torch.randn(*s, dtype=torch.bfloat16) * 0.05)(B, S, D)),
            "wqkv": _w((lambda *s: torch.randn(*s, dtype=torch.bfloat16) * 0.05)(D, 3 * D)),
            "wo": _w((lambda *s: torch.randn(*s, dtype=torch.bfloat16) * 0.05)(D, D)),
        }
    _A_in = _A_setup()

    def _B_setup():
        B, S, D, F = 1, 2048, 640, 1728
        return {
            "x": _w((lambda *s: torch.randn(*s, dtype=torch.bfloat16) * 0.05)(B, S, D)),
            "w_gate": _w((lambda *s: torch.randn(*s, dtype=torch.bfloat16) * 0.05)(D, F)),
            "w_up": _w((lambda *s: torch.randn(*s, dtype=torch.bfloat16) * 0.05)(D, F)),
            "w_down": _w((lambda *s: torch.randn(*s, dtype=torch.bfloat16) * 0.05)(F, D)),
        }
    _B_in = _B_setup()

    return {
        "A_x": _A_in["x"],
        "A_wqkv": _A_in["wqkv"],
        "A_wo": _A_in["wo"],
        "B_x": _B_in["x"],
        "B_w_gate": _B_in["w_gate"],
        "B_w_up": _B_in["w_up"],
        "B_w_down": _B_in["w_down"],
    }

def reference(A_x, A_wqkv, A_wo, B_x, B_w_gate, B_w_up, B_w_down):
    def _A_ref(x, wqkv, wo):
        B, S, D = x.shape
        H = 32; Dh = D // H
        qkv = (lambda x, *d: x.permute(*d))((x @ wqkv).reshape(B, S, 3, H, Dh), 2, 0, 3, 1, 4)
        q, k, v = qkv[0], qkv[1], qkv[2]
        phi = lambda t: torch.where(t > 0, t + 1, torch.exp(t)) + 1e-6
        pq, pk = phi(q), phi(k)
        kv = torch.einsum("bhsd,bhse->bhde", pk, v)
        z = torch.einsum("bhsd->bhd", pk)
        num = torch.einsum("bhqd,bhde->bhqe", pq, kv)
        den = torch.einsum("bhqd,bhd->bhq", pq, z)[..., None] + 1e-6
        o = num / den
        return (lambda x, *d: x.permute(*d))(o, 0, 2, 1, 3).reshape(B, S, D) @ wo

    def _B_ref(x, w_gate, w_up, w_down):
        g = torch.einsum("bsd,df->bsf", x, w_gate)
        u = torch.einsum("bsd,df->bsf", x, w_up)
        h = _sigmoid(g) * u
        return torch.einsum("bsf,fd->bsd", h, w_down)

    x = A_x
    xn = _layernorm(x, axis=-1)
    s = _A_ref(xn, A_wqkv, A_wo)
    g = _silu(_B_ref(xn, B_w_gate, B_w_up, B_w_down))
    return x + s * g
```

```asm
; @launch kernel=g1_kernel grid=(256,1,1) block=(512,1,1) lds=163840
    .amdgcn_target "amdgcn-amd-amdhsa--gfx950"
    .text
    .globl g1_kernel
    .p2align 8
    .type g1_kernel,@function
g1_kernel:
    s_cmp_ge_u32 s2, 256
    s_cbranch_scc1 g1_exit
    s_load_dwordx16 s[16:31], s[0:1], 0
    s_load_dwordx4 s[32:35], s[0:1], 64
    v_lshrrev_b32 v1, 6, v0
    v_and_b32 v2, 63, v0
    s_cmp_ge_u32 s2, 64
    s_cbranch_scc1 g1_nocp
    s_getpc_b64 s[84:85]
g1_pc0:
    s_sub_u32 s84, s84, g1_pc0-g1_kernel
    s_subb_u32 s85, s85, 0
    s_and_b32 s85, s85, 0xffff
    s_mov_b32 s86, code_end-g1_kernel
    s_mov_b32 s87, 0x00020000
    s_mov_b32 m0, 159744
    s_and_b32 s4, s2, -8
    v_add_u32 v3, s4, v1
    v_lshl_add_u32 v3, v3, 3, v2
    v_lshlrev_b32 v3, 7, v3
    s_mov_b64 exec, 0xff
    buffer_load_dword v3, s[84:87], 0 offen lds
    s_mov_b64 exec, -1
g1_nocp:
    s_and_b32 s6, s2, 7
    v_readfirstlane_b32 s8, v1
    s_mul_i32 s6, s6, 30
    s_lshr_b32 s7, s2, 3
    s_add_u32 s7, s7, s6
    s_and_b32 s6, s7, 7
    s_lshr_b32 s7, s7, 3
    s_and_b32 s9, s8, 3
    s_lshr_b32 s11, s9, 1
    s_and_b32 s12, s9, 1
    s_mul_i32 s15, s7, 160
    s_and_b32 s4, s7, 1
    s_lshl_b32 s4, s4, 5
    s_sub_u32 s15, s15, s4
    s_add_u32 s4, s11, 1
    s_mul_i32 s4, s4, 1280
    s_add_u32 s15, s15, s4
    s_mul_i32 s4, s7, 320
    s_mul_i32 s5, s11, 192
    s_add_u32 s4, s4, s5
    s_sub_u32 s4, s4, 2560
    s_cmp_ge_u32 s7, 8
    s_cselect_b32 s15, s4, s15
    s_mul_i32 s4, s7, 192
    s_sub_u32 s4, s4, 2304
    s_movk_i32 s14, 3840
    s_mul_i32 s10, s6, 327680
    s_cmp_ge_u32 s7, 12
    s_cselect_b32 s15, s4, s15
    s_cselect_b32 s14, 3456, s14
    s_mul_i32 s46, s14, 640
    s_mov_b32 s47, 0x00020000
    s_mov_b32 s38, 2621440
    s_mov_b32 s39, 0x00020000
    s_cmp_ge_u32 s2, 240
    s_cbranch_scc1 g1_pack
    s_cmp_ge_u32 s8, 4
    s_cbranch_scc1 g1_loader
    s_lshl_b32 s4, s9, 6
    v_add_u32 v8, s4, v2
    v_mul_u32_u24 v8, 1280, v8
    s_lshl_b32 s4, s12, 5
    v_lshrrev_b32 v9, 1, v2
    v_add_u32 v9, s4, v9
    v_mul_lo_u32 v9, v9, s14
    v_and_b32 v10, 1, v2
    v_lshl_add_u32 v9, v10, 7, v9
    v_add_u32 v9, s15, v9
    s_mul_i32 s4, s7, 86
    s_lshr_b32 s4, s4, 8
    s_mul_i32 s4, s4, 3
    s_sub_u32 s4, s7, s4
    s_lshl_b32 s4, s4, 7
    s_add_u32 s52, s10, s4
    s_lshl_b32 s53, s14, 6
    s_mov_b32 m0, 159744
    s_and_b32 s54, s2, 7
    s_mul_i32 s54, s54, 30
    s_lshl_b32 s55, s7, 3
    s_max_u32 s56, s55, s54
    s_add_u32 s57, s55, 8
    s_add_u32 s54, s54, 30
    s_min_u32 s57, s57, s54
    s_sub_u32 s54, s57, s56
    s_add_u32 s55, s55, s6
    s_sub_u32 s55, s55, s56
    s_mov_b32 s57, 12
    s_cmp_eq_u32 s54, 6
    s_cselect_b32 s57, 16, s57
    s_cmp_eq_u32 s54, 4
    s_cselect_b32 s57, 24, s57
    s_cmp_eq_u32 s54, 2
    s_cselect_b32 s57, 32, s57
    s_lshl1_add_u32 s55, s55, s12
    s_mul_i32 s55, s55, s57
    s_lshl_b32 s56, s12, 5
    s_sub_u32 s55, s55, s56
    s_add_u32 s55, s55, 0
    s_mul_i32 s55, s55, s14
    v_add_u32 v11, s55, v9
    s_lshl_b32 s57, s57, 1
    s_lshl_b32 s56, s14, 5
    s_waitcnt lgkmcnt(0)
    s_mov_b32 s36, s16
    s_and_b32 s37, s17, 0xffff
    s_cmp_eq_u32 s11, 0
    s_cselect_b64 s[44:45], s[24:25], s[26:27]
    s_cmp_ge_u32 s7, 12
    s_cselect_b64 s[44:45], s[44:45], s[18:19]
    s_and_b32 s45, s45, 0xffff
    v_cmpx_gt_i32 vcc, s57, v2
    buffer_load_dword v11, s[44:47], 0 offen lds
    s_mov_b64 exec, -1
    s_add_u32 s4, s52, 0
    buffer_load_dword v8, s[36:39], s4 offen lds
    s_barrier
    v_and_b32 v3, 15, v2
    v_lshrrev_b32 v4, 4, v2
    v_and_b32 v5, 3, v3
    s_cmp_lt_u32 s7, 8
    s_cbranch_scc1 g1_ckv
    s_cmp_lt_u32 s7, 12
    s_cbranch_scc1 g1_cq
    v_and_b32 v30, 1, v5
    v_lshlrev_b32 v30, 3, v30
    v_lshrrev_b32 v31, 1, v5
    v_lshl_add_u32 v30, v31, 2, v30
    s_mul_i32 s4, s12, 48
    v_add_u32 v30, s4, v30
    v_add_u32 v40, 0, v30
    v_add_u32 v41, 16, v30
    v_add_u32 v42, 32, v30
    v_add_u32 v43, 96, v30
    v_add_u32 v44, 112, v30
    v_add_u32 v45, 128, v30
    v_lshlrev_b32 v30, 9, v4
    v_lshrrev_b32 v31, 2, v3
    v_lshl_add_u32 v30, v31, 6, v30
    v_add_u32 v30, 98304, v30
    v_lshrrev_b32 v31, 5, v40
    v_lshl_add_u32 v31, v31, 11, v30
    v_lshrrev_b32 v32, 4, v40
    v_xor_b32 v32, v32, v4
    v_and_b32 v32, 1, v32
    v_lshl_add_u32 v31, v32, 5, v31
    v_bfe_u32 v32, v40, 2, 2
    v_lshl_add_u32 v40, v32, 3, v31
    v_lshrrev_b32 v31, 5, v41
    v_lshl_add_u32 v31, v31, 11, v30
    v_lshrrev_b32 v32, 4, v41
    v_xor_b32 v32, v32, v4
    v_and_b32 v32, 1, v32
    v_lshl_add_u32 v31, v32, 5, v31
    v_bfe_u32 v32, v41, 2, 2
    v_lshl_add_u32 v41, v32, 3, v31
    v_lshrrev_b32 v31, 5, v42
    v_lshl_add_u32 v31, v31, 11, v30
    v_lshrrev_b32 v32, 4, v42
    v_xor_b32 v32, v32, v4
    v_and_b32 v32, 1, v32
    v_lshl_add_u32 v31, v32, 5, v31
    v_bfe_u32 v32, v42, 2, 2
    v_lshl_add_u32 v42, v32, 3, v31
    v_lshrrev_b32 v31, 5, v43
    v_lshl_add_u32 v31, v31, 11, v30
    v_lshrrev_b32 v32, 4, v43
    v_xor_b32 v32, v32, v4
    v_and_b32 v32, 1, v32
    v_lshl_add_u32 v31, v32, 5, v31
    v_bfe_u32 v32, v43, 2, 2
    v_lshl_add_u32 v43, v32, 3, v31
    v_lshrrev_b32 v31, 5, v44
    v_lshl_add_u32 v31, v31, 11, v30
    v_lshrrev_b32 v32, 4, v44
    v_xor_b32 v32, v32, v4
    v_and_b32 v32, 1, v32
    v_lshl_add_u32 v31, v32, 5, v31
    v_bfe_u32 v32, v44, 2, 2
    v_lshl_add_u32 v44, v32, 3, v31
    v_lshrrev_b32 v31, 5, v45
    v_lshl_add_u32 v31, v31, 11, v30
    v_lshrrev_b32 v32, 4, v45
    v_xor_b32 v32, v32, v4
    v_and_b32 v32, 1, v32
    v_lshl_add_u32 v31, v32, 5, v31
    v_bfe_u32 v32, v45, 2, 2
    v_lshl_add_u32 v45, v32, 3, v31
    s_lshl_b32 s4, s11, 14
    v_and_b32 v30, 7, v3
    v_xor_b32 v31, v30, v4
    v_lshlrev_b32 v31, 4, v31
    v_lshl_add_u32 v31, v30, 7, v31
    v_lshrrev_b32 v30, 3, v3
    v_lshl_add_u32 v31, v30, 10, v31
    v_add_u32 v46, s4, v31
    v_xor_b32 v47, 64, v46
    v_mov_b32 v64, 0
    v_mov_b32 v65, 0
    v_mov_b32 v66, 0
    v_mov_b32 v67, 0
    v_mov_b32 v68, 0
    v_mov_b32 v69, 0
    v_mov_b32 v70, 0
    v_mov_b32 v71, 0
    v_mov_b32 v72, 0
    v_mov_b32 v73, 0
    v_mov_b32 v74, 0
    v_mov_b32 v75, 0
    v_mov_b32 v76, 0
    v_mov_b32 v77, 0
    v_mov_b32 v78, 0
    v_mov_b32 v79, 0
    v_mov_b32 v80, 0
    v_mov_b32 v81, 0
    v_mov_b32 v82, 0
    v_mov_b32 v83, 0
    v_mov_b32 v84, 0
    v_mov_b32 v85, 0
    v_mov_b32 v86, 0
    v_mov_b32 v87, 0
    v_mov_b32 v88, 0
    v_mov_b32 v89, 0
    v_mov_b32 v90, 0
    v_mov_b32 v91, 0
    v_mov_b32 v92, 0
    v_mov_b32 v93, 0
    v_mov_b32 v94, 0
    v_mov_b32 v95, 0
    v_mov_b32 v96, 0
    v_mov_b32 v97, 0
    v_mov_b32 v98, 0
    v_mov_b32 v99, 0
    v_mov_b32 v100, 0
    v_mov_b32 v101, 0
    v_mov_b32 v102, 0
    v_mov_b32 v103, 0
    v_mov_b32 v104, 0
    v_mov_b32 v105, 0
    v_mov_b32 v106, 0
    v_mov_b32 v107, 0
    v_mov_b32 v108, 0
    v_mov_b32 v109, 0
    v_mov_b32 v110, 0
    v_mov_b32 v111, 0
    v_mov_b32 v112, 0
    v_mov_b32 v113, 0
    v_mov_b32 v114, 0
    v_mov_b32 v115, 0
    v_mov_b32 v116, 0
    v_mov_b32 v117, 0
    v_mov_b32 v118, 0
    v_mov_b32 v119, 0
    v_mov_b32 v120, 0
    v_mov_b32 v121, 0
    v_mov_b32 v122, 0
    v_mov_b32 v123, 0
    v_mov_b32 v124, 0
    v_mov_b32 v125, 0
    v_mov_b32 v126, 0
    v_mov_b32 v127, 0
    v_mov_b32 v128, 0
    v_mov_b32 v129, 0
    v_mov_b32 v130, 0
    v_mov_b32 v131, 0
    v_mov_b32 v132, 0
    v_mov_b32 v133, 0
    v_mov_b32 v134, 0
    v_mov_b32 v135, 0
    v_mov_b32 v136, 0
    v_mov_b32 v137, 0
    v_mov_b32 v138, 0
    v_mov_b32 v139, 0
    v_mov_b32 v140, 0
    v_mov_b32 v141, 0
    v_mov_b32 v142, 0
    v_mov_b32 v143, 0
    v_mov_b32 v144, 0
    v_mov_b32 v145, 0
    v_mov_b32 v146, 0
    v_mov_b32 v147, 0
    v_mov_b32 v148, 0
    v_mov_b32 v149, 0
    v_mov_b32 v150, 0
    v_mov_b32 v151, 0
    v_mov_b32 v152, 0
    v_mov_b32 v153, 0
    v_mov_b32 v154, 0
    v_mov_b32 v155, 0
    v_mov_b32 v156, 0
    v_mov_b32 v157, 0
    v_mov_b32 v158, 0
    v_mov_b32 v159, 0
    v_mov_b32 v160, 0
    v_mov_b32 v161, 0
    v_mov_b32 v162, 0
    v_mov_b32 v163, 0
    v_mov_b32 v164, 0
    v_mov_b32 v165, 0
    v_mov_b32 v166, 0
    v_mov_b32 v167, 0
    v_mov_b32 v168, 0
    v_mov_b32 v169, 0
    v_mov_b32 v170, 0
    v_mov_b32 v171, 0
    v_mov_b32 v172, 0
    v_mov_b32 v173, 0
    v_mov_b32 v174, 0
    v_mov_b32 v175, 0
    v_mov_b32 v176, 0
    v_mov_b32 v177, 0
    v_mov_b32 v178, 0
    v_mov_b32 v179, 0
    v_mov_b32 v180, 0
    v_mov_b32 v181, 0
    v_mov_b32 v182, 0
    v_mov_b32 v183, 0
    v_mov_b32 v184, 0
    v_mov_b32 v185, 0
    v_mov_b32 v186, 0
    v_mov_b32 v187, 0
    v_mov_b32 v188, 0
    v_mov_b32 v189, 0
    v_mov_b32 v190, 0
    v_mov_b32 v191, 0
    v_mov_b32 v192, 0
    v_mov_b32 v193, 0
    v_mov_b32 v194, 0
    v_mov_b32 v195, 0
    v_mov_b32 v196, 0
    v_mov_b32 v197, 0
    v_mov_b32 v198, 0
    v_mov_b32 v199, 0
    v_mov_b32 v200, 0
    v_mov_b32 v201, 0
    v_mov_b32 v202, 0
    v_mov_b32 v203, 0
    v_mov_b32 v204, 0
    v_mov_b32 v205, 0
    v_mov_b32 v206, 0
    v_mov_b32 v207, 0
    v_mov_b32 v208, 0
    v_mov_b32 v209, 0
    v_mov_b32 v210, 0
    v_mov_b32 v211, 0
    v_mov_b32 v212, 0
    v_mov_b32 v213, 0
    v_mov_b32 v214, 0
    v_mov_b32 v215, 0
    v_mov_b32 v216, 0
    v_mov_b32 v217, 0
    v_mov_b32 v218, 0
    v_mov_b32 v219, 0
    v_mov_b32 v220, 0
    v_mov_b32 v221, 0
    v_mov_b32 v222, 0
    v_mov_b32 v223, 0
    v_mov_b32 v224, 0
    v_mov_b32 v225, 0
    v_mov_b32 v226, 0
    v_mov_b32 v227, 0
    v_mov_b32 v228, 0
    v_mov_b32 v229, 0
    v_mov_b32 v230, 0
    v_mov_b32 v231, 0
    v_mov_b32 v232, 0
    v_mov_b32 v233, 0
    v_mov_b32 v234, 0
    v_mov_b32 v235, 0
    v_mov_b32 v236, 0
    v_mov_b32 v237, 0
    v_mov_b32 v238, 0
    v_mov_b32 v239, 0
    v_mov_b32 v240, 0
    v_mov_b32 v241, 0
    v_mov_b32 v242, 0
    v_mov_b32 v243, 0
    v_mov_b32 v244, 0
    v_mov_b32 v245, 0
    v_mov_b32 v246, 0
    v_mov_b32 v247, 0
    v_mov_b32 v248, 0
    v_mov_b32 v249, 0
    v_mov_b32 v250, 0
    v_mov_b32 v251, 0
    v_mov_b32 v252, 0
    v_mov_b32 v253, 0
    v_mov_b32 v254, 0
    v_mov_b32 v255, 0
    s_mov_b32 s62, 12288
    s_mov_b32 s63, 4294918144
    s_mov_b32 s64, 32768
    s_mov_b32 s65, 4294901760
    s_mov_b32 s60, 0
    s_mov_b32 s59, 0
    s_mov_b32 s61, 12288
    s_mov_b32 s66, 32768
    s_mov_b32 s67, 10
    v_mov_b32 v0, v40
    v_mov_b32 v1, v41
    v_mov_b32 v2, v42
    v_mov_b32 v3, v43
    v_mov_b32 v4, v44
    v_mov_b32 v5, v45
    v_mov_b32 v6, v46
    v_mov_b32 v7, v47
    .p2alignl 5, 0xbf800000
    s_branch g1_gu_ov
g1_gu_sk0:
    ds_append v8 offset:61324
    s_branch g1_gu_bk0
g1_gu_sk1:
    ds_append v8 offset:61324
    s_branch g1_gu_bk1
g1_gu_ov:
    s_barrier
    s_mov_b32 m0, 0
    ds_read_b64_tr_b16 v[8:9], v0
    ds_read_b64_tr_b16 v[10:11], v0 offset:256
    ds_read_b64_tr_b16 v[12:13], v1
    ds_read_b64_tr_b16 v[14:15], v1 offset:256
    ds_read_b64_tr_b16 v[16:17], v2
    ds_read_b64_tr_b16 v[18:19], v2 offset:256
    ds_read_b128 v[32:35], v6 offset:0
    ds_read_b128 v[36:39], v6 offset:2048
    ds_read_b128 v[40:43], v6 offset:4096
    ds_read_b128 v[44:47], v6 offset:6144
    ds_read_b128 v[48:51], v6 offset:8192
    ds_read_b128 v[52:55], v6 offset:10240
    ds_read_b128 v[56:59], v6 offset:12288
    ds_read_b128 v[60:63], v6 offset:14336
    v_add_u32 v0, s61, v0
    v_add_u32 v1, s61, v1
    v_add_u32 v2, s61, v2
    v_add_u32 v6, s66, v6
g1_gu_loop:
    s_waitcnt lgkmcnt(5)
    v_mfma_f32_16x16x32_bf16 v[64:67], v[8:11], v[32:35], v[64:67]
    ds_read_b64_tr_b16 v[20:21], v3
    v_mfma_f32_16x16x32_bf16 v[96:99], v[12:15], v[32:35], v[96:99]
    ds_read_b64_tr_b16 v[22:23], v3 offset:256
    v_mfma_f32_16x16x32_bf16 v[128:131], v[16:19], v[32:35], v[128:131]
    ds_read_b64_tr_b16 v[24:25], v4
    v_mfma_f32_16x16x32_bf16 v[68:71], v[8:11], v[36:39], v[68:71]
    ds_read_b64_tr_b16 v[26:27], v4 offset:256
    v_mfma_f32_16x16x32_bf16 v[100:103], v[12:15], v[36:39], v[100:103]
    ds_read_b64_tr_b16 v[28:29], v5
    v_mfma_f32_16x16x32_bf16 v[132:135], v[16:19], v[36:39], v[132:135]
    ds_read_b64_tr_b16 v[30:31], v5 offset:256
    v_mfma_f32_16x16x32_bf16 v[72:75], v[8:11], v[40:43], v[72:75]
    v_mfma_f32_16x16x32_bf16 v[104:107], v[12:15], v[40:43], v[104:107]
    v_mfma_f32_16x16x32_bf16 v[136:139], v[16:19], v[40:43], v[136:139]
    s_waitcnt lgkmcnt(8)
    v_mfma_f32_16x16x32_bf16 v[76:79], v[8:11], v[44:47], v[76:79]
    v_mfma_f32_16x16x32_bf16 v[108:111], v[12:15], v[44:47], v[108:111]
    v_mfma_f32_16x16x32_bf16 v[140:143], v[16:19], v[44:47], v[140:143]
    v_mfma_f32_16x16x32_bf16 v[80:83], v[8:11], v[48:51], v[80:83]
    v_add_u32 v3, s61, v3
    v_mfma_f32_16x16x32_bf16 v[112:115], v[12:15], v[48:51], v[112:115]
    v_add_u32 v4, s61, v4
    v_mfma_f32_16x16x32_bf16 v[144:147], v[16:19], v[48:51], v[144:147]
    v_add_u32 v5, s61, v5
    v_mfma_f32_16x16x32_bf16 v[84:87], v[8:11], v[52:55], v[84:87]
    v_mfma_f32_16x16x32_bf16 v[116:119], v[12:15], v[52:55], v[116:119]
    v_mfma_f32_16x16x32_bf16 v[148:151], v[16:19], v[52:55], v[148:151]
    s_waitcnt lgkmcnt(0)
    v_mfma_f32_16x16x32_bf16 v[88:91], v[8:11], v[56:59], v[88:91]
    s_add_u32 s60, s60, 1
    s_cmp_eq_u32 s60, 4
    v_mfma_f32_16x16x32_bf16 v[120:123], v[12:15], v[56:59], v[120:123]
    s_cselect_b32 s61, s63, s62
    s_cselect_b32 s60, -1, s60
    v_mfma_f32_16x16x32_bf16 v[152:155], v[16:19], v[56:59], v[152:155]
    v_mfma_f32_16x16x32_bf16 v[92:95], v[8:11], v[60:63], v[92:95]
    v_mfma_f32_16x16x32_bf16 v[124:127], v[12:15], v[60:63], v[124:127]
    s_cmp_le_u32 s67, 1
    v_mfma_f32_16x16x32_bf16 v[156:159], v[16:19], v[60:63], v[156:159]
    s_cbranch_scc1 g1_gu_sk0
    s_barrier
g1_gu_bk0:
    v_mfma_f32_16x16x32_bf16 v[160:163], v[20:23], v[32:35], v[160:163]
    ds_read_b64_tr_b16 v[8:9], v0
    v_mfma_f32_16x16x32_bf16 v[192:195], v[24:27], v[32:35], v[192:195]
    ds_read_b64_tr_b16 v[10:11], v0 offset:256
    v_mfma_f32_16x16x32_bf16 v[224:227], v[28:31], v[32:35], v[224:227]
    ds_read_b128 v[32:35], v7 offset:0
    v_mfma_f32_16x16x32_bf16 v[164:167], v[20:23], v[36:39], v[164:167]
    ds_read_b64_tr_b16 v[12:13], v1
    v_mfma_f32_16x16x32_bf16 v[196:199], v[24:27], v[36:39], v[196:199]
    ds_read_b64_tr_b16 v[14:15], v1 offset:256
    v_mfma_f32_16x16x32_bf16 v[228:231], v[28:31], v[36:39], v[228:231]
    ds_read_b128 v[36:39], v7 offset:2048
    v_mfma_f32_16x16x32_bf16 v[168:171], v[20:23], v[40:43], v[168:171]
    ds_read_b64_tr_b16 v[16:17], v2
    v_mfma_f32_16x16x32_bf16 v[200:203], v[24:27], v[40:43], v[200:203]
    ds_read_b64_tr_b16 v[18:19], v2 offset:256
    v_mfma_f32_16x16x32_bf16 v[232:235], v[28:31], v[40:43], v[232:235]
    ds_read_b128 v[40:43], v7 offset:4096
    v_mfma_f32_16x16x32_bf16 v[172:175], v[20:23], v[44:47], v[172:175]
    v_mfma_f32_16x16x32_bf16 v[204:207], v[24:27], v[44:47], v[204:207]
    v_add_u32 v0, s61, v0
    v_mfma_f32_16x16x32_bf16 v[236:239], v[28:31], v[44:47], v[236:239]
    ds_read_b128 v[44:47], v7 offset:6144
    v_mfma_f32_16x16x32_bf16 v[176:179], v[20:23], v[48:51], v[176:179]
    v_add_u32 v1, s61, v1
    v_mfma_f32_16x16x32_bf16 v[208:211], v[24:27], v[48:51], v[208:211]
    v_add_u32 v2, s61, v2
    v_mfma_f32_16x16x32_bf16 v[240:243], v[28:31], v[48:51], v[240:243]
    ds_read_b128 v[48:51], v7 offset:8192
    v_mfma_f32_16x16x32_bf16 v[180:183], v[20:23], v[52:55], v[180:183]
    v_mfma_f32_16x16x32_bf16 v[212:215], v[24:27], v[52:55], v[212:215]
    v_mfma_f32_16x16x32_bf16 v[244:247], v[28:31], v[52:55], v[244:247]
    ds_read_b128 v[52:55], v7 offset:10240
    v_mfma_f32_16x16x32_bf16 v[184:187], v[20:23], v[56:59], v[184:187]
    v_mfma_f32_16x16x32_bf16 v[216:219], v[24:27], v[56:59], v[216:219]
    v_mfma_f32_16x16x32_bf16 v[248:251], v[28:31], v[56:59], v[248:251]
    ds_read_b128 v[56:59], v7 offset:12288
    v_mfma_f32_16x16x32_bf16 v[188:191], v[20:23], v[60:63], v[188:191]
    v_mfma_f32_16x16x32_bf16 v[220:223], v[24:27], v[60:63], v[220:223]
    v_mfma_f32_16x16x32_bf16 v[252:255], v[28:31], v[60:63], v[252:255]
    ds_read_b128 v[60:63], v7 offset:14336
    v_add_u32 v7, s66, v7
    s_waitcnt lgkmcnt(5)
    v_mfma_f32_16x16x32_bf16 v[64:67], v[8:11], v[32:35], v[64:67]
    ds_read_b64_tr_b16 v[20:21], v3
    v_mfma_f32_16x16x32_bf16 v[96:99], v[12:15], v[32:35], v[96:99]
    ds_read_b64_tr_b16 v[22:23], v3 offset:256
    v_mfma_f32_16x16x32_bf16 v[128:131], v[16:19], v[32:35], v[128:131]
    ds_read_b64_tr_b16 v[24:25], v4
    v_mfma_f32_16x16x32_bf16 v[68:71], v[8:11], v[36:39], v[68:71]
    ds_read_b64_tr_b16 v[26:27], v4 offset:256
    v_mfma_f32_16x16x32_bf16 v[100:103], v[12:15], v[36:39], v[100:103]
    ds_read_b64_tr_b16 v[28:29], v5
    v_mfma_f32_16x16x32_bf16 v[132:135], v[16:19], v[36:39], v[132:135]
    ds_read_b64_tr_b16 v[30:31], v5 offset:256
    v_mfma_f32_16x16x32_bf16 v[72:75], v[8:11], v[40:43], v[72:75]
    v_mfma_f32_16x16x32_bf16 v[104:107], v[12:15], v[40:43], v[104:107]
    v_mfma_f32_16x16x32_bf16 v[136:139], v[16:19], v[40:43], v[136:139]
    s_waitcnt lgkmcnt(8)
    v_mfma_f32_16x16x32_bf16 v[76:79], v[8:11], v[44:47], v[76:79]
    v_mfma_f32_16x16x32_bf16 v[108:111], v[12:15], v[44:47], v[108:111]
    v_mfma_f32_16x16x32_bf16 v[140:143], v[16:19], v[44:47], v[140:143]
    v_mfma_f32_16x16x32_bf16 v[80:83], v[8:11], v[48:51], v[80:83]
    v_add_u32 v3, s61, v3
    v_mfma_f32_16x16x32_bf16 v[112:115], v[12:15], v[48:51], v[112:115]
    v_add_u32 v4, s61, v4
    v_mfma_f32_16x16x32_bf16 v[144:147], v[16:19], v[48:51], v[144:147]
    v_add_u32 v5, s61, v5
    v_mfma_f32_16x16x32_bf16 v[84:87], v[8:11], v[52:55], v[84:87]
    v_mfma_f32_16x16x32_bf16 v[116:119], v[12:15], v[52:55], v[116:119]
    v_mfma_f32_16x16x32_bf16 v[148:151], v[16:19], v[52:55], v[148:151]
    s_waitcnt lgkmcnt(0)
    v_mfma_f32_16x16x32_bf16 v[88:91], v[8:11], v[56:59], v[88:91]
    s_add_u32 s60, s60, 1
    s_cmp_eq_u32 s60, 4
    v_mfma_f32_16x16x32_bf16 v[120:123], v[12:15], v[56:59], v[120:123]
    s_cselect_b32 s61, s63, s62
    s_cselect_b32 s60, -1, s60
    v_mfma_f32_16x16x32_bf16 v[152:155], v[16:19], v[56:59], v[152:155]
    s_add_u32 s59, s59, 1
    s_cmp_eq_u32 s59, 2
    v_mfma_f32_16x16x32_bf16 v[92:95], v[8:11], v[60:63], v[92:95]
    s_cselect_b32 s66, s65, s64
    s_cselect_b32 s59, -1, s59
    s_waitcnt vmcnt(0)
    v_mfma_f32_16x16x32_bf16 v[124:127], v[12:15], v[60:63], v[124:127]
    s_cmp_le_u32 s67, 2
    v_mfma_f32_16x16x32_bf16 v[156:159], v[16:19], v[60:63], v[156:159]
    s_cbranch_scc1 g1_gu_sk1
    s_barrier
g1_gu_bk1:
    v_mfma_f32_16x16x32_bf16 v[160:163], v[20:23], v[32:35], v[160:163]
    ds_read_b64_tr_b16 v[8:9], v0
    v_mfma_f32_16x16x32_bf16 v[192:195], v[24:27], v[32:35], v[192:195]
    ds_read_b64_tr_b16 v[10:11], v0 offset:256
    v_mfma_f32_16x16x32_bf16 v[224:227], v[28:31], v[32:35], v[224:227]
    ds_read_b128 v[32:35], v6 offset:0
    v_mfma_f32_16x16x32_bf16 v[164:167], v[20:23], v[36:39], v[164:167]
    ds_read_b64_tr_b16 v[12:13], v1
    v_mfma_f32_16x16x32_bf16 v[196:199], v[24:27], v[36:39], v[196:199]
    ds_read_b64_tr_b16 v[14:15], v1 offset:256
    v_mfma_f32_16x16x32_bf16 v[228:231], v[28:31], v[36:39], v[228:231]
    ds_read_b128 v[36:39], v6 offset:2048
    v_mfma_f32_16x16x32_bf16 v[168:171], v[20:23], v[40:43], v[168:171]
    ds_read_b64_tr_b16 v[16:17], v2
    v_mfma_f32_16x16x32_bf16 v[200:203], v[24:27], v[40:43], v[200:203]
    ds_read_b64_tr_b16 v[18:19], v2 offset:256
    v_mfma_f32_16x16x32_bf16 v[232:235], v[28:31], v[40:43], v[232:235]
    ds_read_b128 v[40:43], v6 offset:4096
    v_mfma_f32_16x16x32_bf16 v[172:175], v[20:23], v[44:47], v[172:175]
    v_mfma_f32_16x16x32_bf16 v[204:207], v[24:27], v[44:47], v[204:207]
    v_add_u32 v0, s61, v0
    v_mfma_f32_16x16x32_bf16 v[236:239], v[28:31], v[44:47], v[236:239]
    ds_read_b128 v[44:47], v6 offset:6144
    v_mfma_f32_16x16x32_bf16 v[176:179], v[20:23], v[48:51], v[176:179]
    v_add_u32 v1, s61, v1
    v_mfma_f32_16x16x32_bf16 v[208:211], v[24:27], v[48:51], v[208:211]
    v_add_u32 v2, s61, v2
    v_mfma_f32_16x16x32_bf16 v[240:243], v[28:31], v[48:51], v[240:243]
    ds_read_b128 v[48:51], v6 offset:8192
    v_mfma_f32_16x16x32_bf16 v[180:183], v[20:23], v[52:55], v[180:183]
    v_mfma_f32_16x16x32_bf16 v[212:215], v[24:27], v[52:55], v[212:215]
    v_mfma_f32_16x16x32_bf16 v[244:247], v[28:31], v[52:55], v[244:247]
    ds_read_b128 v[52:55], v6 offset:10240
    v_mfma_f32_16x16x32_bf16 v[184:187], v[20:23], v[56:59], v[184:187]
    v_mfma_f32_16x16x32_bf16 v[216:219], v[24:27], v[56:59], v[216:219]
    v_mfma_f32_16x16x32_bf16 v[248:251], v[28:31], v[56:59], v[248:251]
    ds_read_b128 v[56:59], v6 offset:12288
    v_mfma_f32_16x16x32_bf16 v[188:191], v[20:23], v[60:63], v[188:191]
    s_sub_u32 s67, s67, 1
    v_mfma_f32_16x16x32_bf16 v[220:223], v[24:27], v[60:63], v[220:223]
    s_cmp_lg_u32 s67, 0
    v_mfma_f32_16x16x32_bf16 v[252:255], v[28:31], v[60:63], v[252:255]
    ds_read_b128 v[60:63], v6 offset:14336
    v_add_u32 v6, s66, v6
    s_cbranch_scc1 g1_gu_loop
    v_mov_b32 v0, 61312
g1_gu_ep:
    v_mbcnt_lo_u32_b32 v2, -1, 0
    v_mbcnt_hi_u32_b32 v2, -1, v2
    s_waitcnt lgkmcnt(0) vmcnt(0)
    ds_read_b32 v1, v0 offset:100
    v_and_b32 v3, 15, v2
    v_lshrrev_b32 v4, 4, v2
    s_mul_i32 s4, s12, 384
    s_add_u32 s4, s4, 56064
    s_mov_b32 s52, 1.0
    s_mov_b32 s53, 1.0
    s_mov_b32 s89, 1
    s_mov_b32 s50, 0x358637bd
    v_lshl_add_u32 v5, v4, 4, s4
    s_lshl_b32 s4, s11, 11
    s_add_u32 s4, s4, 40960
    v_lshl_add_u32 v6, v3, 4, s4
    ds_read_b128 v[8:11], v5 offset:0
    ds_read_b128 v[12:15], v5 offset:64
    ds_read_b128 v[16:19], v5 offset:128
    ds_read_b128 v[20:23], v5 offset:192
    ds_read_b128 v[24:27], v5 offset:256
    ds_read_b128 v[28:31], v5 offset:320
    ds_read_b128 v[32:35], v6 offset:0
    ds_read_b128 v[36:39], v6 offset:256
    ds_read_b128 v[40:43], v6 offset:512
    ds_read_b128 v[44:47], v6 offset:768
    ds_read_b128 v[48:51], v6 offset:1024
    ds_read_b128 v[52:55], v6 offset:1280
    ds_read_b128 v[56:59], v6 offset:1536
    ds_read_b128 v[60:63], v6 offset:1792
    s_add_u32 s44, s34, 4210688
    s_addc_u32 s45, s35, 0
    s_and_b32 s45, s45, 0xffff
    s_mov_b32 s46, 7077888
    s_mov_b32 s47, 0x00020000
    v_lshrrev_b32 v6, 1, v4
    v_mul_u32_u24 v5, 55296, v6
    v_lshl_add_u32 v5, v3, 4, v5
    v_and_b32 v6, 1, v4
    v_lshl_add_u32 v5, v6, 8, v5
    s_lshl_b32 s4, s6, 1
    s_add_u32 s4, s4, s11
    s_mul_i32 s4, s4, 442368
    s_sub_u32 s15, s7, 12
    s_mul_i32 s15, s15, 6
    s_mul_i32 s5, s12, 3
    s_add_u32 s15, s15, s5
    s_lshl_b32 s15, s15, 9
    s_add_u32 s4, s4, s15
    s_mov_b32 s54, 0xc1a00000
    s_mov_b32 s55, 0xc1a00000
    s_waitcnt lgkmcnt(6)
    v_readfirstlane_b32 s58, v1
    s_cmp_lt_u32 s58, 4
    s_cbranch_scc1 g1_gu_ep
    v_mul_f32 v34, 0x49800000, v33
    v_mul_f32 v38, 0x49800000, v37
    v_pk_fma_f32 v[64:65], v[8:9], v[32:33], v[64:65] op_sel_hi:[1,0,1]
    v_pk_fma_f32 v[66:67], v[10:11], v[32:33], v[66:67] op_sel_hi:[1,0,1]
    v_pk_fma_f32 v[64:65], v[64:65], v[34:35], s[54:55] op_sel:[0,1,0] op_sel_hi:[1,1,1]
    v_exp_f32_e64 v64, v64 clamp
    v_exp_f32_e64 v65, v65 clamp
    v_pk_fma_f32 v[66:67], v[66:67], v[34:35], s[54:55] op_sel:[0,1,0] op_sel_hi:[1,1,1]
    v_exp_f32_e64 v66, v66 clamp
    v_exp_f32_e64 v67, v67 clamp
    v_pk_fma_f32 v[160:161], v[20:21], v[32:33], v[160:161] op_sel_hi:[1,0,1]
    v_pk_fma_f32 v[162:163], v[22:23], v[32:33], v[162:163] op_sel_hi:[1,0,1]
    v_pk_fma_f32 v[68:69], v[8:9], v[36:37], v[68:69] op_sel_hi:[1,0,1]
    v_pk_fma_f32 v[70:71], v[10:11], v[36:37], v[70:71] op_sel_hi:[1,0,1]
    v_pk_fma_f32 v[68:69], v[68:69], v[38:39], s[54:55] op_sel:[0,1,0] op_sel_hi:[1,1,1]
    v_exp_f32_e64 v68, v68 clamp
    v_exp_f32_e64 v69, v69 clamp
    v_pk_fma_f32 v[70:71], v[70:71], v[38:39], s[54:55] op_sel:[0,1,0] op_sel_hi:[1,1,1]
    v_exp_f32_e64 v70, v70 clamp
    v_exp_f32_e64 v71, v71 clamp
    v_pk_fma_f32 v[164:165], v[20:21], v[36:37], v[164:165] op_sel_hi:[1,0,1]
    v_pk_fma_f32 v[166:167], v[22:23], v[36:37], v[166:167] op_sel_hi:[1,0,1]
    v_pk_fma_f32 v[64:65], v[64:65], v[34:35], v[32:33] op_sel:[0,0,1] op_sel_hi:[1,0,1]
    v_pk_fma_f32 v[66:67], v[66:67], v[34:35], v[32:33] op_sel:[0,0,1] op_sel_hi:[1,0,1]
    v_pk_fma_f32 v[68:69], v[68:69], v[38:39], v[36:37] op_sel:[0,0,1] op_sel_hi:[1,0,1]
    v_pk_fma_f32 v[70:71], v[70:71], v[38:39], v[36:37] op_sel:[0,0,1] op_sel_hi:[1,0,1]
    v_pk_mul_f32 v[0:1], v[64:65], v[66:67]
    v_pk_mul_f32 v[2:3], v[68:69], v[70:71]
    v_pk_mul_f32 v[6:7], v[0:1], v[2:3]
    v_rcp_f32 v6, v6
    v_rcp_f32 v7, v7
    v_pk_mul_f32 v[160:161], v[160:161], v[66:67]
    v_pk_mul_f32 v[162:163], v[162:163], v[64:65]
    v_pk_mul_f32 v[164:165], v[164:165], v[70:71]
    v_pk_mul_f32 v[166:167], v[166:167], v[68:69]
    v_pk_mul_f32 v[2:3], v[2:3], v[6:7]
    v_pk_mul_f32 v[0:1], v[0:1], v[6:7]
    v_pk_mul_f32 v[64:65], v[160:161], v[2:3]
    v_pk_mul_f32 v[66:67], v[162:163], v[2:3]
    v_pk_mul_f32 v[68:69], v[164:165], v[0:1]
    v_pk_mul_f32 v[70:71], v[166:167], v[0:1]
    v_cvt_pk_bf16_f32 v160, v64, v65
    v_cvt_pk_bf16_f32 v161, v66, v67
    v_cvt_pk_bf16_f32 v162, v68, v69
    v_cvt_pk_bf16_f32 v163, v70, v71
    v_pk_fma_f32 v[96:97], v[12:13], v[32:33], v[96:97] op_sel_hi:[1,0,1]
    v_pk_fma_f32 v[98:99], v[14:15], v[32:33], v[98:99] op_sel_hi:[1,0,1]
    v_pk_fma_f32 v[96:97], v[96:97], v[34:35], s[54:55] op_sel:[0,1,0] op_sel_hi:[1,1,1]
    v_exp_f32_e64 v96, v96 clamp
    v_exp_f32_e64 v97, v97 clamp
    v_pk_fma_f32 v[98:99], v[98:99], v[34:35], s[54:55] op_sel:[0,1,0] op_sel_hi:[1,1,1]
    v_exp_f32_e64 v98, v98 clamp
    v_exp_f32_e64 v99, v99 clamp
    v_pk_fma_f32 v[192:193], v[24:25], v[32:33], v[192:193] op_sel_hi:[1,0,1]
    v_pk_fma_f32 v[194:195], v[26:27], v[32:33], v[194:195] op_sel_hi:[1,0,1]
    v_pk_fma_f32 v[100:101], v[12:13], v[36:37], v[100:101] op_sel_hi:[1,0,1]
    v_pk_fma_f32 v[102:103], v[14:15], v[36:37], v[102:103] op_sel_hi:[1,0,1]
    v_pk_fma_f32 v[100:101], v[100:101], v[38:39], s[54:55] op_sel:[0,1,0] op_sel_hi:[1,1,1]
    v_exp_f32_e64 v100, v100 clamp
    v_exp_f32_e64 v101, v101 clamp
    v_pk_fma_f32 v[102:103], v[102:103], v[38:39], s[54:55] op_sel:[0,1,0] op_sel_hi:[1,1,1]
    v_exp_f32_e64 v102, v102 clamp
    v_exp_f32_e64 v103, v103 clamp
    v_pk_fma_f32 v[196:197], v[24:25], v[36:37], v[196:197] op_sel_hi:[1,0,1]
    v_pk_fma_f32 v[198:199], v[26:27], v[36:37], v[198:199] op_sel_hi:[1,0,1]
    v_permlane32_swap_b32 v160, v162
    v_permlane32_swap_b32 v161, v163
    buffer_store_dwordx4 v[160:163], v5, s[44:47], s4 offen offset:0 sc1
    v_pk_fma_f32 v[96:97], v[96:97], v[34:35], v[32:33] op_sel:[0,0,1] op_sel_hi:[1,0,1]
    v_pk_fma_f32 v[98:99], v[98:99], v[34:35], v[32:33] op_sel:[0,0,1] op_sel_hi:[1,0,1]
    v_pk_fma_f32 v[100:101], v[100:101], v[38:39], v[36:37] op_sel:[0,0,1] op_sel_hi:[1,0,1]
    v_pk_fma_f32 v[102:103], v[102:103], v[38:39], v[36:37] op_sel:[0,0,1] op_sel_hi:[1,0,1]
    v_pk_mul_f32 v[0:1], v[96:97], v[98:99]
    v_pk_mul_f32 v[2:3], v[100:101], v[102:103]
    v_pk_mul_f32 v[6:7], v[0:1], v[2:3]
    v_rcp_f32 v6, v6
    v_rcp_f32 v7, v7
    v_pk_mul_f32 v[192:193], v[192:193], v[98:99]
    v_pk_mul_f32 v[194:195], v[194:195], v[96:97]
    v_pk_mul_f32 v[196:197], v[196:197], v[102:103]
    v_pk_mul_f32 v[198:199], v[198:199], v[100:101]
    v_pk_mul_f32 v[2:3], v[2:3], v[6:7]
    v_pk_mul_f32 v[0:1], v[0:1], v[6:7]
    v_pk_mul_f32 v[96:97], v[192:193], v[2:3]
    v_pk_mul_f32 v[98:99], v[194:195], v[2:3]
    v_pk_mul_f32 v[100:101], v[196:197], v[0:1]
    v_pk_mul_f32 v[102:103], v[198:199], v[0:1]
    v_cvt_pk_bf16_f32 v192, v96, v97
    v_cvt_pk_bf16_f32 v193, v98, v99
    v_cvt_pk_bf16_f32 v194, v100, v101
    v_cvt_pk_bf16_f32 v195, v102, v103
    v_pk_fma_f32 v[128:129], v[16:17], v[32:33], v[128:129] op_sel_hi:[1,0,1]
    v_pk_fma_f32 v[130:131], v[18:19], v[32:33], v[130:131] op_sel_hi:[1,0,1]
    v_pk_fma_f32 v[128:129], v[128:129], v[34:35], s[54:55] op_sel:[0,1,0] op_sel_hi:[1,1,1]
    v_exp_f32_e64 v128, v128 clamp
    v_exp_f32_e64 v129, v129 clamp
    v_pk_fma_f32 v[130:131], v[130:131], v[34:35], s[54:55] op_sel:[0,1,0] op_sel_hi:[1,1,1]
    v_exp_f32_e64 v130, v130 clamp
    v_exp_f32_e64 v131, v131 clamp
    v_pk_fma_f32 v[224:225], v[28:29], v[32:33], v[224:225] op_sel_hi:[1,0,1]
    v_pk_fma_f32 v[226:227], v[30:31], v[32:33], v[226:227] op_sel_hi:[1,0,1]
    v_pk_fma_f32 v[132:133], v[16:17], v[36:37], v[132:133] op_sel_hi:[1,0,1]
    v_pk_fma_f32 v[134:135], v[18:19], v[36:37], v[134:135] op_sel_hi:[1,0,1]
    v_pk_fma_f32 v[132:133], v[132:133], v[38:39], s[54:55] op_sel:[0,1,0] op_sel_hi:[1,1,1]
    v_exp_f32_e64 v132, v132 clamp
    v_exp_f32_e64 v133, v133 clamp
    v_pk_fma_f32 v[134:135], v[134:135], v[38:39], s[54:55] op_sel:[0,1,0] op_sel_hi:[1,1,1]
    v_exp_f32_e64 v134, v134 clamp
    v_exp_f32_e64 v135, v135 clamp
    v_pk_fma_f32 v[228:229], v[28:29], v[36:37], v[228:229] op_sel_hi:[1,0,1]
    v_pk_fma_f32 v[230:231], v[30:31], v[36:37], v[230:231] op_sel_hi:[1,0,1]
    v_permlane32_swap_b32 v192, v194
    v_permlane32_swap_b32 v193, v195
    buffer_store_dwordx4 v[192:195], v5, s[44:47], s4 offen offset:512 sc1
    v_pk_fma_f32 v[128:129], v[128:129], v[34:35], v[32:33] op_sel:[0,0,1] op_sel_hi:[1,0,1]
    v_pk_fma_f32 v[130:131], v[130:131], v[34:35], v[32:33] op_sel:[0,0,1] op_sel_hi:[1,0,1]
    v_pk_fma_f32 v[132:133], v[132:133], v[38:39], v[36:37] op_sel:[0,0,1] op_sel_hi:[1,0,1]
    v_pk_fma_f32 v[134:135], v[134:135], v[38:39], v[36:37] op_sel:[0,0,1] op_sel_hi:[1,0,1]
    v_pk_mul_f32 v[0:1], v[128:129], v[130:131]
    v_pk_mul_f32 v[2:3], v[132:133], v[134:135]
    v_pk_mul_f32 v[6:7], v[0:1], v[2:3]
    v_rcp_f32 v6, v6
    v_rcp_f32 v7, v7
    v_pk_mul_f32 v[224:225], v[224:225], v[130:131]
    v_pk_mul_f32 v[226:227], v[226:227], v[128:129]
    v_pk_mul_f32 v[228:229], v[228:229], v[134:135]
    v_pk_mul_f32 v[230:231], v[230:231], v[132:133]
    v_pk_mul_f32 v[2:3], v[2:3], v[6:7]
    v_pk_mul_f32 v[0:1], v[0:1], v[6:7]
    v_pk_mul_f32 v[128:129], v[224:225], v[2:3]
    v_pk_mul_f32 v[130:131], v[226:227], v[2:3]
    v_pk_mul_f32 v[132:133], v[228:229], v[0:1]
    v_pk_mul_f32 v[134:135], v[230:231], v[0:1]
    v_cvt_pk_bf16_f32 v224, v128, v129
    v_cvt_pk_bf16_f32 v225, v130, v131
    v_cvt_pk_bf16_f32 v226, v132, v133
    v_cvt_pk_bf16_f32 v227, v134, v135
    s_waitcnt lgkmcnt(0)
    v_mul_f32 v42, 0x49800000, v41
    v_mul_f32 v46, 0x49800000, v45
    v_pk_fma_f32 v[72:73], v[8:9], v[40:41], v[72:73] op_sel_hi:[1,0,1]
    v_pk_fma_f32 v[74:75], v[10:11], v[40:41], v[74:75] op_sel_hi:[1,0,1]
    v_pk_fma_f32 v[72:73], v[72:73], v[42:43], s[54:55] op_sel:[0,1,0] op_sel_hi:[1,1,1]
    v_exp_f32_e64 v72, v72 clamp
    v_exp_f32_e64 v73, v73 clamp
    v_pk_fma_f32 v[74:75], v[74:75], v[42:43], s[54:55] op_sel:[0,1,0] op_sel_hi:[1,1,1]
    v_exp_f32_e64 v74, v74 clamp
    v_exp_f32_e64 v75, v75 clamp
    v_pk_fma_f32 v[168:169], v[20:21], v[40:41], v[168:169] op_sel_hi:[1,0,1]
    v_pk_fma_f32 v[170:171], v[22:23], v[40:41], v[170:171] op_sel_hi:[1,0,1]
    v_pk_fma_f32 v[76:77], v[8:9], v[44:45], v[76:77] op_sel_hi:[1,0,1]
    v_pk_fma_f32 v[78:79], v[10:11], v[44:45], v[78:79] op_sel_hi:[1,0,1]
    v_pk_fma_f32 v[76:77], v[76:77], v[46:47], s[54:55] op_sel:[0,1,0] op_sel_hi:[1,1,1]
    v_exp_f32_e64 v76, v76 clamp
    v_exp_f32_e64 v77, v77 clamp
    v_pk_fma_f32 v[78:79], v[78:79], v[46:47], s[54:55] op_sel:[0,1,0] op_sel_hi:[1,1,1]
    v_exp_f32_e64 v78, v78 clamp
    v_exp_f32_e64 v79, v79 clamp
    v_pk_fma_f32 v[172:173], v[20:21], v[44:45], v[172:173] op_sel_hi:[1,0,1]
    v_pk_fma_f32 v[174:175], v[22:23], v[44:45], v[174:175] op_sel_hi:[1,0,1]
    v_permlane32_swap_b32 v224, v226
    v_permlane32_swap_b32 v225, v227
    buffer_store_dwordx4 v[224:227], v5, s[44:47], s4 offen offset:1024 sc1
    s_add_u32 s4, s4, 110592
    v_pk_fma_f32 v[72:73], v[72:73], v[42:43], v[40:41] op_sel:[0,0,1] op_sel_hi:[1,0,1]
    v_pk_fma_f32 v[74:75], v[74:75], v[42:43], v[40:41] op_sel:[0,0,1] op_sel_hi:[1,0,1]
    v_pk_fma_f32 v[76:77], v[76:77], v[46:47], v[44:45] op_sel:[0,0,1] op_sel_hi:[1,0,1]
    v_pk_fma_f32 v[78:79], v[78:79], v[46:47], v[44:45] op_sel:[0,0,1] op_sel_hi:[1,0,1]
    v_pk_mul_f32 v[0:1], v[72:73], v[74:75]
    v_pk_mul_f32 v[2:3], v[76:77], v[78:79]
    v_pk_mul_f32 v[6:7], v[0:1], v[2:3]
    v_rcp_f32 v6, v6
    v_rcp_f32 v7, v7
    v_pk_mul_f32 v[168:169], v[168:169], v[74:75]
    v_pk_mul_f32 v[170:171], v[170:171], v[72:73]
    v_pk_mul_f32 v[172:173], v[172:173], v[78:79]
    v_pk_mul_f32 v[174:175], v[174:175], v[76:77]
    v_pk_mul_f32 v[2:3], v[2:3], v[6:7]
    v_pk_mul_f32 v[0:1], v[0:1], v[6:7]
    v_pk_mul_f32 v[72:73], v[168:169], v[2:3]
    v_pk_mul_f32 v[74:75], v[170:171], v[2:3]
    v_pk_mul_f32 v[76:77], v[172:173], v[0:1]
    v_pk_mul_f32 v[78:79], v[174:175], v[0:1]
    v_cvt_pk_bf16_f32 v168, v72, v73
    v_cvt_pk_bf16_f32 v169, v74, v75
    v_cvt_pk_bf16_f32 v170, v76, v77
    v_cvt_pk_bf16_f32 v171, v78, v79
    v_pk_fma_f32 v[104:105], v[12:13], v[40:41], v[104:105] op_sel_hi:[1,0,1]
    v_pk_fma_f32 v[106:107], v[14:15], v[40:41], v[106:107] op_sel_hi:[1,0,1]
    v_pk_fma_f32 v[104:105], v[104:105], v[42:43], s[54:55] op_sel:[0,1,0] op_sel_hi:[1,1,1]
    v_exp_f32_e64 v104, v104 clamp
    v_exp_f32_e64 v105, v105 clamp
    v_pk_fma_f32 v[106:107], v[106:107], v[42:43], s[54:55] op_sel:[0,1,0] op_sel_hi:[1,1,1]
    v_exp_f32_e64 v106, v106 clamp
    v_exp_f32_e64 v107, v107 clamp
    v_pk_fma_f32 v[200:201], v[24:25], v[40:41], v[200:201] op_sel_hi:[1,0,1]
    v_pk_fma_f32 v[202:203], v[26:27], v[40:41], v[202:203] op_sel_hi:[1,0,1]
    v_pk_fma_f32 v[108:109], v[12:13], v[44:45], v[108:109] op_sel_hi:[1,0,1]
    v_pk_fma_f32 v[110:111], v[14:15], v[44:45], v[110:111] op_sel_hi:[1,0,1]
    v_pk_fma_f32 v[108:109], v[108:109], v[46:47], s[54:55] op_sel:[0,1,0] op_sel_hi:[1,1,1]
    v_exp_f32_e64 v108, v108 clamp
    v_exp_f32_e64 v109, v109 clamp
    v_pk_fma_f32 v[110:111], v[110:111], v[46:47], s[54:55] op_sel:[0,1,0] op_sel_hi:[1,1,1]
    v_exp_f32_e64 v110, v110 clamp
    v_exp_f32_e64 v111, v111 clamp
    v_pk_fma_f32 v[204:205], v[24:25], v[44:45], v[204:205] op_sel_hi:[1,0,1]
    v_pk_fma_f32 v[206:207], v[26:27], v[44:45], v[206:207] op_sel_hi:[1,0,1]
    v_permlane32_swap_b32 v168, v170
    v_permlane32_swap_b32 v169, v171
    buffer_store_dwordx4 v[168:171], v5, s[44:47], s4 offen offset:0 sc1
    v_pk_fma_f32 v[104:105], v[104:105], v[42:43], v[40:41] op_sel:[0,0,1] op_sel_hi:[1,0,1]
    v_pk_fma_f32 v[106:107], v[106:107], v[42:43], v[40:41] op_sel:[0,0,1] op_sel_hi:[1,0,1]
    v_pk_fma_f32 v[108:109], v[108:109], v[46:47], v[44:45] op_sel:[0,0,1] op_sel_hi:[1,0,1]
    v_pk_fma_f32 v[110:111], v[110:111], v[46:47], v[44:45] op_sel:[0,0,1] op_sel_hi:[1,0,1]
    v_pk_mul_f32 v[0:1], v[104:105], v[106:107]
    v_pk_mul_f32 v[2:3], v[108:109], v[110:111]
    v_pk_mul_f32 v[6:7], v[0:1], v[2:3]
    v_rcp_f32 v6, v6
    v_rcp_f32 v7, v7
    v_pk_mul_f32 v[200:201], v[200:201], v[106:107]
    v_pk_mul_f32 v[202:203], v[202:203], v[104:105]
    v_pk_mul_f32 v[204:205], v[204:205], v[110:111]
    v_pk_mul_f32 v[206:207], v[206:207], v[108:109]
    v_pk_mul_f32 v[2:3], v[2:3], v[6:7]
    v_pk_mul_f32 v[0:1], v[0:1], v[6:7]
    v_pk_mul_f32 v[104:105], v[200:201], v[2:3]
    v_pk_mul_f32 v[106:107], v[202:203], v[2:3]
    v_pk_mul_f32 v[108:109], v[204:205], v[0:1]
    v_pk_mul_f32 v[110:111], v[206:207], v[0:1]
    v_cvt_pk_bf16_f32 v200, v104, v105
    v_cvt_pk_bf16_f32 v201, v106, v107
    v_cvt_pk_bf16_f32 v202, v108, v109
    v_cvt_pk_bf16_f32 v203, v110, v111
    v_pk_fma_f32 v[136:137], v[16:17], v[40:41], v[136:137] op_sel_hi:[1,0,1]
    v_pk_fma_f32 v[138:139], v[18:19], v[40:41], v[138:139] op_sel_hi:[1,0,1]
    v_pk_fma_f32 v[136:137], v[136:137], v[42:43], s[54:55] op_sel:[0,1,0] op_sel_hi:[1,1,1]
    v_exp_f32_e64 v136, v136 clamp
    v_exp_f32_e64 v137, v137 clamp
    v_pk_fma_f32 v[138:139], v[138:139], v[42:43], s[54:55] op_sel:[0,1,0] op_sel_hi:[1,1,1]
    v_exp_f32_e64 v138, v138 clamp
    v_exp_f32_e64 v139, v139 clamp
    v_pk_fma_f32 v[232:233], v[28:29], v[40:41], v[232:233] op_sel_hi:[1,0,1]
    v_pk_fma_f32 v[234:235], v[30:31], v[40:41], v[234:235] op_sel_hi:[1,0,1]
    v_pk_fma_f32 v[140:141], v[16:17], v[44:45], v[140:141] op_sel_hi:[1,0,1]
    v_pk_fma_f32 v[142:143], v[18:19], v[44:45], v[142:143] op_sel_hi:[1,0,1]
    v_pk_fma_f32 v[140:141], v[140:141], v[46:47], s[54:55] op_sel:[0,1,0] op_sel_hi:[1,1,1]
    v_exp_f32_e64 v140, v140 clamp
    v_exp_f32_e64 v141, v141 clamp
    v_pk_fma_f32 v[142:143], v[142:143], v[46:47], s[54:55] op_sel:[0,1,0] op_sel_hi:[1,1,1]
    v_exp_f32_e64 v142, v142 clamp
    v_exp_f32_e64 v143, v143 clamp
    v_pk_fma_f32 v[236:237], v[28:29], v[44:45], v[236:237] op_sel_hi:[1,0,1]
    v_pk_fma_f32 v[238:239], v[30:31], v[44:45], v[238:239] op_sel_hi:[1,0,1]
    v_permlane32_swap_b32 v200, v202
    v_permlane32_swap_b32 v201, v203
    buffer_store_dwordx4 v[200:203], v5, s[44:47], s4 offen offset:512 sc1
    v_pk_fma_f32 v[136:137], v[136:137], v[42:43], v[40:41] op_sel:[0,0,1] op_sel_hi:[1,0,1]
    v_pk_fma_f32 v[138:139], v[138:139], v[42:43], v[40:41] op_sel:[0,0,1] op_sel_hi:[1,0,1]
    v_pk_fma_f32 v[140:141], v[140:141], v[46:47], v[44:45] op_sel:[0,0,1] op_sel_hi:[1,0,1]
    v_pk_fma_f32 v[142:143], v[142:143], v[46:47], v[44:45] op_sel:[0,0,1] op_sel_hi:[1,0,1]
    v_pk_mul_f32 v[0:1], v[136:137], v[138:139]
    v_pk_mul_f32 v[2:3], v[140:141], v[142:143]
    v_pk_mul_f32 v[6:7], v[0:1], v[2:3]
    v_rcp_f32 v6, v6
    v_rcp_f32 v7, v7
    v_pk_mul_f32 v[232:233], v[232:233], v[138:139]
    v_pk_mul_f32 v[234:235], v[234:235], v[136:137]
    v_pk_mul_f32 v[236:237], v[236:237], v[142:143]
    v_pk_mul_f32 v[238:239], v[238:239], v[140:141]
    v_pk_mul_f32 v[2:3], v[2:3], v[6:7]
    v_pk_mul_f32 v[0:1], v[0:1], v[6:7]
    v_pk_mul_f32 v[136:137], v[232:233], v[2:3]
    v_pk_mul_f32 v[138:139], v[234:235], v[2:3]
    v_pk_mul_f32 v[140:141], v[236:237], v[0:1]
    v_pk_mul_f32 v[142:143], v[238:239], v[0:1]
    v_cvt_pk_bf16_f32 v232, v136, v137
    v_cvt_pk_bf16_f32 v233, v138, v139
    v_cvt_pk_bf16_f32 v234, v140, v141
    v_cvt_pk_bf16_f32 v235, v142, v143
    v_mul_f32 v50, 0x49800000, v49
    v_mul_f32 v54, 0x49800000, v53
    v_pk_fma_f32 v[80:81], v[8:9], v[48:49], v[80:81] op_sel_hi:[1,0,1]
    v_pk_fma_f32 v[82:83], v[10:11], v[48:49], v[82:83] op_sel_hi:[1,0,1]
    v_pk_fma_f32 v[80:81], v[80:81], v[50:51], s[54:55] op_sel:[0,1,0] op_sel_hi:[1,1,1]
    v_exp_f32_e64 v80, v80 clamp
    v_exp_f32_e64 v81, v81 clamp
    v_pk_fma_f32 v[82:83], v[82:83], v[50:51], s[54:55] op_sel:[0,1,0] op_sel_hi:[1,1,1]
    v_exp_f32_e64 v82, v82 clamp
    v_exp_f32_e64 v83, v83 clamp
    v_pk_fma_f32 v[176:177], v[20:21], v[48:49], v[176:177] op_sel_hi:[1,0,1]
    v_pk_fma_f32 v[178:179], v[22:23], v[48:49], v[178:179] op_sel_hi:[1,0,1]
    v_pk_fma_f32 v[84:85], v[8:9], v[52:53], v[84:85] op_sel_hi:[1,0,1]
    v_pk_fma_f32 v[86:87], v[10:11], v[52:53], v[86:87] op_sel_hi:[1,0,1]
    v_pk_fma_f32 v[84:85], v[84:85], v[54:55], s[54:55] op_sel:[0,1,0] op_sel_hi:[1,1,1]
    v_exp_f32_e64 v84, v84 clamp
    v_exp_f32_e64 v85, v85 clamp
    v_pk_fma_f32 v[86:87], v[86:87], v[54:55], s[54:55] op_sel:[0,1,0] op_sel_hi:[1,1,1]
    v_exp_f32_e64 v86, v86 clamp
    v_exp_f32_e64 v87, v87 clamp
    v_pk_fma_f32 v[180:181], v[20:21], v[52:53], v[180:181] op_sel_hi:[1,0,1]
    v_pk_fma_f32 v[182:183], v[22:23], v[52:53], v[182:183] op_sel_hi:[1,0,1]
    v_permlane32_swap_b32 v232, v234
    v_permlane32_swap_b32 v233, v235
    buffer_store_dwordx4 v[232:235], v5, s[44:47], s4 offen offset:1024 sc1
    s_add_u32 s4, s4, 110592
    v_pk_fma_f32 v[80:81], v[80:81], v[50:51], v[48:49] op_sel:[0,0,1] op_sel_hi:[1,0,1]
    v_pk_fma_f32 v[82:83], v[82:83], v[50:51], v[48:49] op_sel:[0,0,1] op_sel_hi:[1,0,1]
    v_pk_fma_f32 v[84:85], v[84:85], v[54:55], v[52:53] op_sel:[0,0,1] op_sel_hi:[1,0,1]
    v_pk_fma_f32 v[86:87], v[86:87], v[54:55], v[52:53] op_sel:[0,0,1] op_sel_hi:[1,0,1]
    v_pk_mul_f32 v[0:1], v[80:81], v[82:83]
    v_pk_mul_f32 v[2:3], v[84:85], v[86:87]
    v_pk_mul_f32 v[6:7], v[0:1], v[2:3]
    v_rcp_f32 v6, v6
    v_rcp_f32 v7, v7
    v_pk_mul_f32 v[176:177], v[176:177], v[82:83]
    v_pk_mul_f32 v[178:179], v[178:179], v[80:81]
    v_pk_mul_f32 v[180:181], v[180:181], v[86:87]
    v_pk_mul_f32 v[182:183], v[182:183], v[84:85]
    v_pk_mul_f32 v[2:3], v[2:3], v[6:7]
    v_pk_mul_f32 v[0:1], v[0:1], v[6:7]
    v_pk_mul_f32 v[80:81], v[176:177], v[2:3]
    v_pk_mul_f32 v[82:83], v[178:179], v[2:3]
    v_pk_mul_f32 v[84:85], v[180:181], v[0:1]
    v_pk_mul_f32 v[86:87], v[182:183], v[0:1]
    v_cvt_pk_bf16_f32 v176, v80, v81
    v_cvt_pk_bf16_f32 v177, v82, v83
    v_cvt_pk_bf16_f32 v178, v84, v85
    v_cvt_pk_bf16_f32 v179, v86, v87
    v_pk_fma_f32 v[112:113], v[12:13], v[48:49], v[112:113] op_sel_hi:[1,0,1]
    v_pk_fma_f32 v[114:115], v[14:15], v[48:49], v[114:115] op_sel_hi:[1,0,1]
    v_pk_fma_f32 v[112:113], v[112:113], v[50:51], s[54:55] op_sel:[0,1,0] op_sel_hi:[1,1,1]
    v_exp_f32_e64 v112, v112 clamp
    v_exp_f32_e64 v113, v113 clamp
    v_pk_fma_f32 v[114:115], v[114:115], v[50:51], s[54:55] op_sel:[0,1,0] op_sel_hi:[1,1,1]
    v_exp_f32_e64 v114, v114 clamp
    v_exp_f32_e64 v115, v115 clamp
    v_pk_fma_f32 v[208:209], v[24:25], v[48:49], v[208:209] op_sel_hi:[1,0,1]
    v_pk_fma_f32 v[210:211], v[26:27], v[48:49], v[210:211] op_sel_hi:[1,0,1]
    v_pk_fma_f32 v[116:117], v[12:13], v[52:53], v[116:117] op_sel_hi:[1,0,1]
    v_pk_fma_f32 v[118:119], v[14:15], v[52:53], v[118:119] op_sel_hi:[1,0,1]
    v_pk_fma_f32 v[116:117], v[116:117], v[54:55], s[54:55] op_sel:[0,1,0] op_sel_hi:[1,1,1]
    v_exp_f32_e64 v116, v116 clamp
    v_exp_f32_e64 v117, v117 clamp
    v_pk_fma_f32 v[118:119], v[118:119], v[54:55], s[54:55] op_sel:[0,1,0] op_sel_hi:[1,1,1]
    v_exp_f32_e64 v118, v118 clamp
    v_exp_f32_e64 v119, v119 clamp
    v_pk_fma_f32 v[212:213], v[24:25], v[52:53], v[212:213] op_sel_hi:[1,0,1]
    v_pk_fma_f32 v[214:215], v[26:27], v[52:53], v[214:215] op_sel_hi:[1,0,1]
    v_permlane32_swap_b32 v176, v178
    v_permlane32_swap_b32 v177, v179
    buffer_store_dwordx4 v[176:179], v5, s[44:47], s4 offen offset:0 sc1
    v_pk_fma_f32 v[112:113], v[112:113], v[50:51], v[48:49] op_sel:[0,0,1] op_sel_hi:[1,0,1]
    v_pk_fma_f32 v[114:115], v[114:115], v[50:51], v[48:49] op_sel:[0,0,1] op_sel_hi:[1,0,1]
    v_pk_fma_f32 v[116:117], v[116:117], v[54:55], v[52:53] op_sel:[0,0,1] op_sel_hi:[1,0,1]
    v_pk_fma_f32 v[118:119], v[118:119], v[54:55], v[52:53] op_sel:[0,0,1] op_sel_hi:[1,0,1]
    v_pk_mul_f32 v[0:1], v[112:113], v[114:115]
    v_pk_mul_f32 v[2:3], v[116:117], v[118:119]
    v_pk_mul_f32 v[6:7], v[0:1], v[2:3]
    v_rcp_f32 v6, v6
    v_rcp_f32 v7, v7
    v_pk_mul_f32 v[208:209], v[208:209], v[114:115]
    v_pk_mul_f32 v[210:211], v[210:211], v[112:113]
    v_pk_mul_f32 v[212:213], v[212:213], v[118:119]
    v_pk_mul_f32 v[214:215], v[214:215], v[116:117]
    v_pk_mul_f32 v[2:3], v[2:3], v[6:7]
    v_pk_mul_f32 v[0:1], v[0:1], v[6:7]
    v_pk_mul_f32 v[112:113], v[208:209], v[2:3]
    v_pk_mul_f32 v[114:115], v[210:211], v[2:3]
    v_pk_mul_f32 v[116:117], v[212:213], v[0:1]
    v_pk_mul_f32 v[118:119], v[214:215], v[0:1]
    v_cvt_pk_bf16_f32 v208, v112, v113
    v_cvt_pk_bf16_f32 v209, v114, v115
    v_cvt_pk_bf16_f32 v210, v116, v117
    v_cvt_pk_bf16_f32 v211, v118, v119
    v_pk_fma_f32 v[144:145], v[16:17], v[48:49], v[144:145] op_sel_hi:[1,0,1]
    v_pk_fma_f32 v[146:147], v[18:19], v[48:49], v[146:147] op_sel_hi:[1,0,1]
    v_pk_fma_f32 v[144:145], v[144:145], v[50:51], s[54:55] op_sel:[0,1,0] op_sel_hi:[1,1,1]
    v_exp_f32_e64 v144, v144 clamp
    v_exp_f32_e64 v145, v145 clamp
    v_pk_fma_f32 v[146:147], v[146:147], v[50:51], s[54:55] op_sel:[0,1,0] op_sel_hi:[1,1,1]
    v_exp_f32_e64 v146, v146 clamp
    v_exp_f32_e64 v147, v147 clamp
    v_pk_fma_f32 v[240:241], v[28:29], v[48:49], v[240:241] op_sel_hi:[1,0,1]
    v_pk_fma_f32 v[242:243], v[30:31], v[48:49], v[242:243] op_sel_hi:[1,0,1]
    v_pk_fma_f32 v[148:149], v[16:17], v[52:53], v[148:149] op_sel_hi:[1,0,1]
    v_pk_fma_f32 v[150:151], v[18:19], v[52:53], v[150:151] op_sel_hi:[1,0,1]
    v_pk_fma_f32 v[148:149], v[148:149], v[54:55], s[54:55] op_sel:[0,1,0] op_sel_hi:[1,1,1]
    v_exp_f32_e64 v148, v148 clamp
    v_exp_f32_e64 v149, v149 clamp
    v_pk_fma_f32 v[150:151], v[150:151], v[54:55], s[54:55] op_sel:[0,1,0] op_sel_hi:[1,1,1]
    v_exp_f32_e64 v150, v150 clamp
    v_exp_f32_e64 v151, v151 clamp
    v_pk_fma_f32 v[244:245], v[28:29], v[52:53], v[244:245] op_sel_hi:[1,0,1]
    v_pk_fma_f32 v[246:247], v[30:31], v[52:53], v[246:247] op_sel_hi:[1,0,1]
    v_permlane32_swap_b32 v208, v210
    v_permlane32_swap_b32 v209, v211
    buffer_store_dwordx4 v[208:211], v5, s[44:47], s4 offen offset:512 sc1
    v_pk_fma_f32 v[144:145], v[144:145], v[50:51], v[48:49] op_sel:[0,0,1] op_sel_hi:[1,0,1]
    v_pk_fma_f32 v[146:147], v[146:147], v[50:51], v[48:49] op_sel:[0,0,1] op_sel_hi:[1,0,1]
    v_pk_fma_f32 v[148:149], v[148:149], v[54:55], v[52:53] op_sel:[0,0,1] op_sel_hi:[1,0,1]
    v_pk_fma_f32 v[150:151], v[150:151], v[54:55], v[52:53] op_sel:[0,0,1] op_sel_hi:[1,0,1]
    v_pk_mul_f32 v[0:1], v[144:145], v[146:147]
    v_pk_mul_f32 v[2:3], v[148:149], v[150:151]
    v_pk_mul_f32 v[6:7], v[0:1], v[2:3]
    v_rcp_f32 v6, v6
    v_rcp_f32 v7, v7
    v_pk_mul_f32 v[240:241], v[240:241], v[146:147]
    v_pk_mul_f32 v[242:243], v[242:243], v[144:145]
    v_pk_mul_f32 v[244:245], v[244:245], v[150:151]
    v_pk_mul_f32 v[246:247], v[246:247], v[148:149]
    v_pk_mul_f32 v[2:3], v[2:3], v[6:7]
    v_pk_mul_f32 v[0:1], v[0:1], v[6:7]
    v_pk_mul_f32 v[144:145], v[240:241], v[2:3]
    v_pk_mul_f32 v[146:147], v[242:243], v[2:3]
    v_pk_mul_f32 v[148:149], v[244:245], v[0:1]
    v_pk_mul_f32 v[150:151], v[246:247], v[0:1]
    v_cvt_pk_bf16_f32 v240, v144, v145
    v_cvt_pk_bf16_f32 v241, v146, v147
    v_cvt_pk_bf16_f32 v242, v148, v149
    v_cvt_pk_bf16_f32 v243, v150, v151
    v_mul_f32 v58, 0x49800000, v57
    v_mul_f32 v62, 0x49800000, v61
    v_pk_fma_f32 v[88:89], v[8:9], v[56:57], v[88:89] op_sel_hi:[1,0,1]
    v_pk_fma_f32 v[90:91], v[10:11], v[56:57], v[90:91] op_sel_hi:[1,0,1]
    v_pk_fma_f32 v[88:89], v[88:89], v[58:59], s[54:55] op_sel:[0,1,0] op_sel_hi:[1,1,1]
    v_exp_f32_e64 v88, v88 clamp
    v_exp_f32_e64 v89, v89 clamp
    v_pk_fma_f32 v[90:91], v[90:91], v[58:59], s[54:55] op_sel:[0,1,0] op_sel_hi:[1,1,1]
    v_exp_f32_e64 v90, v90 clamp
    v_exp_f32_e64 v91, v91 clamp
    v_pk_fma_f32 v[184:185], v[20:21], v[56:57], v[184:185] op_sel_hi:[1,0,1]
    v_pk_fma_f32 v[186:187], v[22:23], v[56:57], v[186:187] op_sel_hi:[1,0,1]
    v_pk_fma_f32 v[92:93], v[8:9], v[60:61], v[92:93] op_sel_hi:[1,0,1]
    v_pk_fma_f32 v[94:95], v[10:11], v[60:61], v[94:95] op_sel_hi:[1,0,1]
    v_pk_fma_f32 v[92:93], v[92:93], v[62:63], s[54:55] op_sel:[0,1,0] op_sel_hi:[1,1,1]
    v_exp_f32_e64 v92, v92 clamp
    v_exp_f32_e64 v93, v93 clamp
    v_pk_fma_f32 v[94:95], v[94:95], v[62:63], s[54:55] op_sel:[0,1,0] op_sel_hi:[1,1,1]
    v_exp_f32_e64 v94, v94 clamp
    v_exp_f32_e64 v95, v95 clamp
    v_pk_fma_f32 v[188:189], v[20:21], v[60:61], v[188:189] op_sel_hi:[1,0,1]
    v_pk_fma_f32 v[190:191], v[22:23], v[60:61], v[190:191] op_sel_hi:[1,0,1]
    v_permlane32_swap_b32 v240, v242
    v_permlane32_swap_b32 v241, v243
    buffer_store_dwordx4 v[240:243], v5, s[44:47], s4 offen offset:1024 sc1
    s_add_u32 s4, s4, 110592
    v_pk_fma_f32 v[88:89], v[88:89], v[58:59], v[56:57] op_sel:[0,0,1] op_sel_hi:[1,0,1]
    v_pk_fma_f32 v[90:91], v[90:91], v[58:59], v[56:57] op_sel:[0,0,1] op_sel_hi:[1,0,1]
    v_pk_fma_f32 v[92:93], v[92:93], v[62:63], v[60:61] op_sel:[0,0,1] op_sel_hi:[1,0,1]
    v_pk_fma_f32 v[94:95], v[94:95], v[62:63], v[60:61] op_sel:[0,0,1] op_sel_hi:[1,0,1]
    v_pk_mul_f32 v[0:1], v[88:89], v[90:91]
    v_pk_mul_f32 v[2:3], v[92:93], v[94:95]
    v_pk_mul_f32 v[6:7], v[0:1], v[2:3]
    v_rcp_f32 v6, v6
    v_rcp_f32 v7, v7
    v_pk_mul_f32 v[184:185], v[184:185], v[90:91]
    v_pk_mul_f32 v[186:187], v[186:187], v[88:89]
    v_pk_mul_f32 v[188:189], v[188:189], v[94:95]
    v_pk_mul_f32 v[190:191], v[190:191], v[92:93]
    v_pk_mul_f32 v[2:3], v[2:3], v[6:7]
    v_pk_mul_f32 v[0:1], v[0:1], v[6:7]
    v_pk_mul_f32 v[88:89], v[184:185], v[2:3]
    v_pk_mul_f32 v[90:91], v[186:187], v[2:3]
    v_pk_mul_f32 v[92:93], v[188:189], v[0:1]
    v_pk_mul_f32 v[94:95], v[190:191], v[0:1]
    v_cvt_pk_bf16_f32 v184, v88, v89
    v_cvt_pk_bf16_f32 v185, v90, v91
    v_cvt_pk_bf16_f32 v186, v92, v93
    v_cvt_pk_bf16_f32 v187, v94, v95
    v_pk_fma_f32 v[120:121], v[12:13], v[56:57], v[120:121] op_sel_hi:[1,0,1]
    v_pk_fma_f32 v[122:123], v[14:15], v[56:57], v[122:123] op_sel_hi:[1,0,1]
    v_pk_fma_f32 v[120:121], v[120:121], v[58:59], s[54:55] op_sel:[0,1,0] op_sel_hi:[1,1,1]
    v_exp_f32_e64 v120, v120 clamp
    v_exp_f32_e64 v121, v121 clamp
    v_pk_fma_f32 v[122:123], v[122:123], v[58:59], s[54:55] op_sel:[0,1,0] op_sel_hi:[1,1,1]
    v_exp_f32_e64 v122, v122 clamp
    v_exp_f32_e64 v123, v123 clamp
    v_pk_fma_f32 v[216:217], v[24:25], v[56:57], v[216:217] op_sel_hi:[1,0,1]
    v_pk_fma_f32 v[218:219], v[26:27], v[56:57], v[218:219] op_sel_hi:[1,0,1]
    v_pk_fma_f32 v[124:125], v[12:13], v[60:61], v[124:125] op_sel_hi:[1,0,1]
    v_pk_fma_f32 v[126:127], v[14:15], v[60:61], v[126:127] op_sel_hi:[1,0,1]
    v_pk_fma_f32 v[124:125], v[124:125], v[62:63], s[54:55] op_sel:[0,1,0] op_sel_hi:[1,1,1]
    v_exp_f32_e64 v124, v124 clamp
    v_exp_f32_e64 v125, v125 clamp
    v_pk_fma_f32 v[126:127], v[126:127], v[62:63], s[54:55] op_sel:[0,1,0] op_sel_hi:[1,1,1]
    v_exp_f32_e64 v126, v126 clamp
    v_exp_f32_e64 v127, v127 clamp
    v_pk_fma_f32 v[220:221], v[24:25], v[60:61], v[220:221] op_sel_hi:[1,0,1]
    v_pk_fma_f32 v[222:223], v[26:27], v[60:61], v[222:223] op_sel_hi:[1,0,1]
    v_permlane32_swap_b32 v184, v186
    v_permlane32_swap_b32 v185, v187
    buffer_store_dwordx4 v[184:187], v5, s[44:47], s4 offen offset:0 sc1
    v_pk_fma_f32 v[120:121], v[120:121], v[58:59], v[56:57] op_sel:[0,0,1] op_sel_hi:[1,0,1]
    v_pk_fma_f32 v[122:123], v[122:123], v[58:59], v[56:57] op_sel:[0,0,1] op_sel_hi:[1,0,1]
    v_pk_fma_f32 v[124:125], v[124:125], v[62:63], v[60:61] op_sel:[0,0,1] op_sel_hi:[1,0,1]
    v_pk_fma_f32 v[126:127], v[126:127], v[62:63], v[60:61] op_sel:[0,0,1] op_sel_hi:[1,0,1]
    v_pk_mul_f32 v[0:1], v[120:121], v[122:123]
    v_pk_mul_f32 v[2:3], v[124:125], v[126:127]
    v_pk_mul_f32 v[6:7], v[0:1], v[2:3]
    v_rcp_f32 v6, v6
    v_rcp_f32 v7, v7
    v_pk_mul_f32 v[216:217], v[216:217], v[122:123]
    v_pk_mul_f32 v[218:219], v[218:219], v[120:121]
    v_pk_mul_f32 v[220:221], v[220:221], v[126:127]
    v_pk_mul_f32 v[222:223], v[222:223], v[124:125]
    v_pk_mul_f32 v[2:3], v[2:3], v[6:7]
    v_pk_mul_f32 v[0:1], v[0:1], v[6:7]
    v_pk_mul_f32 v[120:121], v[216:217], v[2:3]
    v_pk_mul_f32 v[122:123], v[218:219], v[2:3]
    v_pk_mul_f32 v[124:125], v[220:221], v[0:1]
    v_pk_mul_f32 v[126:127], v[222:223], v[0:1]
    v_cvt_pk_bf16_f32 v216, v120, v121
    v_cvt_pk_bf16_f32 v217, v122, v123
    v_cvt_pk_bf16_f32 v218, v124, v125
    v_cvt_pk_bf16_f32 v219, v126, v127
    v_pk_fma_f32 v[152:153], v[16:17], v[56:57], v[152:153] op_sel_hi:[1,0,1]
    v_pk_fma_f32 v[154:155], v[18:19], v[56:57], v[154:155] op_sel_hi:[1,0,1]
    v_pk_fma_f32 v[152:153], v[152:153], v[58:59], s[54:55] op_sel:[0,1,0] op_sel_hi:[1,1,1]
    v_exp_f32_e64 v152, v152 clamp
    v_exp_f32_e64 v153, v153 clamp
    v_pk_fma_f32 v[154:155], v[154:155], v[58:59], s[54:55] op_sel:[0,1,0] op_sel_hi:[1,1,1]
    v_exp_f32_e64 v154, v154 clamp
    v_exp_f32_e64 v155, v155 clamp
    v_pk_fma_f32 v[248:249], v[28:29], v[56:57], v[248:249] op_sel_hi:[1,0,1]
    v_pk_fma_f32 v[250:251], v[30:31], v[56:57], v[250:251] op_sel_hi:[1,0,1]
    v_pk_fma_f32 v[156:157], v[16:17], v[60:61], v[156:157] op_sel_hi:[1,0,1]
    v_pk_fma_f32 v[158:159], v[18:19], v[60:61], v[158:159] op_sel_hi:[1,0,1]
    v_pk_fma_f32 v[156:157], v[156:157], v[62:63], s[54:55] op_sel:[0,1,0] op_sel_hi:[1,1,1]
    v_exp_f32_e64 v156, v156 clamp
    v_exp_f32_e64 v157, v157 clamp
    v_pk_fma_f32 v[158:159], v[158:159], v[62:63], s[54:55] op_sel:[0,1,0] op_sel_hi:[1,1,1]
    v_exp_f32_e64 v158, v158 clamp
    v_exp_f32_e64 v159, v159 clamp
    v_pk_fma_f32 v[252:253], v[28:29], v[60:61], v[252:253] op_sel_hi:[1,0,1]
    v_pk_fma_f32 v[254:255], v[30:31], v[60:61], v[254:255] op_sel_hi:[1,0,1]
    v_permlane32_swap_b32 v216, v218
    v_permlane32_swap_b32 v217, v219
    buffer_store_dwordx4 v[216:219], v5, s[44:47], s4 offen offset:512 sc1
    v_pk_fma_f32 v[152:153], v[152:153], v[58:59], v[56:57] op_sel:[0,0,1] op_sel_hi:[1,0,1]
    v_pk_fma_f32 v[154:155], v[154:155], v[58:59], v[56:57] op_sel:[0,0,1] op_sel_hi:[1,0,1]
    v_pk_fma_f32 v[156:157], v[156:157], v[62:63], v[60:61] op_sel:[0,0,1] op_sel_hi:[1,0,1]
    v_pk_fma_f32 v[158:159], v[158:159], v[62:63], v[60:61] op_sel:[0,0,1] op_sel_hi:[1,0,1]
    v_pk_mul_f32 v[0:1], v[152:153], v[154:155]
    v_pk_mul_f32 v[2:3], v[156:157], v[158:159]
    v_pk_mul_f32 v[6:7], v[0:1], v[2:3]
    v_rcp_f32 v6, v6
    v_rcp_f32 v7, v7
    v_pk_mul_f32 v[248:249], v[248:249], v[154:155]
    v_pk_mul_f32 v[250:251], v[250:251], v[152:153]
    v_pk_mul_f32 v[252:253], v[252:253], v[158:159]
    v_pk_mul_f32 v[254:255], v[254:255], v[156:157]
    v_pk_mul_f32 v[2:3], v[2:3], v[6:7]
    v_pk_mul_f32 v[0:1], v[0:1], v[6:7]
    v_pk_mul_f32 v[152:153], v[248:249], v[2:3]
    v_pk_mul_f32 v[154:155], v[250:251], v[2:3]
    v_pk_mul_f32 v[156:157], v[252:253], v[0:1]
    v_pk_mul_f32 v[158:159], v[254:255], v[0:1]
    v_cvt_pk_bf16_f32 v248, v152, v153
    v_cvt_pk_bf16_f32 v249, v154, v155
    v_cvt_pk_bf16_f32 v250, v156, v157
    v_cvt_pk_bf16_f32 v251, v158, v159
    s_nop 1
    v_permlane32_swap_b32 v248, v250
    v_permlane32_swap_b32 v249, v251
    buffer_store_dwordx4 v[248:251], v5, s[44:47], s4 offen offset:1024 sc1
    s_branch g1_done
g1_cq:
    s_mul_i32 s4, s12, 80
    v_mul_u32_u24 v30, 20, v5
    v_add_u32 v40, s4, v30
    v_add_u32 v41, 4, v40
    v_add_u32 v42, 8, v40
    v_add_u32 v43, 12, v40
    v_add_u32 v44, 16, v40
    v_mov_b32 v45, v40
    v_lshlrev_b32 v30, 9, v4
    v_lshrrev_b32 v31, 2, v3
    v_lshl_add_u32 v30, v31, 6, v30
    v_add_u32 v30, 98304, v30
    v_lshrrev_b32 v31, 5, v40
    v_lshl_add_u32 v31, v31, 11, v30
    v_lshrrev_b32 v32, 4, v40
    v_xor_b32 v32, v32, v4
    v_and_b32 v32, 1, v32
    v_lshl_add_u32 v31, v32, 5, v31
    v_bfe_u32 v32, v40, 2, 2
    v_lshl_add_u32 v40, v32, 3, v31
    v_lshrrev_b32 v31, 5, v41
    v_lshl_add_u32 v31, v31, 11, v30
    v_lshrrev_b32 v32, 4, v41
    v_xor_b32 v32, v32, v4
    v_and_b32 v32, 1, v32
    v_lshl_add_u32 v31, v32, 5, v31
    v_bfe_u32 v32, v41, 2, 2
    v_lshl_add_u32 v41, v32, 3, v31
    v_lshrrev_b32 v31, 5, v42
    v_lshl_add_u32 v31, v31, 11, v30
    v_lshrrev_b32 v32, 4, v42
    v_xor_b32 v32, v32, v4
    v_and_b32 v32, 1, v32
    v_lshl_add_u32 v31, v32, 5, v31
    v_bfe_u32 v32, v42, 2, 2
    v_lshl_add_u32 v42, v32, 3, v31
    v_lshrrev_b32 v31, 5, v43
    v_lshl_add_u32 v31, v31, 11, v30
    v_lshrrev_b32 v32, 4, v43
    v_xor_b32 v32, v32, v4
    v_and_b32 v32, 1, v32
    v_lshl_add_u32 v31, v32, 5, v31
    v_bfe_u32 v32, v43, 2, 2
    v_lshl_add_u32 v43, v32, 3, v31
    v_lshrrev_b32 v31, 5, v44
    v_lshl_add_u32 v31, v31, 11, v30
    v_lshrrev_b32 v32, 4, v44
    v_xor_b32 v32, v32, v4
    v_and_b32 v32, 1, v32
    v_lshl_add_u32 v31, v32, 5, v31
    v_bfe_u32 v32, v44, 2, 2
    v_lshl_add_u32 v44, v32, 3, v31
    s_lshl_b32 s4, s11, 14
    v_and_b32 v30, 7, v3
    v_xor_b32 v31, v30, v4
    v_lshlrev_b32 v31, 4, v31
    v_lshl_add_u32 v31, v30, 7, v31
    v_lshrrev_b32 v30, 3, v3
    v_lshl_add_u32 v31, v30, 10, v31
    v_add_u32 v46, s4, v31
    v_xor_b32 v47, 64, v46
    v_mov_b32 v64, 0
    v_mov_b32 v65, 0
    v_mov_b32 v66, 0
    v_mov_b32 v67, 0
    v_mov_b32 v68, 0
    v_mov_b32 v69, 0
    v_mov_b32 v70, 0
    v_mov_b32 v71, 0
    v_mov_b32 v72, 0
    v_mov_b32 v73, 0
    v_mov_b32 v74, 0
    v_mov_b32 v75, 0
    v_mov_b32 v76, 0
    v_mov_b32 v77, 0
    v_mov_b32 v78, 0
    v_mov_b32 v79, 0
    v_mov_b32 v80, 0
    v_mov_b32 v81, 0
    v_mov_b32 v82, 0
    v_mov_b32 v83, 0
    v_mov_b32 v84, 0
    v_mov_b32 v85, 0
    v_mov_b32 v86, 0
    v_mov_b32 v87, 0
    v_mov_b32 v88, 0
    v_mov_b32 v89, 0
    v_mov_b32 v90, 0
    v_mov_b32 v91, 0
    v_mov_b32 v92, 0
    v_mov_b32 v93, 0
    v_mov_b32 v94, 0
    v_mov_b32 v95, 0
    v_mov_b32 v96, 0
    v_mov_b32 v97, 0
    v_mov_b32 v98, 0
    v_mov_b32 v99, 0
    v_mov_b32 v100, 0
    v_mov_b32 v101, 0
    v_mov_b32 v102, 0
    v_mov_b32 v103, 0
    v_mov_b32 v104, 0
    v_mov_b32 v105, 0
    v_mov_b32 v106, 0
    v_mov_b32 v107, 0
    v_mov_b32 v108, 0
    v_mov_b32 v109, 0
    v_mov_b32 v110, 0
    v_mov_b32 v111, 0
    v_mov_b32 v112, 0
    v_mov_b32 v113, 0
    v_mov_b32 v114, 0
    v_mov_b32 v115, 0
    v_mov_b32 v116, 0
    v_mov_b32 v117, 0
    v_mov_b32 v118, 0
    v_mov_b32 v119, 0
    v_mov_b32 v120, 0
    v_mov_b32 v121, 0
    v_mov_b32 v122, 0
    v_mov_b32 v123, 0
    v_mov_b32 v124, 0
    v_mov_b32 v125, 0
    v_mov_b32 v126, 0
    v_mov_b32 v127, 0
    v_mov_b32 v128, 0
    v_mov_b32 v129, 0
    v_mov_b32 v130, 0
    v_mov_b32 v131, 0
    v_mov_b32 v132, 0
    v_mov_b32 v133, 0
    v_mov_b32 v134, 0
    v_mov_b32 v135, 0
    v_mov_b32 v136, 0
    v_mov_b32 v137, 0
    v_mov_b32 v138, 0
    v_mov_b32 v139, 0
    v_mov_b32 v140, 0
    v_mov_b32 v141, 0
    v_mov_b32 v142, 0
    v_mov_b32 v143, 0
    v_mov_b32 v144, 0
    v_mov_b32 v145, 0
    v_mov_b32 v146, 0
    v_mov_b32 v147, 0
    v_mov_b32 v148, 0
    v_mov_b32 v149, 0
    v_mov_b32 v150, 0
    v_mov_b32 v151, 0
    v_mov_b32 v152, 0
    v_mov_b32 v153, 0
    v_mov_b32 v154, 0
    v_mov_b32 v155, 0
    v_mov_b32 v156, 0
    v_mov_b32 v157, 0
    v_mov_b32 v158, 0
    v_mov_b32 v159, 0
    v_mov_b32 v160, 0
    v_mov_b32 v161, 0
    v_mov_b32 v162, 0
    v_mov_b32 v163, 0
    v_mov_b32 v164, 0
    v_mov_b32 v165, 0
    v_mov_b32 v166, 0
    v_mov_b32 v167, 0
    v_mov_b32 v168, 0
    v_mov_b32 v169, 0
    v_mov_b32 v170, 0
    v_mov_b32 v171, 0
    v_mov_b32 v172, 0
    v_mov_b32 v173, 0
    v_mov_b32 v174, 0
    v_mov_b32 v175, 0
    v_mov_b32 v176, 0
    v_mov_b32 v177, 0
    v_mov_b32 v178, 0
    v_mov_b32 v179, 0
    v_mov_b32 v180, 0
    v_mov_b32 v181, 0
    v_mov_b32 v182, 0
    v_mov_b32 v183, 0
    v_mov_b32 v184, 0
    v_mov_b32 v185, 0
    v_mov_b32 v186, 0
    v_mov_b32 v187, 0
    v_mov_b32 v188, 0
    v_mov_b32 v189, 0
    v_mov_b32 v190, 0
    v_mov_b32 v191, 0
    v_mov_b32 v192, 0
    v_mov_b32 v193, 0
    v_mov_b32 v194, 0
    v_mov_b32 v195, 0
    v_mov_b32 v196, 0
    v_mov_b32 v197, 0
    v_mov_b32 v198, 0
    v_mov_b32 v199, 0
    v_mov_b32 v200, 0
    v_mov_b32 v201, 0
    v_mov_b32 v202, 0
    v_mov_b32 v203, 0
    v_mov_b32 v204, 0
    v_mov_b32 v205, 0
    v_mov_b32 v206, 0
    v_mov_b32 v207, 0
    v_mov_b32 v208, 0
    v_mov_b32 v209, 0
    v_mov_b32 v210, 0
    v_mov_b32 v211, 0
    v_mov_b32 v212, 0
    v_mov_b32 v213, 0
    v_mov_b32 v214, 0
    v_mov_b32 v215, 0
    v_mov_b32 v216, 0
    v_mov_b32 v217, 0
    v_mov_b32 v218, 0
    v_mov_b32 v219, 0
    v_mov_b32 v220, 0
    v_mov_b32 v221, 0
    v_mov_b32 v222, 0
    v_mov_b32 v223, 0
    s_mov_b32 s62, 12288
    s_mov_b32 s63, 4294918144
    s_mov_b32 s64, 32768
    s_mov_b32 s65, 4294901760
    s_mov_b32 s60, 0
    s_mov_b32 s59, 0
    s_mov_b32 s61, 12288
    s_mov_b32 s66, 32768
    s_mov_b32 s67, 10
    v_mov_b32 v0, v40
    v_mov_b32 v1, v41
    v_mov_b32 v2, v42
    v_mov_b32 v3, v43
    v_mov_b32 v4, v44
    v_mov_b32 v6, v46
    v_mov_b32 v7, v47
    .p2alignl 5, 0xbf800000
    s_branch g1_q_ov
g1_q_sk0:
    ds_append v8 offset:61324
    s_branch g1_q_bk0
g1_q_sk1:
    ds_append v8 offset:61324
    s_branch g1_q_bk1
g1_q_ov:
    s_barrier
    s_mov_b32 m0, 0
    ds_read_b64_tr_b16 v[8:9], v0
    ds_read_b64_tr_b16 v[10:11], v0 offset:256
    ds_read_b64_tr_b16 v[12:13], v1
    ds_read_b64_tr_b16 v[14:15], v1 offset:256
    ds_read_b64_tr_b16 v[16:17], v2
    ds_read_b64_tr_b16 v[18:19], v2 offset:256
    ds_read_b128 v[32:35], v6 offset:0
    ds_read_b128 v[36:39], v6 offset:2048
    ds_read_b128 v[40:43], v6 offset:4096
    ds_read_b128 v[44:47], v6 offset:6144
    ds_read_b128 v[48:51], v6 offset:8192
    ds_read_b128 v[52:55], v6 offset:10240
    ds_read_b128 v[56:59], v6 offset:12288
    ds_read_b128 v[60:63], v6 offset:14336
    v_add_u32 v0, s61, v0
    v_add_u32 v1, s61, v1
    v_add_u32 v2, s61, v2
    v_add_u32 v6, s66, v6
g1_q_loop:
    s_waitcnt lgkmcnt(5)
    v_mfma_f32_16x16x32_bf16 v[64:67], v[8:11], v[32:35], v[64:67]
    ds_read_b64_tr_b16 v[20:21], v3
    v_mfma_f32_16x16x32_bf16 v[96:99], v[12:15], v[32:35], v[96:99]
    ds_read_b64_tr_b16 v[22:23], v3 offset:256
    v_mfma_f32_16x16x32_bf16 v[128:131], v[16:19], v[32:35], v[128:131]
    ds_read_b64_tr_b16 v[24:25], v4
    v_mfma_f32_16x16x32_bf16 v[68:71], v[8:11], v[36:39], v[68:71]
    ds_read_b64_tr_b16 v[26:27], v4 offset:256
    v_mfma_f32_16x16x32_bf16 v[100:103], v[12:15], v[36:39], v[100:103]
    v_mfma_f32_16x16x32_bf16 v[132:135], v[16:19], v[36:39], v[132:135]
    v_mfma_f32_16x16x32_bf16 v[72:75], v[8:11], v[40:43], v[72:75]
    v_mfma_f32_16x16x32_bf16 v[104:107], v[12:15], v[40:43], v[104:107]
    v_mfma_f32_16x16x32_bf16 v[136:139], v[16:19], v[40:43], v[136:139]
    s_waitcnt lgkmcnt(6)
    v_mfma_f32_16x16x32_bf16 v[76:79], v[8:11], v[44:47], v[76:79]
    v_mfma_f32_16x16x32_bf16 v[108:111], v[12:15], v[44:47], v[108:111]
    v_mfma_f32_16x16x32_bf16 v[140:143], v[16:19], v[44:47], v[140:143]
    v_mfma_f32_16x16x32_bf16 v[80:83], v[8:11], v[48:51], v[80:83]
    v_add_u32 v3, s61, v3
    v_mfma_f32_16x16x32_bf16 v[112:115], v[12:15], v[48:51], v[112:115]
    v_add_u32 v4, s61, v4
    v_mfma_f32_16x16x32_bf16 v[144:147], v[16:19], v[48:51], v[144:147]
    v_mfma_f32_16x16x32_bf16 v[84:87], v[8:11], v[52:55], v[84:87]
    v_mfma_f32_16x16x32_bf16 v[116:119], v[12:15], v[52:55], v[116:119]
    v_mfma_f32_16x16x32_bf16 v[148:151], v[16:19], v[52:55], v[148:151]
    s_waitcnt lgkmcnt(0)
    v_mfma_f32_16x16x32_bf16 v[88:91], v[8:11], v[56:59], v[88:91]
    s_add_u32 s60, s60, 1
    s_cmp_eq_u32 s60, 4
    v_mfma_f32_16x16x32_bf16 v[120:123], v[12:15], v[56:59], v[120:123]
    s_cselect_b32 s61, s63, s62
    s_cselect_b32 s60, -1, s60
    v_mfma_f32_16x16x32_bf16 v[152:155], v[16:19], v[56:59], v[152:155]
    v_mfma_f32_16x16x32_bf16 v[92:95], v[8:11], v[60:63], v[92:95]
    v_mfma_f32_16x16x32_bf16 v[124:127], v[12:15], v[60:63], v[124:127]
    s_cmp_le_u32 s67, 1
    v_mfma_f32_16x16x32_bf16 v[156:159], v[16:19], v[60:63], v[156:159]
    s_cbranch_scc1 g1_q_sk0
    s_barrier
g1_q_bk0:
    v_mfma_f32_16x16x32_bf16 v[160:163], v[20:23], v[32:35], v[160:163]
    ds_read_b64_tr_b16 v[8:9], v0
    ds_read_b64_tr_b16 v[10:11], v0 offset:256
    v_mfma_f32_16x16x32_bf16 v[192:195], v[24:27], v[32:35], v[192:195]
    ds_read_b128 v[32:35], v7 offset:0
    v_mfma_f32_16x16x32_bf16 v[164:167], v[20:23], v[36:39], v[164:167]
    ds_read_b64_tr_b16 v[12:13], v1
    ds_read_b64_tr_b16 v[14:15], v1 offset:256
    v_mfma_f32_16x16x32_bf16 v[196:199], v[24:27], v[36:39], v[196:199]
    ds_read_b128 v[36:39], v7 offset:2048
    v_mfma_f32_16x16x32_bf16 v[168:171], v[20:23], v[40:43], v[168:171]
    ds_read_b64_tr_b16 v[16:17], v2
    ds_read_b64_tr_b16 v[18:19], v2 offset:256
    v_mfma_f32_16x16x32_bf16 v[200:203], v[24:27], v[40:43], v[200:203]
    ds_read_b128 v[40:43], v7 offset:4096
    v_mfma_f32_16x16x32_bf16 v[172:175], v[20:23], v[44:47], v[172:175]
    v_add_u32 v0, s61, v0
    v_mfma_f32_16x16x32_bf16 v[204:207], v[24:27], v[44:47], v[204:207]
    ds_read_b128 v[44:47], v7 offset:6144
    v_mfma_f32_16x16x32_bf16 v[176:179], v[20:23], v[48:51], v[176:179]
    v_add_u32 v1, s61, v1
    v_mfma_f32_16x16x32_bf16 v[208:211], v[24:27], v[48:51], v[208:211]
    ds_read_b128 v[48:51], v7 offset:8192
    v_mfma_f32_16x16x32_bf16 v[180:183], v[20:23], v[52:55], v[180:183]
    v_add_u32 v2, s61, v2
    v_mfma_f32_16x16x32_bf16 v[212:215], v[24:27], v[52:55], v[212:215]
    ds_read_b128 v[52:55], v7 offset:10240
    v_mfma_f32_16x16x32_bf16 v[184:187], v[20:23], v[56:59], v[184:187]
    v_mfma_f32_16x16x32_bf16 v[216:219], v[24:27], v[56:59], v[216:219]
    ds_read_b128 v[56:59], v7 offset:12288
    v_mfma_f32_16x16x32_bf16 v[188:191], v[20:23], v[60:63], v[188:191]
    v_mfma_f32_16x16x32_bf16 v[220:223], v[24:27], v[60:63], v[220:223]
    ds_read_b128 v[60:63], v7 offset:14336
    v_add_u32 v7, s66, v7
    s_waitcnt lgkmcnt(5)
    v_mfma_f32_16x16x32_bf16 v[64:67], v[8:11], v[32:35], v[64:67]
    ds_read_b64_tr_b16 v[20:21], v3
    v_mfma_f32_16x16x32_bf16 v[96:99], v[12:15], v[32:35], v[96:99]
    ds_read_b64_tr_b16 v[22:23], v3 offset:256
    v_mfma_f32_16x16x32_bf16 v[128:131], v[16:19], v[32:35], v[128:131]
    ds_read_b64_tr_b16 v[24:25], v4
    v_mfma_f32_16x16x32_bf16 v[68:71], v[8:11], v[36:39], v[68:71]
    ds_read_b64_tr_b16 v[26:27], v4 offset:256
    v_mfma_f32_16x16x32_bf16 v[100:103], v[12:15], v[36:39], v[100:103]
    v_mfma_f32_16x16x32_bf16 v[132:135], v[16:19], v[36:39], v[132:135]
    v_mfma_f32_16x16x32_bf16 v[72:75], v[8:11], v[40:43], v[72:75]
    v_mfma_f32_16x16x32_bf16 v[104:107], v[12:15], v[40:43], v[104:107]
    v_mfma_f32_16x16x32_bf16 v[136:139], v[16:19], v[40:43], v[136:139]
    s_waitcnt lgkmcnt(6)
    v_mfma_f32_16x16x32_bf16 v[76:79], v[8:11], v[44:47], v[76:79]
    v_mfma_f32_16x16x32_bf16 v[108:111], v[12:15], v[44:47], v[108:111]
    v_mfma_f32_16x16x32_bf16 v[140:143], v[16:19], v[44:47], v[140:143]
    v_mfma_f32_16x16x32_bf16 v[80:83], v[8:11], v[48:51], v[80:83]
    v_add_u32 v3, s61, v3
    v_mfma_f32_16x16x32_bf16 v[112:115], v[12:15], v[48:51], v[112:115]
    v_add_u32 v4, s61, v4
    v_mfma_f32_16x16x32_bf16 v[144:147], v[16:19], v[48:51], v[144:147]
    v_mfma_f32_16x16x32_bf16 v[84:87], v[8:11], v[52:55], v[84:87]
    v_mfma_f32_16x16x32_bf16 v[116:119], v[12:15], v[52:55], v[116:119]
    v_mfma_f32_16x16x32_bf16 v[148:151], v[16:19], v[52:55], v[148:151]
    s_waitcnt lgkmcnt(0)
    v_mfma_f32_16x16x32_bf16 v[88:91], v[8:11], v[56:59], v[88:91]
    s_add_u32 s60, s60, 1
    s_cmp_eq_u32 s60, 4
    v_mfma_f32_16x16x32_bf16 v[120:123], v[12:15], v[56:59], v[120:123]
    s_cselect_b32 s61, s63, s62
    s_cselect_b32 s60, -1, s60
    v_mfma_f32_16x16x32_bf16 v[152:155], v[16:19], v[56:59], v[152:155]
    s_add_u32 s59, s59, 1
    s_cmp_eq_u32 s59, 2
    v_mfma_f32_16x16x32_bf16 v[92:95], v[8:11], v[60:63], v[92:95]
    s_cselect_b32 s66, s65, s64
    s_cselect_b32 s59, -1, s59
    s_waitcnt vmcnt(0)
    v_mfma_f32_16x16x32_bf16 v[124:127], v[12:15], v[60:63], v[124:127]
    s_cmp_le_u32 s67, 2
    v_mfma_f32_16x16x32_bf16 v[156:159], v[16:19], v[60:63], v[156:159]
    s_cbranch_scc1 g1_q_sk1
    s_barrier
g1_q_bk1:
    v_mfma_f32_16x16x32_bf16 v[160:163], v[20:23], v[32:35], v[160:163]
    ds_read_b64_tr_b16 v[8:9], v0
    ds_read_b64_tr_b16 v[10:11], v0 offset:256
    v_mfma_f32_16x16x32_bf16 v[192:195], v[24:27], v[32:35], v[192:195]
    ds_read_b128 v[32:35], v6 offset:0
    v_mfma_f32_16x16x32_bf16 v[164:167], v[20:23], v[36:39], v[164:167]
    ds_read_b64_tr_b16 v[12:13], v1
    ds_read_b64_tr_b16 v[14:15], v1 offset:256
    v_mfma_f32_16x16x32_bf16 v[196:199], v[24:27], v[36:39], v[196:199]
    ds_read_b128 v[36:39], v6 offset:2048
    v_mfma_f32_16x16x32_bf16 v[168:171], v[20:23], v[40:43], v[168:171]
    ds_read_b64_tr_b16 v[16:17], v2
    ds_read_b64_tr_b16 v[18:19], v2 offset:256
    v_mfma_f32_16x16x32_bf16 v[200:203], v[24:27], v[40:43], v[200:203]
    ds_read_b128 v[40:43], v6 offset:4096
    v_mfma_f32_16x16x32_bf16 v[172:175], v[20:23], v[44:47], v[172:175]
    v_add_u32 v0, s61, v0
    v_mfma_f32_16x16x32_bf16 v[204:207], v[24:27], v[44:47], v[204:207]
    ds_read_b128 v[44:47], v6 offset:6144
    v_mfma_f32_16x16x32_bf16 v[176:179], v[20:23], v[48:51], v[176:179]
    v_add_u32 v1, s61, v1
    v_mfma_f32_16x16x32_bf16 v[208:211], v[24:27], v[48:51], v[208:211]
    ds_read_b128 v[48:51], v6 offset:8192
    v_mfma_f32_16x16x32_bf16 v[180:183], v[20:23], v[52:55], v[180:183]
    v_add_u32 v2, s61, v2
    v_mfma_f32_16x16x32_bf16 v[212:215], v[24:27], v[52:55], v[212:215]
    ds_read_b128 v[52:55], v6 offset:10240
    v_mfma_f32_16x16x32_bf16 v[184:187], v[20:23], v[56:59], v[184:187]
    s_sub_u32 s67, s67, 1
    v_mfma_f32_16x16x32_bf16 v[216:219], v[24:27], v[56:59], v[216:219]
    ds_read_b128 v[56:59], v6 offset:12288
    v_mfma_f32_16x16x32_bf16 v[188:191], v[20:23], v[60:63], v[188:191]
    s_cmp_lg_u32 s67, 0
    v_mfma_f32_16x16x32_bf16 v[220:223], v[24:27], v[60:63], v[220:223]
    ds_read_b128 v[60:63], v6 offset:14336
    v_add_u32 v6, s66, v6
    s_cbranch_scc1 g1_q_loop
    v_mov_b32 v0, 61312
g1_q_ep:
    v_mbcnt_lo_u32_b32 v2, -1, 0
    v_mbcnt_hi_u32_b32 v2, -1, v2
    s_waitcnt lgkmcnt(0) vmcnt(0)
    ds_read_b32 v1, v0 offset:100
    v_and_b32 v3, 15, v2
    v_lshrrev_b32 v4, 4, v2
    s_mul_i32 s4, s12, 384
    s_add_u32 s4, s4, 56064
    s_mov_b32 s52, 1.0
    s_mov_b32 s53, 1.0
    s_mov_b32 s89, 1
    s_mov_b32 s50, 0x358637bd
    v_lshl_add_u32 v5, v4, 4, s4
    s_lshl_b32 s4, s11, 11
    s_add_u32 s4, s4, 40960
    v_lshl_add_u32 v6, v3, 4, s4
    ds_read_b128 v[8:11], v5 offset:0
    ds_read_b128 v[12:15], v5 offset:64
    ds_read_b128 v[16:19], v5 offset:128
    ds_read_b128 v[20:23], v5 offset:192
    ds_read_b128 v[24:27], v5 offset:256
    ds_read_b128 v[28:31], v5 offset:320
    ds_read_b128 v[32:35], v6 offset:0
    ds_read_b128 v[36:39], v6 offset:256
    ds_read_b128 v[40:43], v6 offset:512
    ds_read_b128 v[44:47], v6 offset:768
    ds_read_b128 v[48:51], v6 offset:1024
    ds_read_b128 v[52:55], v6 offset:1280
    ds_read_b128 v[56:59], v6 offset:1536
    ds_read_b128 v[60:63], v6 offset:1792
    s_add_u32 s44, s34, 1064960
    s_addc_u32 s45, s35, 0
    s_and_b32 s45, s45, 0xffff
    s_mov_b32 s46, 3145728
    s_mov_b32 s47, 0x00020000
    v_lshlrev_b32 v5, 4, v2
    s_lshl_b32 s4, s6, 1
    s_add_u32 s4, s4, s11
    s_lshl_b32 s4, s4, 5
    s_sub_u32 s5, s7, 8
    s_lshl_b32 s5, s5, 1
    s_add_u32 s4, s4, s5
    s_add_u32 s4, s4, s12
    s_mul_i32 s4, s4, 5120
    s_add_u32 s5, s4, 4096
    s_waitcnt lgkmcnt(0)
    v_readfirstlane_b32 s58, v1
    s_cmp_lt_u32 s58, 4
    s_cbranch_scc1 g1_q_ep
    v_pk_fma_f32 v[64:65], v[8:9], v[32:33], v[64:65] op_sel_hi:[1,0,1]
    v_pk_fma_f32 v[66:67], v[10:11], v[32:33], v[66:67] op_sel_hi:[1,0,1]
    v_pk_mul_f32 v[0:1], v[64:65], v[34:35] op_sel:[0,1] op_sel_hi:[1,1]
    v_exp_f32 v0, v0 clamp
    v_exp_f32 v1, v1 clamp
    v_pk_fma_f32 v[64:65], v[64:65], v[34:35], s[52:53] op_sel_hi:[1,0,1]
    v_pk_mul_f32 v[2:3], v[66:67], v[34:35] op_sel:[0,1] op_sel_hi:[1,1]
    v_exp_f32 v2, v2 clamp
    v_exp_f32 v3, v3 clamp
    v_pk_fma_f32 v[66:67], v[66:67], v[34:35], s[52:53] op_sel_hi:[1,0,1]
    v_max3_f32 v64, v64, v0, s50
    v_max3_f32 v65, v65, v1, s50
    v_max3_f32 v66, v66, v2, s50
    v_max3_f32 v67, v67, v3, s50
    v_cvt_pk_bf16_f32 v64, v64, v65
    v_cvt_pk_bf16_f32 v65, v66, v67
    v_pk_fma_f32 v[96:97], v[12:13], v[32:33], v[96:97] op_sel_hi:[1,0,1]
    v_pk_fma_f32 v[98:99], v[14:15], v[32:33], v[98:99] op_sel_hi:[1,0,1]
    v_pk_mul_f32 v[0:1], v[96:97], v[34:35] op_sel:[0,1] op_sel_hi:[1,1]
    v_exp_f32 v0, v0 clamp
    v_exp_f32 v1, v1 clamp
    v_pk_fma_f32 v[96:97], v[96:97], v[34:35], s[52:53] op_sel_hi:[1,0,1]
    v_pk_mul_f32 v[2:3], v[98:99], v[34:35] op_sel:[0,1] op_sel_hi:[1,1]
    v_exp_f32 v2, v2 clamp
    v_exp_f32 v3, v3 clamp
    v_pk_fma_f32 v[98:99], v[98:99], v[34:35], s[52:53] op_sel_hi:[1,0,1]
    v_max3_f32 v96, v96, v0, s50
    v_max3_f32 v97, v97, v1, s50
    v_max3_f32 v98, v98, v2, s50
    v_max3_f32 v99, v99, v3, s50
    v_cvt_pk_bf16_f32 v66, v96, v97
    v_cvt_pk_bf16_f32 v67, v98, v99
    buffer_store_dwordx4 v[64:67], v5, s[44:47], s4 offen offset:0 sc1
    v_pk_fma_f32 v[128:129], v[16:17], v[32:33], v[128:129] op_sel_hi:[1,0,1]
    v_pk_fma_f32 v[130:131], v[18:19], v[32:33], v[130:131] op_sel_hi:[1,0,1]
    v_pk_mul_f32 v[0:1], v[128:129], v[34:35] op_sel:[0,1] op_sel_hi:[1,1]
    v_exp_f32 v0, v0 clamp
    v_exp_f32 v1, v1 clamp
    v_pk_fma_f32 v[128:129], v[128:129], v[34:35], s[52:53] op_sel_hi:[1,0,1]
    v_pk_mul_f32 v[2:3], v[130:131], v[34:35] op_sel:[0,1] op_sel_hi:[1,1]
    v_exp_f32 v2, v2 clamp
    v_exp_f32 v3, v3 clamp
    v_pk_fma_f32 v[130:131], v[130:131], v[34:35], s[52:53] op_sel_hi:[1,0,1]
    v_max3_f32 v128, v128, v0, s50
    v_max3_f32 v129, v129, v1, s50
    v_max3_f32 v130, v130, v2, s50
    v_max3_f32 v131, v131, v3, s50
    v_cvt_pk_bf16_f32 v128, v128, v129
    v_cvt_pk_bf16_f32 v129, v130, v131
    v_pk_fma_f32 v[160:161], v[20:21], v[32:33], v[160:161] op_sel_hi:[1,0,1]
    v_pk_fma_f32 v[162:163], v[22:23], v[32:33], v[162:163] op_sel_hi:[1,0,1]
    v_pk_mul_f32 v[0:1], v[160:161], v[34:35] op_sel:[0,1] op_sel_hi:[1,1]
    v_exp_f32 v0, v0 clamp
    v_exp_f32 v1, v1 clamp
    v_pk_fma_f32 v[160:161], v[160:161], v[34:35], s[52:53] op_sel_hi:[1,0,1]
    v_pk_mul_f32 v[2:3], v[162:163], v[34:35] op_sel:[0,1] op_sel_hi:[1,1]
    v_exp_f32 v2, v2 clamp
    v_exp_f32 v3, v3 clamp
    v_pk_fma_f32 v[162:163], v[162:163], v[34:35], s[52:53] op_sel_hi:[1,0,1]
    v_max3_f32 v160, v160, v0, s50
    v_max3_f32 v161, v161, v1, s50
    v_max3_f32 v162, v162, v2, s50
    v_max3_f32 v163, v163, v3, s50
    v_cvt_pk_bf16_f32 v130, v160, v161
    v_cvt_pk_bf16_f32 v131, v162, v163
    buffer_store_dwordx4 v[128:131], v5, s[44:47], s4 offen offset:1024 sc1
    v_pk_fma_f32 v[68:69], v[8:9], v[36:37], v[68:69] op_sel_hi:[1,0,1]
    v_pk_fma_f32 v[70:71], v[10:11], v[36:37], v[70:71] op_sel_hi:[1,0,1]
    v_pk_mul_f32 v[0:1], v[68:69], v[38:39] op_sel:[0,1] op_sel_hi:[1,1]
    v_exp_f32 v0, v0 clamp
    v_exp_f32 v1, v1 clamp
    v_pk_fma_f32 v[68:69], v[68:69], v[38:39], s[52:53] op_sel_hi:[1,0,1]
    v_pk_mul_f32 v[2:3], v[70:71], v[38:39] op_sel:[0,1] op_sel_hi:[1,1]
    v_exp_f32 v2, v2 clamp
    v_exp_f32 v3, v3 clamp
    v_pk_fma_f32 v[70:71], v[70:71], v[38:39], s[52:53] op_sel_hi:[1,0,1]
    v_max3_f32 v68, v68, v0, s50
    v_max3_f32 v69, v69, v1, s50
    v_max3_f32 v70, v70, v2, s50
    v_max3_f32 v71, v71, v3, s50
    v_cvt_pk_bf16_f32 v68, v68, v69
    v_cvt_pk_bf16_f32 v69, v70, v71
    v_pk_fma_f32 v[100:101], v[12:13], v[36:37], v[100:101] op_sel_hi:[1,0,1]
    v_pk_fma_f32 v[102:103], v[14:15], v[36:37], v[102:103] op_sel_hi:[1,0,1]
    v_pk_mul_f32 v[0:1], v[100:101], v[38:39] op_sel:[0,1] op_sel_hi:[1,1]
    v_exp_f32 v0, v0 clamp
    v_exp_f32 v1, v1 clamp
    v_pk_fma_f32 v[100:101], v[100:101], v[38:39], s[52:53] op_sel_hi:[1,0,1]
    v_pk_mul_f32 v[2:3], v[102:103], v[38:39] op_sel:[0,1] op_sel_hi:[1,1]
    v_exp_f32 v2, v2 clamp
    v_exp_f32 v3, v3 clamp
    v_pk_fma_f32 v[102:103], v[102:103], v[38:39], s[52:53] op_sel_hi:[1,0,1]
    v_max3_f32 v100, v100, v0, s50
    v_max3_f32 v101, v101, v1, s50
    v_max3_f32 v102, v102, v2, s50
    v_max3_f32 v103, v103, v3, s50
    v_cvt_pk_bf16_f32 v70, v100, v101
    v_cvt_pk_bf16_f32 v71, v102, v103
    buffer_store_dwordx4 v[68:71], v5, s[44:47], s4 offen offset:2048 sc1
    v_pk_fma_f32 v[132:133], v[16:17], v[36:37], v[132:133] op_sel_hi:[1,0,1]
    v_pk_fma_f32 v[134:135], v[18:19], v[36:37], v[134:135] op_sel_hi:[1,0,1]
    v_pk_mul_f32 v[0:1], v[132:133], v[38:39] op_sel:[0,1] op_sel_hi:[1,1]
    v_exp_f32 v0, v0 clamp
    v_exp_f32 v1, v1 clamp
    v_pk_fma_f32 v[132:133], v[132:133], v[38:39], s[52:53] op_sel_hi:[1,0,1]
    v_pk_mul_f32 v[2:3], v[134:135], v[38:39] op_sel:[0,1] op_sel_hi:[1,1]
    v_exp_f32 v2, v2 clamp
    v_exp_f32 v3, v3 clamp
    v_pk_fma_f32 v[134:135], v[134:135], v[38:39], s[52:53] op_sel_hi:[1,0,1]
    v_max3_f32 v132, v132, v0, s50
    v_max3_f32 v133, v133, v1, s50
    v_max3_f32 v134, v134, v2, s50
    v_max3_f32 v135, v135, v3, s50
    v_cvt_pk_bf16_f32 v132, v132, v133
    v_cvt_pk_bf16_f32 v133, v134, v135
    v_pk_fma_f32 v[164:165], v[20:21], v[36:37], v[164:165] op_sel_hi:[1,0,1]
    v_pk_fma_f32 v[166:167], v[22:23], v[36:37], v[166:167] op_sel_hi:[1,0,1]
    v_pk_mul_f32 v[0:1], v[164:165], v[38:39] op_sel:[0,1] op_sel_hi:[1,1]
    v_exp_f32 v0, v0 clamp
    v_exp_f32 v1, v1 clamp
    v_pk_fma_f32 v[164:165], v[164:165], v[38:39], s[52:53] op_sel_hi:[1,0,1]
    v_pk_mul_f32 v[2:3], v[166:167], v[38:39] op_sel:[0,1] op_sel_hi:[1,1]
    v_exp_f32 v2, v2 clamp
    v_exp_f32 v3, v3 clamp
    v_pk_fma_f32 v[166:167], v[166:167], v[38:39], s[52:53] op_sel_hi:[1,0,1]
    v_max3_f32 v164, v164, v0, s50
    v_max3_f32 v165, v165, v1, s50
    v_max3_f32 v166, v166, v2, s50
    v_max3_f32 v167, v167, v3, s50
    v_cvt_pk_bf16_f32 v134, v164, v165
    v_cvt_pk_bf16_f32 v135, v166, v167
    buffer_store_dwordx4 v[132:135], v5, s[44:47], s4 offen offset:3072 sc1
    v_pk_fma_f32 v[192:193], v[24:25], v[32:33], v[192:193] op_sel_hi:[1,0,1]
    v_pk_fma_f32 v[194:195], v[26:27], v[32:33], v[194:195] op_sel_hi:[1,0,1]
    v_pk_mul_f32 v[0:1], v[192:193], v[34:35] op_sel:[0,1] op_sel_hi:[1,1]
    v_exp_f32 v0, v0 clamp
    v_exp_f32 v1, v1 clamp
    v_pk_fma_f32 v[192:193], v[192:193], v[34:35], s[52:53] op_sel_hi:[1,0,1]
    v_pk_mul_f32 v[2:3], v[194:195], v[34:35] op_sel:[0,1] op_sel_hi:[1,1]
    v_exp_f32 v2, v2 clamp
    v_exp_f32 v3, v3 clamp
    v_pk_fma_f32 v[194:195], v[194:195], v[34:35], s[52:53] op_sel_hi:[1,0,1]
    v_max3_f32 v192, v192, v0, s50
    v_max3_f32 v193, v193, v1, s50
    v_max3_f32 v194, v194, v2, s50
    v_max3_f32 v195, v195, v3, s50
    v_cvt_pk_bf16_f32 v192, v192, v193
    v_cvt_pk_bf16_f32 v193, v194, v195
    v_pk_fma_f32 v[196:197], v[24:25], v[36:37], v[196:197] op_sel_hi:[1,0,1]
    v_pk_fma_f32 v[198:199], v[26:27], v[36:37], v[198:199] op_sel_hi:[1,0,1]
    v_pk_mul_f32 v[0:1], v[196:197], v[38:39] op_sel:[0,1] op_sel_hi:[1,1]
    v_exp_f32 v0, v0 clamp
    v_exp_f32 v1, v1 clamp
    v_pk_fma_f32 v[196:197], v[196:197], v[38:39], s[52:53] op_sel_hi:[1,0,1]
    v_pk_mul_f32 v[2:3], v[198:199], v[38:39] op_sel:[0,1] op_sel_hi:[1,1]
    v_exp_f32 v2, v2 clamp
    v_exp_f32 v3, v3 clamp
    v_pk_fma_f32 v[198:199], v[198:199], v[38:39], s[52:53] op_sel_hi:[1,0,1]
    v_max3_f32 v196, v196, v0, s50
    v_max3_f32 v197, v197, v1, s50
    v_max3_f32 v198, v198, v2, s50
    v_max3_f32 v199, v199, v3, s50
    v_cvt_pk_bf16_f32 v194, v196, v197
    v_cvt_pk_bf16_f32 v195, v198, v199
    buffer_store_dwordx4 v[192:195], v5, s[44:47], s5 offen sc1
    s_add_u32 s4, s4, 40960
    s_add_u32 s5, s5, 40960
    v_pk_fma_f32 v[72:73], v[8:9], v[40:41], v[72:73] op_sel_hi:[1,0,1]
    v_pk_fma_f32 v[74:75], v[10:11], v[40:41], v[74:75] op_sel_hi:[1,0,1]
    v_pk_mul_f32 v[0:1], v[72:73], v[42:43] op_sel:[0,1] op_sel_hi:[1,1]
    v_exp_f32 v0, v0 clamp
    v_exp_f32 v1, v1 clamp
    v_pk_fma_f32 v[72:73], v[72:73], v[42:43], s[52:53] op_sel_hi:[1,0,1]
    v_pk_mul_f32 v[2:3], v[74:75], v[42:43] op_sel:[0,1] op_sel_hi:[1,1]
    v_exp_f32 v2, v2 clamp
    v_exp_f32 v3, v3 clamp
    v_pk_fma_f32 v[74:75], v[74:75], v[42:43], s[52:53] op_sel_hi:[1,0,1]
    v_max3_f32 v72, v72, v0, s50
    v_max3_f32 v73, v73, v1, s50
    v_max3_f32 v74, v74, v2, s50
    v_max3_f32 v75, v75, v3, s50
    v_cvt_pk_bf16_f32 v72, v72, v73
    v_cvt_pk_bf16_f32 v73, v74, v75
    v_pk_fma_f32 v[104:105], v[12:13], v[40:41], v[104:105] op_sel_hi:[1,0,1]
    v_pk_fma_f32 v[106:107], v[14:15], v[40:41], v[106:107] op_sel_hi:[1,0,1]
    v_pk_mul_f32 v[0:1], v[104:105], v[42:43] op_sel:[0,1] op_sel_hi:[1,1]
    v_exp_f32 v0, v0 clamp
    v_exp_f32 v1, v1 clamp
    v_pk_fma_f32 v[104:105], v[104:105], v[42:43], s[52:53] op_sel_hi:[1,0,1]
    v_pk_mul_f32 v[2:3], v[106:107], v[42:43] op_sel:[0,1] op_sel_hi:[1,1]
    v_exp_f32 v2, v2 clamp
    v_exp_f32 v3, v3 clamp
    v_pk_fma_f32 v[106:107], v[106:107], v[42:43], s[52:53] op_sel_hi:[1,0,1]
    v_max3_f32 v104, v104, v0, s50
    v_max3_f32 v105, v105, v1, s50
    v_max3_f32 v106, v106, v2, s50
    v_max3_f32 v107, v107, v3, s50
    v_cvt_pk_bf16_f32 v74, v104, v105
    v_cvt_pk_bf16_f32 v75, v106, v107
    buffer_store_dwordx4 v[72:75], v5, s[44:47], s4 offen offset:0 sc1
    v_pk_fma_f32 v[136:137], v[16:17], v[40:41], v[136:137] op_sel_hi:[1,0,1]
    v_pk_fma_f32 v[138:139], v[18:19], v[40:41], v[138:139] op_sel_hi:[1,0,1]
    v_pk_mul_f32 v[0:1], v[136:137], v[42:43] op_sel:[0,1] op_sel_hi:[1,1]
    v_exp_f32 v0, v0 clamp
    v_exp_f32 v1, v1 clamp
    v_pk_fma_f32 v[136:137], v[136:137], v[42:43], s[52:53] op_sel_hi:[1,0,1]
    v_pk_mul_f32 v[2:3], v[138:139], v[42:43] op_sel:[0,1] op_sel_hi:[1,1]
    v_exp_f32 v2, v2 clamp
    v_exp_f32 v3, v3 clamp
    v_pk_fma_f32 v[138:139], v[138:139], v[42:43], s[52:53] op_sel_hi:[1,0,1]
    v_max3_f32 v136, v136, v0, s50
    v_max3_f32 v137, v137, v1, s50
    v_max3_f32 v138, v138, v2, s50
    v_max3_f32 v139, v139, v3, s50
    v_cvt_pk_bf16_f32 v136, v136, v137
    v_cvt_pk_bf16_f32 v137, v138, v139
    v_pk_fma_f32 v[168:169], v[20:21], v[40:41], v[168:169] op_sel_hi:[1,0,1]
    v_pk_fma_f32 v[170:171], v[22:23], v[40:41], v[170:171] op_sel_hi:[1,0,1]
    v_pk_mul_f32 v[0:1], v[168:169], v[42:43] op_sel:[0,1] op_sel_hi:[1,1]
    v_exp_f32 v0, v0 clamp
    v_exp_f32 v1, v1 clamp
    v_pk_fma_f32 v[168:169], v[168:169], v[42:43], s[52:53] op_sel_hi:[1,0,1]
    v_pk_mul_f32 v[2:3], v[170:171], v[42:43] op_sel:[0,1] op_sel_hi:[1,1]
    v_exp_f32 v2, v2 clamp
    v_exp_f32 v3, v3 clamp
    v_pk_fma_f32 v[170:171], v[170:171], v[42:43], s[52:53] op_sel_hi:[1,0,1]
    v_max3_f32 v168, v168, v0, s50
    v_max3_f32 v169, v169, v1, s50
    v_max3_f32 v170, v170, v2, s50
    v_max3_f32 v171, v171, v3, s50
    v_cvt_pk_bf16_f32 v138, v168, v169
    v_cvt_pk_bf16_f32 v139, v170, v171
    buffer_store_dwordx4 v[136:139], v5, s[44:47], s4 offen offset:1024 sc1
    v_pk_fma_f32 v[76:77], v[8:9], v[44:45], v[76:77] op_sel_hi:[1,0,1]
    v_pk_fma_f32 v[78:79], v[10:11], v[44:45], v[78:79] op_sel_hi:[1,0,1]
    v_pk_mul_f32 v[0:1], v[76:77], v[46:47] op_sel:[0,1] op_sel_hi:[1,1]
    v_exp_f32 v0, v0 clamp
    v_exp_f32 v1, v1 clamp
    v_pk_fma_f32 v[76:77], v[76:77], v[46:47], s[52:53] op_sel_hi:[1,0,1]
    v_pk_mul_f32 v[2:3], v[78:79], v[46:47] op_sel:[0,1] op_sel_hi:[1,1]
    v_exp_f32 v2, v2 clamp
    v_exp_f32 v3, v3 clamp
    v_pk_fma_f32 v[78:79], v[78:79], v[46:47], s[52:53] op_sel_hi:[1,0,1]
    v_max3_f32 v76, v76, v0, s50
    v_max3_f32 v77, v77, v1, s50
    v_max3_f32 v78, v78, v2, s50
    v_max3_f32 v79, v79, v3, s50
    v_cvt_pk_bf16_f32 v76, v76, v77
    v_cvt_pk_bf16_f32 v77, v78, v79
    v_pk_fma_f32 v[108:109], v[12:13], v[44:45], v[108:109] op_sel_hi:[1,0,1]
    v_pk_fma_f32 v[110:111], v[14:15], v[44:45], v[110:111] op_sel_hi:[1,0,1]
    v_pk_mul_f32 v[0:1], v[108:109], v[46:47] op_sel:[0,1] op_sel_hi:[1,1]
    v_exp_f32 v0, v0 clamp
    v_exp_f32 v1, v1 clamp
    v_pk_fma_f32 v[108:109], v[108:109], v[46:47], s[52:53] op_sel_hi:[1,0,1]
    v_pk_mul_f32 v[2:3], v[110:111], v[46:47] op_sel:[0,1] op_sel_hi:[1,1]
    v_exp_f32 v2, v2 clamp
    v_exp_f32 v3, v3 clamp
    v_pk_fma_f32 v[110:111], v[110:111], v[46:47], s[52:53] op_sel_hi:[1,0,1]
    v_max3_f32 v108, v108, v0, s50
    v_max3_f32 v109, v109, v1, s50
    v_max3_f32 v110, v110, v2, s50
    v_max3_f32 v111, v111, v3, s50
    v_cvt_pk_bf16_f32 v78, v108, v109
    v_cvt_pk_bf16_f32 v79, v110, v111
    buffer_store_dwordx4 v[76:79], v5, s[44:47], s4 offen offset:2048 sc1
    v_pk_fma_f32 v[140:141], v[16:17], v[44:45], v[140:141] op_sel_hi:[1,0,1]
    v_pk_fma_f32 v[142:143], v[18:19], v[44:45], v[142:143] op_sel_hi:[1,0,1]
    v_pk_mul_f32 v[0:1], v[140:141], v[46:47] op_sel:[0,1] op_sel_hi:[1,1]
    v_exp_f32 v0, v0 clamp
    v_exp_f32 v1, v1 clamp
    v_pk_fma_f32 v[140:141], v[140:141], v[46:47], s[52:53] op_sel_hi:[1,0,1]
    v_pk_mul_f32 v[2:3], v[142:143], v[46:47] op_sel:[0,1] op_sel_hi:[1,1]
    v_exp_f32 v2, v2 clamp
    v_exp_f32 v3, v3 clamp
    v_pk_fma_f32 v[142:143], v[142:143], v[46:47], s[52:53] op_sel_hi:[1,0,1]
    v_max3_f32 v140, v140, v0, s50
    v_max3_f32 v141, v141, v1, s50
    v_max3_f32 v142, v142, v2, s50
    v_max3_f32 v143, v143, v3, s50
    v_cvt_pk_bf16_f32 v140, v140, v141
    v_cvt_pk_bf16_f32 v141, v142, v143
    v_pk_fma_f32 v[172:173], v[20:21], v[44:45], v[172:173] op_sel_hi:[1,0,1]
    v_pk_fma_f32 v[174:175], v[22:23], v[44:45], v[174:175] op_sel_hi:[1,0,1]
    v_pk_mul_f32 v[0:1], v[172:173], v[46:47] op_sel:[0,1] op_sel_hi:[1,1]
    v_exp_f32 v0, v0 clamp
    v_exp_f32 v1, v1 clamp
    v_pk_fma_f32 v[172:173], v[172:173], v[46:47], s[52:53] op_sel_hi:[1,0,1]
    v_pk_mul_f32 v[2:3], v[174:175], v[46:47] op_sel:[0,1] op_sel_hi:[1,1]
    v_exp_f32 v2, v2 clamp
    v_exp_f32 v3, v3 clamp
    v_pk_fma_f32 v[174:175], v[174:175], v[46:47], s[52:53] op_sel_hi:[1,0,1]
    v_max3_f32 v172, v172, v0, s50
    v_max3_f32 v173, v173, v1, s50
    v_max3_f32 v174, v174, v2, s50
    v_max3_f32 v175, v175, v3, s50
    v_cvt_pk_bf16_f32 v142, v172, v173
    v_cvt_pk_bf16_f32 v143, v174, v175
    buffer_store_dwordx4 v[140:143], v5, s[44:47], s4 offen offset:3072 sc1
    v_pk_fma_f32 v[200:201], v[24:25], v[40:41], v[200:201] op_sel_hi:[1,0,1]
    v_pk_fma_f32 v[202:203], v[26:27], v[40:41], v[202:203] op_sel_hi:[1,0,1]
    v_pk_mul_f32 v[0:1], v[200:201], v[42:43] op_sel:[0,1] op_sel_hi:[1,1]
    v_exp_f32 v0, v0 clamp
    v_exp_f32 v1, v1 clamp
    v_pk_fma_f32 v[200:201], v[200:201], v[42:43], s[52:53] op_sel_hi:[1,0,1]
    v_pk_mul_f32 v[2:3], v[202:203], v[42:43] op_sel:[0,1] op_sel_hi:[1,1]
    v_exp_f32 v2, v2 clamp
    v_exp_f32 v3, v3 clamp
    v_pk_fma_f32 v[202:203], v[202:203], v[42:43], s[52:53] op_sel_hi:[1,0,1]
    v_max3_f32 v200, v200, v0, s50
    v_max3_f32 v201, v201, v1, s50
    v_max3_f32 v202, v202, v2, s50
    v_max3_f32 v203, v203, v3, s50
    v_cvt_pk_bf16_f32 v200, v200, v201
    v_cvt_pk_bf16_f32 v201, v202, v203
    v_pk_fma_f32 v[204:205], v[24:25], v[44:45], v[204:205] op_sel_hi:[1,0,1]
    v_pk_fma_f32 v[206:207], v[26:27], v[44:45], v[206:207] op_sel_hi:[1,0,1]
    v_pk_mul_f32 v[0:1], v[204:205], v[46:47] op_sel:[0,1] op_sel_hi:[1,1]
    v_exp_f32 v0, v0 clamp
    v_exp_f32 v1, v1 clamp
    v_pk_fma_f32 v[204:205], v[204:205], v[46:47], s[52:53] op_sel_hi:[1,0,1]
    v_pk_mul_f32 v[2:3], v[206:207], v[46:47] op_sel:[0,1] op_sel_hi:[1,1]
    v_exp_f32 v2, v2 clamp
    v_exp_f32 v3, v3 clamp
    v_pk_fma_f32 v[206:207], v[206:207], v[46:47], s[52:53] op_sel_hi:[1,0,1]
    v_max3_f32 v204, v204, v0, s50
    v_max3_f32 v205, v205, v1, s50
    v_max3_f32 v206, v206, v2, s50
    v_max3_f32 v207, v207, v3, s50
    v_cvt_pk_bf16_f32 v202, v204, v205
    v_cvt_pk_bf16_f32 v203, v206, v207
    buffer_store_dwordx4 v[200:203], v5, s[44:47], s5 offen sc1
    s_add_u32 s4, s4, 40960
    s_add_u32 s5, s5, 40960
    v_pk_fma_f32 v[80:81], v[8:9], v[48:49], v[80:81] op_sel_hi:[1,0,1]
    v_pk_fma_f32 v[82:83], v[10:11], v[48:49], v[82:83] op_sel_hi:[1,0,1]
    v_pk_mul_f32 v[0:1], v[80:81], v[50:51] op_sel:[0,1] op_sel_hi:[1,1]
    v_exp_f32 v0, v0 clamp
    v_exp_f32 v1, v1 clamp
    v_pk_fma_f32 v[80:81], v[80:81], v[50:51], s[52:53] op_sel_hi:[1,0,1]
    v_pk_mul_f32 v[2:3], v[82:83], v[50:51] op_sel:[0,1] op_sel_hi:[1,1]
    v_exp_f32 v2, v2 clamp
    v_exp_f32 v3, v3 clamp
    v_pk_fma_f32 v[82:83], v[82:83], v[50:51], s[52:53] op_sel_hi:[1,0,1]
    v_max3_f32 v80, v80, v0, s50
    v_max3_f32 v81, v81, v1, s50
    v_max3_f32 v82, v82, v2, s50
    v_max3_f32 v83, v83, v3, s50
    v_cvt_pk_bf16_f32 v80, v80, v81
    v_cvt_pk_bf16_f32 v81, v82, v83
    v_pk_fma_f32 v[112:113], v[12:13], v[48:49], v[112:113] op_sel_hi:[1,0,1]
    v_pk_fma_f32 v[114:115], v[14:15], v[48:49], v[114:115] op_sel_hi:[1,0,1]
    v_pk_mul_f32 v[0:1], v[112:113], v[50:51] op_sel:[0,1] op_sel_hi:[1,1]
    v_exp_f32 v0, v0 clamp
    v_exp_f32 v1, v1 clamp
    v_pk_fma_f32 v[112:113], v[112:113], v[50:51], s[52:53] op_sel_hi:[1,0,1]
    v_pk_mul_f32 v[2:3], v[114:115], v[50:51] op_sel:[0,1] op_sel_hi:[1,1]
    v_exp_f32 v2, v2 clamp
    v_exp_f32 v3, v3 clamp
    v_pk_fma_f32 v[114:115], v[114:115], v[50:51], s[52:53] op_sel_hi:[1,0,1]
    v_max3_f32 v112, v112, v0, s50
    v_max3_f32 v113, v113, v1, s50
    v_max3_f32 v114, v114, v2, s50
    v_max3_f32 v115, v115, v3, s50
    v_cvt_pk_bf16_f32 v82, v112, v113
    v_cvt_pk_bf16_f32 v83, v114, v115
    buffer_store_dwordx4 v[80:83], v5, s[44:47], s4 offen offset:0 sc1
    v_pk_fma_f32 v[144:145], v[16:17], v[48:49], v[144:145] op_sel_hi:[1,0,1]
    v_pk_fma_f32 v[146:147], v[18:19], v[48:49], v[146:147] op_sel_hi:[1,0,1]
    v_pk_mul_f32 v[0:1], v[144:145], v[50:51] op_sel:[0,1] op_sel_hi:[1,1]
    v_exp_f32 v0, v0 clamp
    v_exp_f32 v1, v1 clamp
    v_pk_fma_f32 v[144:145], v[144:145], v[50:51], s[52:53] op_sel_hi:[1,0,1]
    v_pk_mul_f32 v[2:3], v[146:147], v[50:51] op_sel:[0,1] op_sel_hi:[1,1]
    v_exp_f32 v2, v2 clamp
    v_exp_f32 v3, v3 clamp
    v_pk_fma_f32 v[146:147], v[146:147], v[50:51], s[52:53] op_sel_hi:[1,0,1]
    v_max3_f32 v144, v144, v0, s50
    v_max3_f32 v145, v145, v1, s50
    v_max3_f32 v146, v146, v2, s50
    v_max3_f32 v147, v147, v3, s50
    v_cvt_pk_bf16_f32 v144, v144, v145
    v_cvt_pk_bf16_f32 v145, v146, v147
    v_pk_fma_f32 v[176:177], v[20:21], v[48:49], v[176:177] op_sel_hi:[1,0,1]
    v_pk_fma_f32 v[178:179], v[22:23], v[48:49], v[178:179] op_sel_hi:[1,0,1]
    v_pk_mul_f32 v[0:1], v[176:177], v[50:51] op_sel:[0,1] op_sel_hi:[1,1]
    v_exp_f32 v0, v0 clamp
    v_exp_f32 v1, v1 clamp
    v_pk_fma_f32 v[176:177], v[176:177], v[50:51], s[52:53] op_sel_hi:[1,0,1]
    v_pk_mul_f32 v[2:3], v[178:179], v[50:51] op_sel:[0,1] op_sel_hi:[1,1]
    v_exp_f32 v2, v2 clamp
    v_exp_f32 v3, v3 clamp
    v_pk_fma_f32 v[178:179], v[178:179], v[50:51], s[52:53] op_sel_hi:[1,0,1]
    v_max3_f32 v176, v176, v0, s50
    v_max3_f32 v177, v177, v1, s50
    v_max3_f32 v178, v178, v2, s50
    v_max3_f32 v179, v179, v3, s50
    v_cvt_pk_bf16_f32 v146, v176, v177
    v_cvt_pk_bf16_f32 v147, v178, v179
    buffer_store_dwordx4 v[144:147], v5, s[44:47], s4 offen offset:1024 sc1
    v_pk_fma_f32 v[84:85], v[8:9], v[52:53], v[84:85] op_sel_hi:[1,0,1]
    v_pk_fma_f32 v[86:87], v[10:11], v[52:53], v[86:87] op_sel_hi:[1,0,1]
    v_pk_mul_f32 v[0:1], v[84:85], v[54:55] op_sel:[0,1] op_sel_hi:[1,1]
    v_exp_f32 v0, v0 clamp
    v_exp_f32 v1, v1 clamp
    v_pk_fma_f32 v[84:85], v[84:85], v[54:55], s[52:53] op_sel_hi:[1,0,1]
    v_pk_mul_f32 v[2:3], v[86:87], v[54:55] op_sel:[0,1] op_sel_hi:[1,1]
    v_exp_f32 v2, v2 clamp
    v_exp_f32 v3, v3 clamp
    v_pk_fma_f32 v[86:87], v[86:87], v[54:55], s[52:53] op_sel_hi:[1,0,1]
    v_max3_f32 v84, v84, v0, s50
    v_max3_f32 v85, v85, v1, s50
    v_max3_f32 v86, v86, v2, s50
    v_max3_f32 v87, v87, v3, s50
    v_cvt_pk_bf16_f32 v84, v84, v85
    v_cvt_pk_bf16_f32 v85, v86, v87
    v_pk_fma_f32 v[116:117], v[12:13], v[52:53], v[116:117] op_sel_hi:[1,0,1]
    v_pk_fma_f32 v[118:119], v[14:15], v[52:53], v[118:119] op_sel_hi:[1,0,1]
    v_pk_mul_f32 v[0:1], v[116:117], v[54:55] op_sel:[0,1] op_sel_hi:[1,1]
    v_exp_f32 v0, v0 clamp
    v_exp_f32 v1, v1 clamp
    v_pk_fma_f32 v[116:117], v[116:117], v[54:55], s[52:53] op_sel_hi:[1,0,1]
    v_pk_mul_f32 v[2:3], v[118:119], v[54:55] op_sel:[0,1] op_sel_hi:[1,1]
    v_exp_f32 v2, v2 clamp
    v_exp_f32 v3, v3 clamp
    v_pk_fma_f32 v[118:119], v[118:119], v[54:55], s[52:53] op_sel_hi:[1,0,1]
    v_max3_f32 v116, v116, v0, s50
    v_max3_f32 v117, v117, v1, s50
    v_max3_f32 v118, v118, v2, s50
    v_max3_f32 v119, v119, v3, s50
    v_cvt_pk_bf16_f32 v86, v116, v117
    v_cvt_pk_bf16_f32 v87, v118, v119
    buffer_store_dwordx4 v[84:87], v5, s[44:47], s4 offen offset:2048 sc1
    v_pk_fma_f32 v[148:149], v[16:17], v[52:53], v[148:149] op_sel_hi:[1,0,1]
    v_pk_fma_f32 v[150:151], v[18:19], v[52:53], v[150:151] op_sel_hi:[1,0,1]
    v_pk_mul_f32 v[0:1], v[148:149], v[54:55] op_sel:[0,1] op_sel_hi:[1,1]
    v_exp_f32 v0, v0 clamp
    v_exp_f32 v1, v1 clamp
    v_pk_fma_f32 v[148:149], v[148:149], v[54:55], s[52:53] op_sel_hi:[1,0,1]
    v_pk_mul_f32 v[2:3], v[150:151], v[54:55] op_sel:[0,1] op_sel_hi:[1,1]
    v_exp_f32 v2, v2 clamp
    v_exp_f32 v3, v3 clamp
    v_pk_fma_f32 v[150:151], v[150:151], v[54:55], s[52:53] op_sel_hi:[1,0,1]
    v_max3_f32 v148, v148, v0, s50
    v_max3_f32 v149, v149, v1, s50
    v_max3_f32 v150, v150, v2, s50
    v_max3_f32 v151, v151, v3, s50
    v_cvt_pk_bf16_f32 v148, v148, v149
    v_cvt_pk_bf16_f32 v149, v150, v151
    v_pk_fma_f32 v[180:181], v[20:21], v[52:53], v[180:181] op_sel_hi:[1,0,1]
    v_pk_fma_f32 v[182:183], v[22:23], v[52:53], v[182:183] op_sel_hi:[1,0,1]
    v_pk_mul_f32 v[0:1], v[180:181], v[54:55] op_sel:[0,1] op_sel_hi:[1,1]
    v_exp_f32 v0, v0 clamp
    v_exp_f32 v1, v1 clamp
    v_pk_fma_f32 v[180:181], v[180:181], v[54:55], s[52:53] op_sel_hi:[1,0,1]
    v_pk_mul_f32 v[2:3], v[182:183], v[54:55] op_sel:[0,1] op_sel_hi:[1,1]
    v_exp_f32 v2, v2 clamp
    v_exp_f32 v3, v3 clamp
    v_pk_fma_f32 v[182:183], v[182:183], v[54:55], s[52:53] op_sel_hi:[1,0,1]
    v_max3_f32 v180, v180, v0, s50
    v_max3_f32 v181, v181, v1, s50
    v_max3_f32 v182, v182, v2, s50
    v_max3_f32 v183, v183, v3, s50
    v_cvt_pk_bf16_f32 v150, v180, v181
    v_cvt_pk_bf16_f32 v151, v182, v183
    buffer_store_dwordx4 v[148:151], v5, s[44:47], s4 offen offset:3072 sc1
    v_pk_fma_f32 v[208:209], v[24:25], v[48:49], v[208:209] op_sel_hi:[1,0,1]
    v_pk_fma_f32 v[210:211], v[26:27], v[48:49], v[210:211] op_sel_hi:[1,0,1]
    v_pk_mul_f32 v[0:1], v[208:209], v[50:51] op_sel:[0,1] op_sel_hi:[1,1]
    v_exp_f32 v0, v0 clamp
    v_exp_f32 v1, v1 clamp
    v_pk_fma_f32 v[208:209], v[208:209], v[50:51], s[52:53] op_sel_hi:[1,0,1]
    v_pk_mul_f32 v[2:3], v[210:211], v[50:51] op_sel:[0,1] op_sel_hi:[1,1]
    v_exp_f32 v2, v2 clamp
    v_exp_f32 v3, v3 clamp
    v_pk_fma_f32 v[210:211], v[210:211], v[50:51], s[52:53] op_sel_hi:[1,0,1]
    v_max3_f32 v208, v208, v0, s50
    v_max3_f32 v209, v209, v1, s50
    v_max3_f32 v210, v210, v2, s50
    v_max3_f32 v211, v211, v3, s50
    v_cvt_pk_bf16_f32 v208, v208, v209
    v_cvt_pk_bf16_f32 v209, v210, v211
    v_pk_fma_f32 v[212:213], v[24:25], v[52:53], v[212:213] op_sel_hi:[1,0,1]
    v_pk_fma_f32 v[214:215], v[26:27], v[52:53], v[214:215] op_sel_hi:[1,0,1]
    v_pk_mul_f32 v[0:1], v[212:213], v[54:55] op_sel:[0,1] op_sel_hi:[1,1]
    v_exp_f32 v0, v0 clamp
    v_exp_f32 v1, v1 clamp
    v_pk_fma_f32 v[212:213], v[212:213], v[54:55], s[52:53] op_sel_hi:[1,0,1]
    v_pk_mul_f32 v[2:3], v[214:215], v[54:55] op_sel:[0,1] op_sel_hi:[1,1]
    v_exp_f32 v2, v2 clamp
    v_exp_f32 v3, v3 clamp
    v_pk_fma_f32 v[214:215], v[214:215], v[54:55], s[52:53] op_sel_hi:[1,0,1]
    v_max3_f32 v212, v212, v0, s50
    v_max3_f32 v213, v213, v1, s50
    v_max3_f32 v214, v214, v2, s50
    v_max3_f32 v215, v215, v3, s50
    v_cvt_pk_bf16_f32 v210, v212, v213
    v_cvt_pk_bf16_f32 v211, v214, v215
    buffer_store_dwordx4 v[208:211], v5, s[44:47], s5 offen sc1
    s_add_u32 s4, s4, 40960
    s_add_u32 s5, s5, 40960
    v_pk_fma_f32 v[88:89], v[8:9], v[56:57], v[88:89] op_sel_hi:[1,0,1]
    v_pk_fma_f32 v[90:91], v[10:11], v[56:57], v[90:91] op_sel_hi:[1,0,1]
    v_pk_mul_f32 v[0:1], v[88:89], v[58:59] op_sel:[0,1] op_sel_hi:[1,1]
    v_exp_f32 v0, v0 clamp
    v_exp_f32 v1, v1 clamp
    v_pk_fma_f32 v[88:89], v[88:89], v[58:59], s[52:53] op_sel_hi:[1,0,1]
    v_pk_mul_f32 v[2:3], v[90:91], v[58:59] op_sel:[0,1] op_sel_hi:[1,1]
    v_exp_f32 v2, v2 clamp
    v_exp_f32 v3, v3 clamp
    v_pk_fma_f32 v[90:91], v[90:91], v[58:59], s[52:53] op_sel_hi:[1,0,1]
    v_max3_f32 v88, v88, v0, s50
    v_max3_f32 v89, v89, v1, s50
    v_max3_f32 v90, v90, v2, s50
    v_max3_f32 v91, v91, v3, s50
    v_cvt_pk_bf16_f32 v88, v88, v89
    v_cvt_pk_bf16_f32 v89, v90, v91
    v_pk_fma_f32 v[120:121], v[12:13], v[56:57], v[120:121] op_sel_hi:[1,0,1]
    v_pk_fma_f32 v[122:123], v[14:15], v[56:57], v[122:123] op_sel_hi:[1,0,1]
    v_pk_mul_f32 v[0:1], v[120:121], v[58:59] op_sel:[0,1] op_sel_hi:[1,1]
    v_exp_f32 v0, v0 clamp
    v_exp_f32 v1, v1 clamp
    v_pk_fma_f32 v[120:121], v[120:121], v[58:59], s[52:53] op_sel_hi:[1,0,1]
    v_pk_mul_f32 v[2:3], v[122:123], v[58:59] op_sel:[0,1] op_sel_hi:[1,1]
    v_exp_f32 v2, v2 clamp
    v_exp_f32 v3, v3 clamp
    v_pk_fma_f32 v[122:123], v[122:123], v[58:59], s[52:53] op_sel_hi:[1,0,1]
    v_max3_f32 v120, v120, v0, s50
    v_max3_f32 v121, v121, v1, s50
    v_max3_f32 v122, v122, v2, s50
    v_max3_f32 v123, v123, v3, s50
    v_cvt_pk_bf16_f32 v90, v120, v121
    v_cvt_pk_bf16_f32 v91, v122, v123
    buffer_store_dwordx4 v[88:91], v5, s[44:47], s4 offen offset:0 sc1
    v_pk_fma_f32 v[152:153], v[16:17], v[56:57], v[152:153] op_sel_hi:[1,0,1]
    v_pk_fma_f32 v[154:155], v[18:19], v[56:57], v[154:155] op_sel_hi:[1,0,1]
    v_pk_mul_f32 v[0:1], v[152:153], v[58:59] op_sel:[0,1] op_sel_hi:[1,1]
    v_exp_f32 v0, v0 clamp
    v_exp_f32 v1, v1 clamp
    v_pk_fma_f32 v[152:153], v[152:153], v[58:59], s[52:53] op_sel_hi:[1,0,1]
    v_pk_mul_f32 v[2:3], v[154:155], v[58:59] op_sel:[0,1] op_sel_hi:[1,1]
    v_exp_f32 v2, v2 clamp
    v_exp_f32 v3, v3 clamp
    v_pk_fma_f32 v[154:155], v[154:155], v[58:59], s[52:53] op_sel_hi:[1,0,1]
    v_max3_f32 v152, v152, v0, s50
    v_max3_f32 v153, v153, v1, s50
    v_max3_f32 v154, v154, v2, s50
    v_max3_f32 v155, v155, v3, s50
    v_cvt_pk_bf16_f32 v152, v152, v153
    v_cvt_pk_bf16_f32 v153, v154, v155
    v_pk_fma_f32 v[184:185], v[20:21], v[56:57], v[184:185] op_sel_hi:[1,0,1]
    v_pk_fma_f32 v[186:187], v[22:23], v[56:57], v[186:187] op_sel_hi:[1,0,1]
    v_pk_mul_f32 v[0:1], v[184:185], v[58:59] op_sel:[0,1] op_sel_hi:[1,1]
    v_exp_f32 v0, v0 clamp
    v_exp_f32 v1, v1 clamp
    v_pk_fma_f32 v[184:185], v[184:185], v[58:59], s[52:53] op_sel_hi:[1,0,1]
    v_pk_mul_f32 v[2:3], v[186:187], v[58:59] op_sel:[0,1] op_sel_hi:[1,1]
    v_exp_f32 v2, v2 clamp
    v_exp_f32 v3, v3 clamp
    v_pk_fma_f32 v[186:187], v[186:187], v[58:59], s[52:53] op_sel_hi:[1,0,1]
    v_max3_f32 v184, v184, v0, s50
    v_max3_f32 v185, v185, v1, s50
    v_max3_f32 v186, v186, v2, s50
    v_max3_f32 v187, v187, v3, s50
    v_cvt_pk_bf16_f32 v154, v184, v185
    v_cvt_pk_bf16_f32 v155, v186, v187
    buffer_store_dwordx4 v[152:155], v5, s[44:47], s4 offen offset:1024 sc1
    v_pk_fma_f32 v[92:93], v[8:9], v[60:61], v[92:93] op_sel_hi:[1,0,1]
    v_pk_fma_f32 v[94:95], v[10:11], v[60:61], v[94:95] op_sel_hi:[1,0,1]
    v_pk_mul_f32 v[0:1], v[92:93], v[62:63] op_sel:[0,1] op_sel_hi:[1,1]
    v_exp_f32 v0, v0 clamp
    v_exp_f32 v1, v1 clamp
    v_pk_fma_f32 v[92:93], v[92:93], v[62:63], s[52:53] op_sel_hi:[1,0,1]
    v_pk_mul_f32 v[2:3], v[94:95], v[62:63] op_sel:[0,1] op_sel_hi:[1,1]
    v_exp_f32 v2, v2 clamp
    v_exp_f32 v3, v3 clamp
    v_pk_fma_f32 v[94:95], v[94:95], v[62:63], s[52:53] op_sel_hi:[1,0,1]
    v_max3_f32 v92, v92, v0, s50
    v_max3_f32 v93, v93, v1, s50
    v_max3_f32 v94, v94, v2, s50
    v_max3_f32 v95, v95, v3, s50
    v_cvt_pk_bf16_f32 v92, v92, v93
    v_cvt_pk_bf16_f32 v93, v94, v95
    v_pk_fma_f32 v[124:125], v[12:13], v[60:61], v[124:125] op_sel_hi:[1,0,1]
    v_pk_fma_f32 v[126:127], v[14:15], v[60:61], v[126:127] op_sel_hi:[1,0,1]
    v_pk_mul_f32 v[0:1], v[124:125], v[62:63] op_sel:[0,1] op_sel_hi:[1,1]
    v_exp_f32 v0, v0 clamp
    v_exp_f32 v1, v1 clamp
    v_pk_fma_f32 v[124:125], v[124:125], v[62:63], s[52:53] op_sel_hi:[1,0,1]
    v_pk_mul_f32 v[2:3], v[126:127], v[62:63] op_sel:[0,1] op_sel_hi:[1,1]
    v_exp_f32 v2, v2 clamp
    v_exp_f32 v3, v3 clamp
    v_pk_fma_f32 v[126:127], v[126:127], v[62:63], s[52:53] op_sel_hi:[1,0,1]
    v_max3_f32 v124, v124, v0, s50
    v_max3_f32 v125, v125, v1, s50
    v_max3_f32 v126, v126, v2, s50
    v_max3_f32 v127, v127, v3, s50
    v_cvt_pk_bf16_f32 v94, v124, v125
    v_cvt_pk_bf16_f32 v95, v126, v127
    buffer_store_dwordx4 v[92:95], v5, s[44:47], s4 offen offset:2048 sc1
    v_pk_fma_f32 v[156:157], v[16:17], v[60:61], v[156:157] op_sel_hi:[1,0,1]
    v_pk_fma_f32 v[158:159], v[18:19], v[60:61], v[158:159] op_sel_hi:[1,0,1]
    v_pk_mul_f32 v[0:1], v[156:157], v[62:63] op_sel:[0,1] op_sel_hi:[1,1]
    v_exp_f32 v0, v0 clamp
    v_exp_f32 v1, v1 clamp
    v_pk_fma_f32 v[156:157], v[156:157], v[62:63], s[52:53] op_sel_hi:[1,0,1]
    v_pk_mul_f32 v[2:3], v[158:159], v[62:63] op_sel:[0,1] op_sel_hi:[1,1]
    v_exp_f32 v2, v2 clamp
    v_exp_f32 v3, v3 clamp
    v_pk_fma_f32 v[158:159], v[158:159], v[62:63], s[52:53] op_sel_hi:[1,0,1]
    v_max3_f32 v156, v156, v0, s50
    v_max3_f32 v157, v157, v1, s50
    v_max3_f32 v158, v158, v2, s50
    v_max3_f32 v159, v159, v3, s50
    v_cvt_pk_bf16_f32 v156, v156, v157
    v_cvt_pk_bf16_f32 v157, v158, v159
    v_pk_fma_f32 v[188:189], v[20:21], v[60:61], v[188:189] op_sel_hi:[1,0,1]
    v_pk_fma_f32 v[190:191], v[22:23], v[60:61], v[190:191] op_sel_hi:[1,0,1]
    v_pk_mul_f32 v[0:1], v[188:189], v[62:63] op_sel:[0,1] op_sel_hi:[1,1]
    v_exp_f32 v0, v0 clamp
    v_exp_f32 v1, v1 clamp
    v_pk_fma_f32 v[188:189], v[188:189], v[62:63], s[52:53] op_sel_hi:[1,0,1]
    v_pk_mul_f32 v[2:3], v[190:191], v[62:63] op_sel:[0,1] op_sel_hi:[1,1]
    v_exp_f32 v2, v2 clamp
    v_exp_f32 v3, v3 clamp
    v_pk_fma_f32 v[190:191], v[190:191], v[62:63], s[52:53] op_sel_hi:[1,0,1]
    v_max3_f32 v188, v188, v0, s50
    v_max3_f32 v189, v189, v1, s50
    v_max3_f32 v190, v190, v2, s50
    v_max3_f32 v191, v191, v3, s50
    v_cvt_pk_bf16_f32 v158, v188, v189
    v_cvt_pk_bf16_f32 v159, v190, v191
    buffer_store_dwordx4 v[156:159], v5, s[44:47], s4 offen offset:3072 sc1
    v_pk_fma_f32 v[216:217], v[24:25], v[56:57], v[216:217] op_sel_hi:[1,0,1]
    v_pk_fma_f32 v[218:219], v[26:27], v[56:57], v[218:219] op_sel_hi:[1,0,1]
    v_pk_mul_f32 v[0:1], v[216:217], v[58:59] op_sel:[0,1] op_sel_hi:[1,1]
    v_exp_f32 v0, v0 clamp
    v_exp_f32 v1, v1 clamp
    v_pk_fma_f32 v[216:217], v[216:217], v[58:59], s[52:53] op_sel_hi:[1,0,1]
    v_pk_mul_f32 v[2:3], v[218:219], v[58:59] op_sel:[0,1] op_sel_hi:[1,1]
    v_exp_f32 v2, v2 clamp
    v_exp_f32 v3, v3 clamp
    v_pk_fma_f32 v[218:219], v[218:219], v[58:59], s[52:53] op_sel_hi:[1,0,1]
    v_max3_f32 v216, v216, v0, s50
    v_max3_f32 v217, v217, v1, s50
    v_max3_f32 v218, v218, v2, s50
    v_max3_f32 v219, v219, v3, s50
    v_cvt_pk_bf16_f32 v216, v216, v217
    v_cvt_pk_bf16_f32 v217, v218, v219
    v_pk_fma_f32 v[220:221], v[24:25], v[60:61], v[220:221] op_sel_hi:[1,0,1]
    v_pk_fma_f32 v[222:223], v[26:27], v[60:61], v[222:223] op_sel_hi:[1,0,1]
    v_pk_mul_f32 v[0:1], v[220:221], v[62:63] op_sel:[0,1] op_sel_hi:[1,1]
    v_exp_f32 v0, v0 clamp
    v_exp_f32 v1, v1 clamp
    v_pk_fma_f32 v[220:221], v[220:221], v[62:63], s[52:53] op_sel_hi:[1,0,1]
    v_pk_mul_f32 v[2:3], v[222:223], v[62:63] op_sel:[0,1] op_sel_hi:[1,1]
    v_exp_f32 v2, v2 clamp
    v_exp_f32 v3, v3 clamp
    v_pk_fma_f32 v[222:223], v[222:223], v[62:63], s[52:53] op_sel_hi:[1,0,1]
    v_max3_f32 v220, v220, v0, s50
    v_max3_f32 v221, v221, v1, s50
    v_max3_f32 v222, v222, v2, s50
    v_max3_f32 v223, v223, v3, s50
    v_cvt_pk_bf16_f32 v218, v220, v221
    v_cvt_pk_bf16_f32 v219, v222, v223
    buffer_store_dwordx4 v[216:219], v5, s[44:47], s5 offen sc1
    s_branch g1_done
g1_ckv:
    s_and_b32 s4, s7, 1
    s_lshl_b32 s4, s4, 4
    s_mul_i32 s5, s12, 40
    s_add_u32 s4, s4, s5
    v_lshl_add_u32 v40, v5, 2, s4
    v_add_u32 v41, 20, v40
    v_add_u32 v43, 96, v40
    v_add_u32 v44, 116, v40
    v_and_b32 v30, 1, v5
    v_mul_u32_u24 v30, 20, v30
    v_lshrrev_b32 v31, 1, v5
    v_mul_u32_u24 v31, 96, v31
    s_add_u32 s4, s4, 16
    v_add3_u32 v42, v30, v31, s4
    v_mov_b32 v45, v40
    v_lshlrev_b32 v30, 9, v4
    v_lshrrev_b32 v31, 2, v3
    v_lshl_add_u32 v30, v31, 6, v30
    v_add_u32 v30, 98304, v30
    v_lshrrev_b32 v31, 5, v40
    v_lshl_add_u32 v31, v31, 11, v30
    v_lshrrev_b32 v32, 4, v40
    v_xor_b32 v32, v32, v4
    v_and_b32 v32, 1, v32
    v_lshl_add_u32 v31, v32, 5, v31
    v_bfe_u32 v32, v40, 2, 2
    v_lshl_add_u32 v40, v32, 3, v31
    v_lshrrev_b32 v31, 5, v41
    v_lshl_add_u32 v31, v31, 11, v30
    v_lshrrev_b32 v32, 4, v41
    v_xor_b32 v32, v32, v4
    v_and_b32 v32, 1, v32
    v_lshl_add_u32 v31, v32, 5, v31
    v_bfe_u32 v32, v41, 2, 2
    v_lshl_add_u32 v41, v32, 3, v31
    v_lshrrev_b32 v31, 5, v42
    v_lshl_add_u32 v31, v31, 11, v30
    v_lshrrev_b32 v32, 4, v42
    v_xor_b32 v32, v32, v4
    v_and_b32 v32, 1, v32
    v_lshl_add_u32 v31, v32, 5, v31
    v_bfe_u32 v32, v42, 2, 2
    v_lshl_add_u32 v42, v32, 3, v31
    v_lshrrev_b32 v31, 5, v43
    v_lshl_add_u32 v31, v31, 11, v30
    v_lshrrev_b32 v32, 4, v43
    v_xor_b32 v32, v32, v4
    v_and_b32 v32, 1, v32
    v_lshl_add_u32 v31, v32, 5, v31
    v_bfe_u32 v32, v43, 2, 2
    v_lshl_add_u32 v43, v32, 3, v31
    v_lshrrev_b32 v31, 5, v44
    v_lshl_add_u32 v31, v31, 11, v30
    v_lshrrev_b32 v32, 4, v44
    v_xor_b32 v32, v32, v4
    v_and_b32 v32, 1, v32
    v_lshl_add_u32 v31, v32, 5, v31
    v_bfe_u32 v32, v44, 2, 2
    v_lshl_add_u32 v44, v32, 3, v31
    s_lshl_b32 s4, s11, 14
    v_and_b32 v30, 7, v3
    v_xor_b32 v31, v30, v4
    v_lshlrev_b32 v31, 4, v31
    v_lshl_add_u32 v31, v30, 7, v31
    v_lshrrev_b32 v30, 3, v3
    v_lshl_add_u32 v31, v30, 10, v31
    v_add_u32 v46, s4, v31
    v_xor_b32 v47, 64, v46
    s_mul_i32 s4, s9, 3392
    s_add_u32 s4, s4, 40960
    s_mov_b32 s5, 59968
    v_lshl_add_u32 v50, v2, 4, s5
    v_mul_u32_u24 v51, 80, v3
    v_lshl_add_u32 v52, v4, 4, s4
    v_add_u32 v28, v51, v52
    v_add_u32 v29, 1696, v28
    v_lshrrev_b32 v53, 2, v3
    v_cmp_eq_u32 s[54:55], 0, v3
    v_cmp_eq_u32 s[56:57], 2, v53
    v_cmp_eq_u32 s[58:59], 3, v53
    v_and_b32 v53, 3, v3
    v_mul_u32_u24 v53, 80, v53
    v_add_u32 v53, 1280, v53
    v_mov_b32 v54, 1600
    v_cndmask_b32 v53, v53, v54, s[54:55]
    s_or_b64 s[56:57], s[56:57], s[54:55]
    s_or_b64 s[58:59], s[58:59], s[54:55]
    v_add_u32 v54, v53, v52
    v_cndmask_b32 v30, v50, v54, s[56:57]
    v_add_u32 v54, 1696, v54
    v_cndmask_b32 v31, v50, v54, s[58:59]
    v_cmp_eq_u32 s[54:55], 0, v4
    v_cmp_eq_u32 vcc, 1, v4
    s_add_u32 s5, s4, 64
    v_add_u32 v54, s5, v51
    v_cndmask_b32 v92, v50, v54, s[54:55]
    v_add_u32 v54, 1696, v54
    v_cndmask_b32 v93, v50, v54, vcc
    s_and_b64 s[56:57], s[56:57], s[54:55]
    s_and_b64 s[58:59], s[58:59], vcc
    v_add_u32 v54, s5, v53
    v_cndmask_b32 v94, v50, v54, s[56:57]
    v_add_u32 v54, 1696, v54
    v_cndmask_b32 v94, v94, v54, s[58:59]
    v_mov_b32 v96, 0
    v_mov_b32 v97, 0
    v_mov_b32 v98, 0
    v_mov_b32 v99, 0
    v_mov_b32 v100, 0
    v_mov_b32 v101, 0
    v_mov_b32 v102, 0
    v_mov_b32 v103, 0
    v_mov_b32 v104, 0
    v_mov_b32 v105, 0
    v_mov_b32 v106, 0
    v_mov_b32 v107, 0
    v_mov_b32 v108, 0
    v_mov_b32 v109, 0
    v_mov_b32 v110, 0
    v_mov_b32 v111, 0
    v_mov_b32 v112, 0
    v_mov_b32 v113, 0
    v_mov_b32 v114, 0
    v_mov_b32 v115, 0
    v_mov_b32 v116, 0
    v_mov_b32 v117, 0
    v_mov_b32 v118, 0
    v_mov_b32 v119, 0
    v_mov_b32 v120, 0
    v_mov_b32 v121, 0
    v_mov_b32 v122, 0
    v_mov_b32 v123, 0
    v_mov_b32 v124, 0
    v_mov_b32 v125, 0
    v_mov_b32 v126, 0
    v_mov_b32 v127, 0
    v_mov_b32 v128, 0
    v_mov_b32 v129, 0
    v_mov_b32 v130, 0
    v_mov_b32 v131, 0
    v_mov_b32 v132, 0
    v_mov_b32 v133, 0
    v_mov_b32 v134, 0
    v_mov_b32 v135, 0
    v_mov_b32 v136, 0
    v_mov_b32 v137, 0
    v_mov_b32 v138, 0
    v_mov_b32 v139, 0
    v_mov_b32 v140, 0
    v_mov_b32 v141, 0
    v_mov_b32 v142, 0
    v_mov_b32 v143, 0
    v_mov_b32 v144, 0
    v_mov_b32 v145, 0
    v_mov_b32 v146, 0
    v_mov_b32 v147, 0
    v_mov_b32 v148, 0
    v_mov_b32 v149, 0
    v_mov_b32 v150, 0
    v_mov_b32 v151, 0
    v_mov_b32 v152, 0
    v_mov_b32 v153, 0
    v_mov_b32 v154, 0
    v_mov_b32 v155, 0
    v_mov_b32 v156, 0
    v_mov_b32 v157, 0
    v_mov_b32 v158, 0
    v_mov_b32 v159, 0
    v_mov_b32 v160, 0
    v_mov_b32 v161, 0
    v_mov_b32 v162, 0
    v_mov_b32 v163, 0
    v_mov_b32 v164, 0
    v_mov_b32 v165, 0
    v_mov_b32 v166, 0
    v_mov_b32 v167, 0
    v_mov_b32 v168, 0
    v_mov_b32 v169, 0
    v_mov_b32 v170, 0
    v_mov_b32 v171, 0
    v_mov_b32 v172, 0
    v_mov_b32 v173, 0
    v_mov_b32 v174, 0
    v_mov_b32 v175, 0
    v_mov_b32 v176, 0
    v_mov_b32 v177, 0
    v_mov_b32 v178, 0
    v_mov_b32 v179, 0
    v_mov_b32 v180, 0
    v_mov_b32 v181, 0
    v_mov_b32 v182, 0
    v_mov_b32 v183, 0
    v_mov_b32 v184, 0
    v_mov_b32 v185, 0
    v_mov_b32 v186, 0
    v_mov_b32 v187, 0
    v_mov_b32 v188, 0
    v_mov_b32 v189, 0
    v_mov_b32 v190, 0
    v_mov_b32 v191, 0
    v_mov_b32 v192, 0
    v_mov_b32 v193, 0
    v_mov_b32 v194, 0
    v_mov_b32 v195, 0
    v_mov_b32 v196, 0
    v_mov_b32 v197, 0
    v_mov_b32 v198, 0
    v_mov_b32 v199, 0
    v_mov_b32 v200, 0
    v_mov_b32 v201, 0
    v_mov_b32 v202, 0
    v_mov_b32 v203, 0
    v_mov_b32 v204, 0
    v_mov_b32 v205, 0
    v_mov_b32 v206, 0
    v_mov_b32 v207, 0
    v_mov_b32 v208, 0
    v_mov_b32 v209, 0
    v_mov_b32 v210, 0
    v_mov_b32 v211, 0
    v_mov_b32 v212, 0
    v_mov_b32 v213, 0
    v_mov_b32 v214, 0
    v_mov_b32 v215, 0
    v_mov_b32 v216, 0
    v_mov_b32 v217, 0
    v_mov_b32 v218, 0
    v_mov_b32 v219, 0
    v_mov_b32 v220, 0
    v_mov_b32 v221, 0
    v_mov_b32 v222, 0
    v_mov_b32 v223, 0
    v_mov_b32 v224, 0
    v_mov_b32 v225, 0
    v_mov_b32 v226, 0
    v_mov_b32 v227, 0
    v_mov_b32 v228, 0
    v_mov_b32 v229, 0
    v_mov_b32 v230, 0
    v_mov_b32 v231, 0
    v_mov_b32 v232, 0
    v_mov_b32 v233, 0
    v_mov_b32 v234, 0
    v_mov_b32 v235, 0
    v_mov_b32 v236, 0
    v_mov_b32 v237, 0
    v_mov_b32 v238, 0
    v_mov_b32 v239, 0
    v_mov_b32 v240, 0
    v_mov_b32 v241, 0
    v_mov_b32 v242, 0
    v_mov_b32 v243, 0
    v_mov_b32 v244, 0
    v_mov_b32 v245, 0
    v_mov_b32 v246, 0
    v_mov_b32 v247, 0
    v_mov_b32 v248, 0
    v_mov_b32 v249, 0
    v_mov_b32 v250, 0
    v_mov_b32 v251, 0
    v_mov_b32 v252, 0
    v_mov_b32 v253, 0
    v_mov_b32 v254, 0
    v_mov_b32 v255, 0
    s_mov_b32 s62, 12288
    s_mov_b32 s63, 4294918144
    s_mov_b32 s64, 32768
    s_mov_b32 s65, 4294901760
    s_mov_b32 s60, 0
    s_mov_b32 s59, 0
    s_mov_b32 s61, 12288
    s_mov_b32 s66, 32768
    s_mov_b32 s67, 10
    v_mov_b32 v0, v40
    v_mov_b32 v1, v41
    v_mov_b32 v2, v42
    v_mov_b32 v3, v43
    v_mov_b32 v4, v44
    v_mov_b32 v6, v46
    v_mov_b32 v7, v47
    .p2alignl 5, 0xbf800000
    s_branch g1_kv_ov
g1_kv_sk0:
    ds_append v8 offset:61324
    s_branch g1_kv_bk0
g1_kv_sk1:
    ds_append v8 offset:61324
    s_branch g1_kv_bk1
g1_kv_ov:
    s_barrier
    s_mov_b32 m0, 0
    ds_read_b64_tr_b16 v[8:9], v0
    ds_read_b64_tr_b16 v[10:11], v0 offset:256
    ds_read_b64_tr_b16 v[12:13], v1
    ds_read_b64_tr_b16 v[14:15], v1 offset:256
    ds_read_b64_tr_b16 v[16:17], v2
    ds_read_b64_tr_b16 v[18:19], v2 offset:256
    ds_read_b128 v[32:35], v6 offset:0
    ds_read_b128 v[36:39], v6 offset:2048
    ds_read_b128 v[40:43], v6 offset:4096
    ds_read_b128 v[44:47], v6 offset:6144
    ds_read_b128 v[48:51], v6 offset:8192
    ds_read_b128 v[52:55], v6 offset:10240
    ds_read_b128 v[56:59], v6 offset:12288
    ds_read_b128 v[60:63], v6 offset:14336
    v_add_u32 v0, s61, v0
    v_add_u32 v1, s61, v1
    v_add_u32 v2, s61, v2
    v_add_u32 v6, s66, v6
g1_kv_loop:
    s_waitcnt lgkmcnt(5)
    v_mfma_f32_16x16x32_bf16 v[96:99], v[32:35], v[8:11], v[96:99]
    ds_read_b64_tr_b16 v[20:21], v3
    v_mfma_f32_16x16x32_bf16 v[128:131], v[32:35], v[12:15], v[128:131]
    ds_read_b64_tr_b16 v[22:23], v3 offset:256
    v_mfma_f32_16x16x32_bf16 v[160:163], v[32:35], v[16:19], v[160:163]
    ds_read_b64_tr_b16 v[24:25], v4
    v_mfma_f32_16x16x32_bf16 v[100:103], v[36:39], v[8:11], v[100:103]
    ds_read_b64_tr_b16 v[26:27], v4 offset:256
    v_mfma_f32_16x16x32_bf16 v[132:135], v[36:39], v[12:15], v[132:135]
    v_mfma_f32_16x16x32_bf16 v[164:167], v[36:39], v[16:19], v[164:167]
    v_mfma_f32_16x16x32_bf16 v[104:107], v[40:43], v[8:11], v[104:107]
    v_mfma_f32_16x16x32_bf16 v[136:139], v[40:43], v[12:15], v[136:139]
    v_mfma_f32_16x16x32_bf16 v[168:171], v[40:43], v[16:19], v[168:171]
    s_waitcnt lgkmcnt(6)
    v_mfma_f32_16x16x32_bf16 v[108:111], v[44:47], v[8:11], v[108:111]
    v_mfma_f32_16x16x32_bf16 v[140:143], v[44:47], v[12:15], v[140:143]
    v_mfma_f32_16x16x32_bf16 v[172:175], v[44:47], v[16:19], v[172:175]
    v_mfma_f32_16x16x32_bf16 v[112:115], v[48:51], v[8:11], v[112:115]
    v_add_u32 v3, s61, v3
    v_mfma_f32_16x16x32_bf16 v[144:147], v[48:51], v[12:15], v[144:147]
    v_add_u32 v4, s61, v4
    v_mfma_f32_16x16x32_bf16 v[176:179], v[48:51], v[16:19], v[176:179]
    v_mfma_f32_16x16x32_bf16 v[116:119], v[52:55], v[8:11], v[116:119]
    v_mfma_f32_16x16x32_bf16 v[148:151], v[52:55], v[12:15], v[148:151]
    v_mfma_f32_16x16x32_bf16 v[180:183], v[52:55], v[16:19], v[180:183]
    s_waitcnt lgkmcnt(0)
    v_mfma_f32_16x16x32_bf16 v[120:123], v[56:59], v[8:11], v[120:123]
    s_add_u32 s60, s60, 1
    s_cmp_eq_u32 s60, 4
    v_mfma_f32_16x16x32_bf16 v[152:155], v[56:59], v[12:15], v[152:155]
    s_cselect_b32 s61, s63, s62
    s_cselect_b32 s60, -1, s60
    v_mfma_f32_16x16x32_bf16 v[184:187], v[56:59], v[16:19], v[184:187]
    v_mfma_f32_16x16x32_bf16 v[124:127], v[60:63], v[8:11], v[124:127]
    v_mfma_f32_16x16x32_bf16 v[156:159], v[60:63], v[12:15], v[156:159]
    s_cmp_le_u32 s67, 1
    v_mfma_f32_16x16x32_bf16 v[188:191], v[60:63], v[16:19], v[188:191]
    s_cbranch_scc1 g1_kv_sk0
    s_barrier
g1_kv_bk0:
    v_mfma_f32_16x16x32_bf16 v[192:195], v[32:35], v[20:23], v[192:195]
    ds_read_b64_tr_b16 v[8:9], v0
    ds_read_b64_tr_b16 v[10:11], v0 offset:256
    v_mfma_f32_16x16x32_bf16 v[224:227], v[32:35], v[24:27], v[224:227]
    ds_read_b128 v[32:35], v7 offset:0
    v_mfma_f32_16x16x32_bf16 v[196:199], v[36:39], v[20:23], v[196:199]
    ds_read_b64_tr_b16 v[12:13], v1
    ds_read_b64_tr_b16 v[14:15], v1 offset:256
    v_mfma_f32_16x16x32_bf16 v[228:231], v[36:39], v[24:27], v[228:231]
    ds_read_b128 v[36:39], v7 offset:2048
    v_mfma_f32_16x16x32_bf16 v[200:203], v[40:43], v[20:23], v[200:203]
    ds_read_b64_tr_b16 v[16:17], v2
    ds_read_b64_tr_b16 v[18:19], v2 offset:256
    v_mfma_f32_16x16x32_bf16 v[232:235], v[40:43], v[24:27], v[232:235]
    ds_read_b128 v[40:43], v7 offset:4096
    v_mfma_f32_16x16x32_bf16 v[204:207], v[44:47], v[20:23], v[204:207]
    v_add_u32 v0, s61, v0
    v_mfma_f32_16x16x32_bf16 v[236:239], v[44:47], v[24:27], v[236:239]
    ds_read_b128 v[44:47], v7 offset:6144
    v_mfma_f32_16x16x32_bf16 v[208:211], v[48:51], v[20:23], v[208:211]
    v_add_u32 v1, s61, v1
    v_mfma_f32_16x16x32_bf16 v[240:243], v[48:51], v[24:27], v[240:243]
    ds_read_b128 v[48:51], v7 offset:8192
    v_mfma_f32_16x16x32_bf16 v[212:215], v[52:55], v[20:23], v[212:215]
    v_add_u32 v2, s61, v2
    v_mfma_f32_16x16x32_bf16 v[244:247], v[52:55], v[24:27], v[244:247]
    ds_read_b128 v[52:55], v7 offset:10240
    v_mfma_f32_16x16x32_bf16 v[216:219], v[56:59], v[20:23], v[216:219]
    v_mfma_f32_16x16x32_bf16 v[248:251], v[56:59], v[24:27], v[248:251]
    ds_read_b128 v[56:59], v7 offset:12288
    v_mfma_f32_16x16x32_bf16 v[220:223], v[60:63], v[20:23], v[220:223]
    v_mfma_f32_16x16x32_bf16 v[252:255], v[60:63], v[24:27], v[252:255]
    ds_read_b128 v[60:63], v7 offset:14336
    v_add_u32 v7, s66, v7
    s_waitcnt lgkmcnt(5)
    v_mfma_f32_16x16x32_bf16 v[96:99], v[32:35], v[8:11], v[96:99]
    ds_read_b64_tr_b16 v[20:21], v3
    v_mfma_f32_16x16x32_bf16 v[128:131], v[32:35], v[12:15], v[128:131]
    ds_read_b64_tr_b16 v[22:23], v3 offset:256
    v_mfma_f32_16x16x32_bf16 v[160:163], v[32:35], v[16:19], v[160:163]
    ds_read_b64_tr_b16 v[24:25], v4
    v_mfma_f32_16x16x32_bf16 v[100:103], v[36:39], v[8:11], v[100:103]
    ds_read_b64_tr_b16 v[26:27], v4 offset:256
    v_mfma_f32_16x16x32_bf16 v[132:135], v[36:39], v[12:15], v[132:135]
    v_mfma_f32_16x16x32_bf16 v[164:167], v[36:39], v[16:19], v[164:167]
    v_mfma_f32_16x16x32_bf16 v[104:107], v[40:43], v[8:11], v[104:107]
    v_mfma_f32_16x16x32_bf16 v[136:139], v[40:43], v[12:15], v[136:139]
    v_mfma_f32_16x16x32_bf16 v[168:171], v[40:43], v[16:19], v[168:171]
    s_waitcnt lgkmcnt(6)
    v_mfma_f32_16x16x32_bf16 v[108:111], v[44:47], v[8:11], v[108:111]
    v_mfma_f32_16x16x32_bf16 v[140:143], v[44:47], v[12:15], v[140:143]
    v_mfma_f32_16x16x32_bf16 v[172:175], v[44:47], v[16:19], v[172:175]
    v_mfma_f32_16x16x32_bf16 v[112:115], v[48:51], v[8:11], v[112:115]
    v_add_u32 v3, s61, v3
    v_mfma_f32_16x16x32_bf16 v[144:147], v[48:51], v[12:15], v[144:147]
    v_add_u32 v4, s61, v4
    v_mfma_f32_16x16x32_bf16 v[176:179], v[48:51], v[16:19], v[176:179]
    v_mfma_f32_16x16x32_bf16 v[116:119], v[52:55], v[8:11], v[116:119]
    v_mfma_f32_16x16x32_bf16 v[148:151], v[52:55], v[12:15], v[148:151]
    v_mfma_f32_16x16x32_bf16 v[180:183], v[52:55], v[16:19], v[180:183]
    s_waitcnt lgkmcnt(0)
    v_mfma_f32_16x16x32_bf16 v[120:123], v[56:59], v[8:11], v[120:123]
    s_add_u32 s60, s60, 1
    s_cmp_eq_u32 s60, 4
    v_mfma_f32_16x16x32_bf16 v[152:155], v[56:59], v[12:15], v[152:155]
    s_cselect_b32 s61, s63, s62
    s_cselect_b32 s60, -1, s60
    v_mfma_f32_16x16x32_bf16 v[184:187], v[56:59], v[16:19], v[184:187]
    s_add_u32 s59, s59, 1
    s_cmp_eq_u32 s59, 2
    v_mfma_f32_16x16x32_bf16 v[124:127], v[60:63], v[8:11], v[124:127]
    s_cselect_b32 s66, s65, s64
    s_cselect_b32 s59, -1, s59
    s_waitcnt vmcnt(0)
    v_mfma_f32_16x16x32_bf16 v[156:159], v[60:63], v[12:15], v[156:159]
    s_cmp_le_u32 s67, 2
    v_mfma_f32_16x16x32_bf16 v[188:191], v[60:63], v[16:19], v[188:191]
    s_cbranch_scc1 g1_kv_sk1
    s_barrier
g1_kv_bk1:
    v_mfma_f32_16x16x32_bf16 v[192:195], v[32:35], v[20:23], v[192:195]
    ds_read_b64_tr_b16 v[8:9], v0
    ds_read_b64_tr_b16 v[10:11], v0 offset:256
    v_mfma_f32_16x16x32_bf16 v[224:227], v[32:35], v[24:27], v[224:227]
    ds_read_b128 v[32:35], v6 offset:0
    v_mfma_f32_16x16x32_bf16 v[196:199], v[36:39], v[20:23], v[196:199]
    ds_read_b64_tr_b16 v[12:13], v1
    ds_read_b64_tr_b16 v[14:15], v1 offset:256
    v_mfma_f32_16x16x32_bf16 v[228:231], v[36:39], v[24:27], v[228:231]
    ds_read_b128 v[36:39], v6 offset:2048
    v_mfma_f32_16x16x32_bf16 v[200:203], v[40:43], v[20:23], v[200:203]
    ds_read_b64_tr_b16 v[16:17], v2
    ds_read_b64_tr_b16 v[18:19], v2 offset:256
    v_mfma_f32_16x16x32_bf16 v[232:235], v[40:43], v[24:27], v[232:235]
    ds_read_b128 v[40:43], v6 offset:4096
    v_mfma_f32_16x16x32_bf16 v[204:207], v[44:47], v[20:23], v[204:207]
    v_add_u32 v0, s61, v0
    v_mfma_f32_16x16x32_bf16 v[236:239], v[44:47], v[24:27], v[236:239]
    ds_read_b128 v[44:47], v6 offset:6144
    v_mfma_f32_16x16x32_bf16 v[208:211], v[48:51], v[20:23], v[208:211]
    v_add_u32 v1, s61, v1
    v_mfma_f32_16x16x32_bf16 v[240:243], v[48:51], v[24:27], v[240:243]
    ds_read_b128 v[48:51], v6 offset:8192
    v_mfma_f32_16x16x32_bf16 v[212:215], v[52:55], v[20:23], v[212:215]
    v_add_u32 v2, s61, v2
    v_mfma_f32_16x16x32_bf16 v[244:247], v[52:55], v[24:27], v[244:247]
    ds_read_b128 v[52:55], v6 offset:10240
    v_mfma_f32_16x16x32_bf16 v[216:219], v[56:59], v[20:23], v[216:219]
    s_sub_u32 s67, s67, 1
    v_mfma_f32_16x16x32_bf16 v[248:251], v[56:59], v[24:27], v[248:251]
    ds_read_b128 v[56:59], v6 offset:12288
    v_mfma_f32_16x16x32_bf16 v[220:223], v[60:63], v[20:23], v[220:223]
    s_cmp_lg_u32 s67, 0
    v_mfma_f32_16x16x32_bf16 v[252:255], v[60:63], v[24:27], v[252:255]
    ds_read_b128 v[60:63], v6 offset:14336
    v_add_u32 v6, s66, v6
    s_cbranch_scc1 g1_kv_loop
    v_mov_b32 v0, 61312
g1_kv_ep:
    v_mbcnt_lo_u32_b32 v2, -1, 0
    v_mbcnt_hi_u32_b32 v2, -1, v2
    s_waitcnt lgkmcnt(0) vmcnt(0)
    ds_read_b32 v1, v0 offset:100
    v_and_b32 v3, 15, v2
    v_lshrrev_b32 v4, 4, v2
    s_mul_i32 s4, s12, 384
    s_add_u32 s4, s4, 56064
    s_mov_b32 s52, 1.0
    s_mov_b32 s53, 1.0
    s_mov_b32 s89, 1
    s_mov_b32 s50, 0x358637bd
    v_lshl_add_u32 v5, v3, 2, s4
    ds_read_b32 v56, v5 offset:0
    ds_read_b32 v57, v5 offset:64
    ds_read_b32 v58, v5 offset:128
    ds_read_b32 v59, v5 offset:192
    ds_read_b32 v60, v5 offset:256
    s_lshl_b32 s4, s11, 9
    s_add_u32 s4, s4, 56832
    v_lshl_add_u32 v95, v4, 4, s4
    v_cmp_gt_u32 s[54:55], 8, v3
    v_mov_b32 v61, 0x3f803f80
    s_nop 0
    v_cndmask_b32 v62, 0, 1.0, s[54:55]
    v_mov_b32 v63, v62
    ds_read_b128 v[32:35], v95 offset:0
    ds_read_b128 v[36:39], v95 offset:1024
    ds_read_b128 v[40:43], v95 offset:2048
    ds_read_b128 v[44:47], v95 offset:64
    ds_read_b128 v[48:51], v95 offset:1088
    ds_read_b128 v[52:55], v95 offset:2112
    ds_read_b128 v[4:7], v95 offset:128
    ds_read_b128 v[8:11], v95 offset:1152
    ds_read_b128 v[12:15], v95 offset:2176
    ds_read_b128 v[16:19], v95 offset:192
    ds_read_b128 v[20:23], v95 offset:1216
    ds_read_b128 v[24:27], v95 offset:2240
    s_waitcnt lgkmcnt(6)
    v_readfirstlane_b32 s58, v1
    s_cmp_lt_u32 s58, 4
    s_cbranch_scc1 g1_kv_ep
    v_pk_fma_f32 v[96:97], v[56:57], v[32:33], v[96:97] op_sel:[0,0,0] op_sel_hi:[0,1,1]
    v_pk_fma_f32 v[98:99], v[56:57], v[34:35], v[98:99] op_sel:[0,0,0] op_sel_hi:[0,1,1]
    v_pk_mul_f32 v[0:1], v[96:97], v[40:41]
    v_exp_f32 v0, v0 clamp
    v_exp_f32 v1, v1 clamp
    v_pk_fma_f32 v[96:97], v[96:97], v[36:37], s[52:53]
    v_pk_mul_f32 v[2:3], v[98:99], v[42:43]
    v_exp_f32 v2, v2 clamp
    v_exp_f32 v3, v3 clamp
    v_pk_fma_f32 v[98:99], v[98:99], v[38:39], s[52:53]
    v_max3_f32 v96, v96, v0, s50
    v_max3_f32 v97, v97, v1, s50
    v_max3_f32 v98, v98, v2, s50
    v_max3_f32 v99, v99, v3, s50
    v_cvt_pk_bf16_f32 v96, v96, v97
    v_cvt_pk_bf16_f32 v97, v98, v99
    v_pk_fma_f32 v[100:101], v[56:57], v[44:45], v[100:101] op_sel:[0,0,0] op_sel_hi:[0,1,1]
    v_pk_fma_f32 v[102:103], v[56:57], v[46:47], v[102:103] op_sel:[0,0,0] op_sel_hi:[0,1,1]
    v_pk_mul_f32 v[0:1], v[100:101], v[52:53]
    v_exp_f32 v0, v0 clamp
    v_exp_f32 v1, v1 clamp
    v_pk_fma_f32 v[100:101], v[100:101], v[48:49], s[52:53]
    v_pk_mul_f32 v[2:3], v[102:103], v[54:55]
    v_exp_f32 v2, v2 clamp
    v_exp_f32 v3, v3 clamp
    v_pk_fma_f32 v[102:103], v[102:103], v[50:51], s[52:53]
    v_max3_f32 v100, v100, v0, s50
    v_max3_f32 v101, v101, v1, s50
    v_max3_f32 v102, v102, v2, s50
    v_max3_f32 v103, v103, v3, s50
    v_cvt_pk_bf16_f32 v98, v100, v101
    v_cvt_pk_bf16_f32 v99, v102, v103
    v_pk_fma_f32 v[128:129], v[56:57], v[32:33], v[128:129] op_sel:[1,0,0] op_sel_hi:[1,1,1]
    v_pk_fma_f32 v[130:131], v[56:57], v[34:35], v[130:131] op_sel:[1,0,0] op_sel_hi:[1,1,1]
    v_pk_mul_f32 v[0:1], v[128:129], v[40:41]
    v_exp_f32 v0, v0 clamp
    v_exp_f32 v1, v1 clamp
    v_pk_fma_f32 v[128:129], v[128:129], v[36:37], s[52:53]
    v_pk_mul_f32 v[2:3], v[130:131], v[42:43]
    v_exp_f32 v2, v2 clamp
    v_exp_f32 v3, v3 clamp
    v_pk_fma_f32 v[130:131], v[130:131], v[38:39], s[52:53]
    v_max3_f32 v128, v128, v0, s50
    v_max3_f32 v129, v129, v1, s50
    v_max3_f32 v130, v130, v2, s50
    v_max3_f32 v131, v131, v3, s50
    v_cvt_pk_bf16_f32 v128, v128, v129
    v_cvt_pk_bf16_f32 v129, v130, v131
    v_pk_fma_f32 v[132:133], v[56:57], v[44:45], v[132:133] op_sel:[1,0,0] op_sel_hi:[1,1,1]
    v_pk_fma_f32 v[134:135], v[56:57], v[46:47], v[134:135] op_sel:[1,0,0] op_sel_hi:[1,1,1]
    v_pk_mul_f32 v[0:1], v[132:133], v[52:53]
    v_exp_f32 v0, v0 clamp
    v_exp_f32 v1, v1 clamp
    v_pk_fma_f32 v[132:133], v[132:133], v[48:49], s[52:53]
    v_pk_mul_f32 v[2:3], v[134:135], v[54:55]
    v_exp_f32 v2, v2 clamp
    v_exp_f32 v3, v3 clamp
    v_pk_fma_f32 v[134:135], v[134:135], v[50:51], s[52:53]
    v_max3_f32 v132, v132, v0, s50
    v_max3_f32 v133, v133, v1, s50
    v_max3_f32 v134, v134, v2, s50
    v_max3_f32 v135, v135, v3, s50
    v_cvt_pk_bf16_f32 v130, v132, v133
    v_cvt_pk_bf16_f32 v131, v134, v135
    v_pk_fma_f32 v[160:161], v[58:59], v[32:33], v[160:161] op_sel:[0,0,0] op_sel_hi:[0,1,1]
    v_pk_fma_f32 v[162:163], v[58:59], v[34:35], v[162:163] op_sel:[0,0,0] op_sel_hi:[0,1,1]
    v_pk_mul_f32 v[0:1], v[160:161], v[40:41]
    v_exp_f32 v0, v0 clamp
    v_exp_f32 v1, v1 clamp
    v_pk_fma_f32 v[160:161], v[160:161], v[36:37], v[62:63]
    v_pk_mul_f32 v[2:3], v[162:163], v[42:43]
    v_exp_f32 v2, v2 clamp
    v_exp_f32 v3, v3 clamp
    v_pk_fma_f32 v[162:163], v[162:163], v[38:39], v[62:63]
    v_max3_f32 v0, v160, v0, s50
    v_max3_f32 v1, v161, v1, s50
    v_max3_f32 v2, v162, v2, s50
    v_max3_f32 v3, v163, v3, s50
    v_cndmask_b32 v160, v160, v0, s[54:55]
    v_cndmask_b32 v161, v161, v1, s[54:55]
    v_cndmask_b32 v162, v162, v2, s[54:55]
    v_cndmask_b32 v163, v163, v3, s[54:55]
    v_cvt_pk_bf16_f32 v160, v160, v161
    v_cvt_pk_bf16_f32 v161, v162, v163
    v_pk_fma_f32 v[164:165], v[58:59], v[44:45], v[164:165] op_sel:[0,0,0] op_sel_hi:[0,1,1]
    v_pk_fma_f32 v[166:167], v[58:59], v[46:47], v[166:167] op_sel:[0,0,0] op_sel_hi:[0,1,1]
    v_pk_mul_f32 v[0:1], v[164:165], v[52:53]
    v_exp_f32 v0, v0 clamp
    v_exp_f32 v1, v1 clamp
    v_pk_fma_f32 v[164:165], v[164:165], v[48:49], v[62:63]
    v_pk_mul_f32 v[2:3], v[166:167], v[54:55]
    v_exp_f32 v2, v2 clamp
    v_exp_f32 v3, v3 clamp
    v_pk_fma_f32 v[166:167], v[166:167], v[50:51], v[62:63]
    v_max3_f32 v0, v164, v0, s50
    v_max3_f32 v1, v165, v1, s50
    v_max3_f32 v2, v166, v2, s50
    v_max3_f32 v3, v167, v3, s50
    v_cndmask_b32 v164, v164, v0, s[54:55]
    v_cndmask_b32 v165, v165, v1, s[54:55]
    v_cndmask_b32 v166, v166, v2, s[54:55]
    v_cndmask_b32 v167, v167, v3, s[54:55]
    v_cvt_pk_bf16_f32 v162, v164, v165
    v_cvt_pk_bf16_f32 v163, v166, v167
    v_cndmask_b32 v164, v160, v61, s[54:55]
    v_cndmask_b32 v165, v161, v61, s[54:55]
    v_cndmask_b32 v166, v162, v61, s[54:55]
    v_cndmask_b32 v167, v163, v61, s[54:55]
    v_pk_fma_f32 v[192:193], v[58:59], v[32:33], v[192:193] op_sel:[1,0,0] op_sel_hi:[1,1,1]
    v_pk_fma_f32 v[194:195], v[58:59], v[34:35], v[194:195] op_sel:[1,0,0] op_sel_hi:[1,1,1]
    v_pk_mul_f32 v[192:193], v[192:193], v[36:37]
    v_pk_mul_f32 v[194:195], v[194:195], v[38:39]
    v_cvt_pk_bf16_f32 v192, v192, v193
    v_cvt_pk_bf16_f32 v193, v194, v195
    v_pk_fma_f32 v[196:197], v[58:59], v[44:45], v[196:197] op_sel:[1,0,0] op_sel_hi:[1,1,1]
    v_pk_fma_f32 v[198:199], v[58:59], v[46:47], v[198:199] op_sel:[1,0,0] op_sel_hi:[1,1,1]
    v_pk_mul_f32 v[196:197], v[196:197], v[48:49]
    v_pk_mul_f32 v[198:199], v[198:199], v[50:51]
    v_cvt_pk_bf16_f32 v194, v196, v197
    v_cvt_pk_bf16_f32 v195, v198, v199
    v_pk_fma_f32 v[224:225], v[60:61], v[32:33], v[224:225] op_sel:[0,0,0] op_sel_hi:[0,1,1]
    v_pk_fma_f32 v[226:227], v[60:61], v[34:35], v[226:227] op_sel:[0,0,0] op_sel_hi:[0,1,1]
    v_pk_mul_f32 v[224:225], v[224:225], v[36:37]
    v_pk_mul_f32 v[226:227], v[226:227], v[38:39]
    v_cvt_pk_bf16_f32 v224, v224, v225
    v_cvt_pk_bf16_f32 v225, v226, v227
    v_pk_fma_f32 v[228:229], v[60:61], v[44:45], v[228:229] op_sel:[0,0,0] op_sel_hi:[0,1,1]
    v_pk_fma_f32 v[230:231], v[60:61], v[46:47], v[230:231] op_sel:[0,0,0] op_sel_hi:[0,1,1]
    v_pk_mul_f32 v[228:229], v[228:229], v[48:49]
    v_pk_mul_f32 v[230:231], v[230:231], v[50:51]
    v_cvt_pk_bf16_f32 v226, v228, v229
    v_cvt_pk_bf16_f32 v227, v230, v231
    ds_read_b128 v[32:35], v95 offset:256
    ds_read_b128 v[36:39], v95 offset:1280
    ds_read_b128 v[40:43], v95 offset:2304
    ds_read_b128 v[44:47], v95 offset:320
    ds_read_b128 v[48:51], v95 offset:1344
    ds_read_b128 v[52:55], v95 offset:2368
    s_waitcnt lgkmcnt(6)
    v_pk_fma_f32 v[104:105], v[56:57], v[4:5], v[104:105] op_sel:[0,0,0] op_sel_hi:[0,1,1]
    v_pk_fma_f32 v[106:107], v[56:57], v[6:7], v[106:107] op_sel:[0,0,0] op_sel_hi:[0,1,1]
    v_pk_mul_f32 v[0:1], v[104:105], v[12:13]
    v_exp_f32 v0, v0 clamp
    v_exp_f32 v1, v1 clamp
    v_mfma_f32_16x16x32_bf16 v[64:67], v[96:99], v[192:195], 0
    v_pk_fma_f32 v[104:105], v[104:105], v[8:9], s[52:53]
    v_pk_mul_f32 v[2:3], v[106:107], v[14:15]
    v_exp_f32 v2, v2 clamp
    v_exp_f32 v3, v3 clamp
    v_pk_fma_f32 v[106:107], v[106:107], v[10:11], s[52:53]
    v_max3_f32 v104, v104, v0, s50
    v_max3_f32 v105, v105, v1, s50
    v_max3_f32 v106, v106, v2, s50
    v_max3_f32 v107, v107, v3, s50
    v_cvt_pk_bf16_f32 v104, v104, v105
    v_cvt_pk_bf16_f32 v105, v106, v107
    v_pk_fma_f32 v[108:109], v[56:57], v[16:17], v[108:109] op_sel:[0,0,0] op_sel_hi:[0,1,1]
    v_mfma_f32_16x16x32_bf16 v[68:71], v[128:131], v[224:227], 0
    v_pk_fma_f32 v[110:111], v[56:57], v[18:19], v[110:111] op_sel:[0,0,0] op_sel_hi:[0,1,1]
    v_pk_mul_f32 v[0:1], v[108:109], v[24:25]
    v_exp_f32 v0, v0 clamp
    v_exp_f32 v1, v1 clamp
    v_pk_fma_f32 v[108:109], v[108:109], v[20:21], s[52:53]
    v_pk_mul_f32 v[2:3], v[110:111], v[26:27]
    v_exp_f32 v2, v2 clamp
    v_exp_f32 v3, v3 clamp
    v_pk_fma_f32 v[110:111], v[110:111], v[22:23], s[52:53]
    v_max3_f32 v108, v108, v0, s50
    v_max3_f32 v109, v109, v1, s50
    v_max3_f32 v110, v110, v2, s50
    v_mfma_f32_16x16x32_bf16 v[72:75], v[96:99], v[164:167], 0
    v_max3_f32 v111, v111, v3, s50
    v_cvt_pk_bf16_f32 v106, v108, v109
    v_cvt_pk_bf16_f32 v107, v110, v111
    v_pk_fma_f32 v[136:137], v[56:57], v[4:5], v[136:137] op_sel:[1,0,0] op_sel_hi:[1,1,1]
    v_pk_fma_f32 v[138:139], v[56:57], v[6:7], v[138:139] op_sel:[1,0,0] op_sel_hi:[1,1,1]
    v_pk_mul_f32 v[0:1], v[136:137], v[12:13]
    v_exp_f32 v0, v0 clamp
    v_exp_f32 v1, v1 clamp
    v_pk_fma_f32 v[136:137], v[136:137], v[8:9], s[52:53]
    v_pk_mul_f32 v[2:3], v[138:139], v[14:15]
    v_exp_f32 v2, v2 clamp
    v_exp_f32 v3, v3 clamp
    v_mfma_f32_16x16x32_bf16 v[76:79], v[128:131], v[164:167], 0
    v_pk_fma_f32 v[138:139], v[138:139], v[10:11], s[52:53]
    v_max3_f32 v136, v136, v0, s50
    v_max3_f32 v137, v137, v1, s50
    v_max3_f32 v138, v138, v2, s50
    v_max3_f32 v139, v139, v3, s50
    v_cvt_pk_bf16_f32 v136, v136, v137
    v_cvt_pk_bf16_f32 v137, v138, v139
    v_pk_fma_f32 v[140:141], v[56:57], v[16:17], v[140:141] op_sel:[1,0,0] op_sel_hi:[1,1,1]
    v_pk_fma_f32 v[142:143], v[56:57], v[18:19], v[142:143] op_sel:[1,0,0] op_sel_hi:[1,1,1]
    v_pk_mul_f32 v[0:1], v[140:141], v[24:25]
    v_exp_f32 v0, v0 clamp
    v_exp_f32 v1, v1 clamp
    v_mfma_f32_16x16x32_bf16 v[80:83], v[160:163], v[192:195], 0
    v_pk_fma_f32 v[140:141], v[140:141], v[20:21], s[52:53]
    v_pk_mul_f32 v[2:3], v[142:143], v[26:27]
    v_exp_f32 v2, v2 clamp
    v_exp_f32 v3, v3 clamp
    v_pk_fma_f32 v[142:143], v[142:143], v[22:23], s[52:53]
    v_max3_f32 v140, v140, v0, s50
    v_max3_f32 v141, v141, v1, s50
    v_max3_f32 v142, v142, v2, s50
    v_max3_f32 v143, v143, v3, s50
    v_cvt_pk_bf16_f32 v138, v140, v141
    v_cvt_pk_bf16_f32 v139, v142, v143
    v_pk_fma_f32 v[168:169], v[58:59], v[4:5], v[168:169] op_sel:[0,0,0] op_sel_hi:[0,1,1]
    v_mfma_f32_16x16x32_bf16 v[84:87], v[160:163], v[224:227], 0
    v_pk_fma_f32 v[170:171], v[58:59], v[6:7], v[170:171] op_sel:[0,0,0] op_sel_hi:[0,1,1]
    v_pk_mul_f32 v[0:1], v[168:169], v[12:13]
    v_exp_f32 v0, v0 clamp
    v_exp_f32 v1, v1 clamp
    v_pk_fma_f32 v[168:169], v[168:169], v[8:9], v[62:63]
    v_pk_mul_f32 v[2:3], v[170:171], v[14:15]
    v_exp_f32 v2, v2 clamp
    v_exp_f32 v3, v3 clamp
    v_pk_fma_f32 v[170:171], v[170:171], v[10:11], v[62:63]
    v_max3_f32 v0, v168, v0, s50
    v_max3_f32 v1, v169, v1, s50
    v_max3_f32 v2, v170, v2, s50
    v_mfma_f32_16x16x32_bf16 v[88:91], v[160:163], v[164:167], 0
    v_max3_f32 v3, v171, v3, s50
    v_cndmask_b32 v168, v168, v0, s[54:55]
    v_cndmask_b32 v169, v169, v1, s[54:55]
    v_cndmask_b32 v170, v170, v2, s[54:55]
    v_cndmask_b32 v171, v171, v3, s[54:55]
    v_cvt_pk_bf16_f32 v168, v168, v169
    v_cvt_pk_bf16_f32 v169, v170, v171
    v_pk_fma_f32 v[172:173], v[58:59], v[16:17], v[172:173] op_sel:[0,0,0] op_sel_hi:[0,1,1]
    v_pk_fma_f32 v[174:175], v[58:59], v[18:19], v[174:175] op_sel:[0,0,0] op_sel_hi:[0,1,1]
    v_pk_mul_f32 v[0:1], v[172:173], v[24:25]
    v_exp_f32 v0, v0 clamp
    v_exp_f32 v1, v1 clamp
    v_pk_fma_f32 v[172:173], v[172:173], v[20:21], v[62:63]
    v_pk_mul_f32 v[2:3], v[174:175], v[26:27]
    v_exp_f32 v2, v2 clamp
    v_exp_f32 v3, v3 clamp
    v_pk_fma_f32 v[174:175], v[174:175], v[22:23], v[62:63]
    v_max3_f32 v0, v172, v0, s50
    v_max3_f32 v1, v173, v1, s50
    v_max3_f32 v2, v174, v2, s50
    v_max3_f32 v3, v175, v3, s50
    v_cndmask_b32 v172, v172, v0, s[54:55]
    v_cndmask_b32 v173, v173, v1, s[54:55]
    v_cndmask_b32 v174, v174, v2, s[54:55]
    v_cndmask_b32 v175, v175, v3, s[54:55]
    v_cvt_pk_bf16_f32 v170, v172, v173
    v_cvt_pk_bf16_f32 v171, v174, v175
    v_cndmask_b32 v172, v168, v61, s[54:55]
    v_cndmask_b32 v173, v169, v61, s[54:55]
    v_cndmask_b32 v174, v170, v61, s[54:55]
    v_cndmask_b32 v175, v171, v61, s[54:55]
    v_pk_fma_f32 v[200:201], v[58:59], v[4:5], v[200:201] op_sel:[1,0,0] op_sel_hi:[1,1,1]
    v_pk_fma_f32 v[202:203], v[58:59], v[6:7], v[202:203] op_sel:[1,0,0] op_sel_hi:[1,1,1]
    v_pk_mul_f32 v[200:201], v[200:201], v[8:9]
    v_pk_mul_f32 v[202:203], v[202:203], v[10:11]
    v_cvt_pk_bf16_f32 v200, v200, v201
    v_cvt_pk_bf16_f32 v201, v202, v203
    v_pk_fma_f32 v[204:205], v[58:59], v[16:17], v[204:205] op_sel:[1,0,0] op_sel_hi:[1,1,1]
    v_pk_fma_f32 v[206:207], v[58:59], v[18:19], v[206:207] op_sel:[1,0,0] op_sel_hi:[1,1,1]
    v_pk_mul_f32 v[204:205], v[204:205], v[20:21]
    v_pk_mul_f32 v[206:207], v[206:207], v[22:23]
    v_cvt_pk_bf16_f32 v202, v204, v205
    v_cvt_pk_bf16_f32 v203, v206, v207
    v_pk_fma_f32 v[232:233], v[60:61], v[4:5], v[232:233] op_sel:[0,0,0] op_sel_hi:[0,1,1]
    v_pk_fma_f32 v[234:235], v[60:61], v[6:7], v[234:235] op_sel:[0,0,0] op_sel_hi:[0,1,1]
    v_pk_mul_f32 v[232:233], v[232:233], v[8:9]
    v_pk_mul_f32 v[234:235], v[234:235], v[10:11]
    v_cvt_pk_bf16_f32 v232, v232, v233
    v_cvt_pk_bf16_f32 v233, v234, v235
    v_pk_fma_f32 v[236:237], v[60:61], v[16:17], v[236:237] op_sel:[0,0,0] op_sel_hi:[0,1,1]
    v_pk_fma_f32 v[238:239], v[60:61], v[18:19], v[238:239] op_sel:[0,0,0] op_sel_hi:[0,1,1]
    v_pk_mul_f32 v[236:237], v[236:237], v[20:21]
    v_pk_mul_f32 v[238:239], v[238:239], v[22:23]
    v_cvt_pk_bf16_f32 v234, v236, v237
    v_cvt_pk_bf16_f32 v235, v238, v239
    ds_read_b128 v[4:7], v95 offset:384
    ds_read_b128 v[8:11], v95 offset:1408
    ds_read_b128 v[12:15], v95 offset:2432
    ds_read_b128 v[16:19], v95 offset:448
    ds_read_b128 v[20:23], v95 offset:1472
    ds_read_b128 v[24:27], v95 offset:2496
    s_waitcnt lgkmcnt(6)
    v_pk_fma_f32 v[112:113], v[56:57], v[32:33], v[112:113] op_sel:[0,0,0] op_sel_hi:[0,1,1]
    v_pk_fma_f32 v[114:115], v[56:57], v[34:35], v[114:115] op_sel:[0,0,0] op_sel_hi:[0,1,1]
    v_pk_mul_f32 v[0:1], v[112:113], v[40:41]
    v_exp_f32 v0, v0 clamp
    v_exp_f32 v1, v1 clamp
    v_mfma_f32_16x16x32_bf16 v[64:67], v[104:107], v[200:203], v[64:67]
    v_pk_fma_f32 v[112:113], v[112:113], v[36:37], s[52:53]
    v_pk_mul_f32 v[2:3], v[114:115], v[42:43]
    v_exp_f32 v2, v2 clamp
    v_exp_f32 v3, v3 clamp
    v_pk_fma_f32 v[114:115], v[114:115], v[38:39], s[52:53]
    v_max3_f32 v112, v112, v0, s50
    v_max3_f32 v113, v113, v1, s50
    v_max3_f32 v114, v114, v2, s50
    v_max3_f32 v115, v115, v3, s50
    v_cvt_pk_bf16_f32 v112, v112, v113
    v_cvt_pk_bf16_f32 v113, v114, v115
    v_pk_fma_f32 v[116:117], v[56:57], v[44:45], v[116:117] op_sel:[0,0,0] op_sel_hi:[0,1,1]
    v_mfma_f32_16x16x32_bf16 v[68:71], v[136:139], v[232:235], v[68:71]
    v_pk_fma_f32 v[118:119], v[56:57], v[46:47], v[118:119] op_sel:[0,0,0] op_sel_hi:[0,1,1]
    v_pk_mul_f32 v[0:1], v[116:117], v[52:53]
    v_exp_f32 v0, v0 clamp
    v_exp_f32 v1, v1 clamp
    v_pk_fma_f32 v[116:117], v[116:117], v[48:49], s[52:53]
    v_pk_mul_f32 v[2:3], v[118:119], v[54:55]
    v_exp_f32 v2, v2 clamp
    v_exp_f32 v3, v3 clamp
    v_pk_fma_f32 v[118:119], v[118:119], v[50:51], s[52:53]
    v_max3_f32 v116, v116, v0, s50
    v_max3_f32 v117, v117, v1, s50
    v_max3_f32 v118, v118, v2, s50
    v_mfma_f32_16x16x32_bf16 v[72:75], v[104:107], v[172:175], v[72:75]
    v_max3_f32 v119, v119, v3, s50
    v_cvt_pk_bf16_f32 v114, v116, v117
    v_cvt_pk_bf16_f32 v115, v118, v119
    v_pk_fma_f32 v[144:145], v[56:57], v[32:33], v[144:145] op_sel:[1,0,0] op_sel_hi:[1,1,1]
    v_pk_fma_f32 v[146:147], v[56:57], v[34:35], v[146:147] op_sel:[1,0,0] op_sel_hi:[1,1,1]
    v_pk_mul_f32 v[0:1], v[144:145], v[40:41]
    v_exp_f32 v0, v0 clamp
    v_exp_f32 v1, v1 clamp
    v_pk_fma_f32 v[144:145], v[144:145], v[36:37], s[52:53]
    v_pk_mul_f32 v[2:3], v[146:147], v[42:43]
    v_exp_f32 v2, v2 clamp
    v_exp_f32 v3, v3 clamp
    v_mfma_f32_16x16x32_bf16 v[76:79], v[136:139], v[172:175], v[76:79]
    v_pk_fma_f32 v[146:147], v[146:147], v[38:39], s[52:53]
    v_max3_f32 v144, v144, v0, s50
    v_max3_f32 v145, v145, v1, s50
    v_max3_f32 v146, v146, v2, s50
    v_max3_f32 v147, v147, v3, s50
    v_cvt_pk_bf16_f32 v144, v144, v145
    v_cvt_pk_bf16_f32 v145, v146, v147
    v_pk_fma_f32 v[148:149], v[56:57], v[44:45], v[148:149] op_sel:[1,0,0] op_sel_hi:[1,1,1]
    v_pk_fma_f32 v[150:151], v[56:57], v[46:47], v[150:151] op_sel:[1,0,0] op_sel_hi:[1,1,1]
    v_pk_mul_f32 v[0:1], v[148:149], v[52:53]
    v_exp_f32 v0, v0 clamp
    v_exp_f32 v1, v1 clamp
    v_mfma_f32_16x16x32_bf16 v[80:83], v[168:171], v[200:203], v[80:83]
    v_pk_fma_f32 v[148:149], v[148:149], v[48:49], s[52:53]
    v_pk_mul_f32 v[2:3], v[150:151], v[54:55]
    v_exp_f32 v2, v2 clamp
    v_exp_f32 v3, v3 clamp
    v_pk_fma_f32 v[150:151], v[150:151], v[50:51], s[52:53]
    v_max3_f32 v148, v148, v0, s50
    v_max3_f32 v149, v149, v1, s50
    v_max3_f32 v150, v150, v2, s50
    v_max3_f32 v151, v151, v3, s50
    v_cvt_pk_bf16_f32 v146, v148, v149
    v_cvt_pk_bf16_f32 v147, v150, v151
    v_pk_fma_f32 v[176:177], v[58:59], v[32:33], v[176:177] op_sel:[0,0,0] op_sel_hi:[0,1,1]
    v_mfma_f32_16x16x32_bf16 v[84:87], v[168:171], v[232:235], v[84:87]
    v_pk_fma_f32 v[178:179], v[58:59], v[34:35], v[178:179] op_sel:[0,0,0] op_sel_hi:[0,1,1]
    v_pk_mul_f32 v[0:1], v[176:177], v[40:41]
    v_exp_f32 v0, v0 clamp
    v_exp_f32 v1, v1 clamp
    v_pk_fma_f32 v[176:177], v[176:177], v[36:37], v[62:63]
    v_pk_mul_f32 v[2:3], v[178:179], v[42:43]
    v_exp_f32 v2, v2 clamp
    v_exp_f32 v3, v3 clamp
    v_pk_fma_f32 v[178:179], v[178:179], v[38:39], v[62:63]
    v_max3_f32 v0, v176, v0, s50
    v_max3_f32 v1, v177, v1, s50
    v_max3_f32 v2, v178, v2, s50
    v_mfma_f32_16x16x32_bf16 v[88:91], v[168:171], v[172:175], v[88:91]
    v_max3_f32 v3, v179, v3, s50
    v_cndmask_b32 v176, v176, v0, s[54:55]
    v_cndmask_b32 v177, v177, v1, s[54:55]
    v_cndmask_b32 v178, v178, v2, s[54:55]
    v_cndmask_b32 v179, v179, v3, s[54:55]
    v_cvt_pk_bf16_f32 v176, v176, v177
    v_cvt_pk_bf16_f32 v177, v178, v179
    v_pk_fma_f32 v[180:181], v[58:59], v[44:45], v[180:181] op_sel:[0,0,0] op_sel_hi:[0,1,1]
    v_pk_fma_f32 v[182:183], v[58:59], v[46:47], v[182:183] op_sel:[0,0,0] op_sel_hi:[0,1,1]
    v_pk_mul_f32 v[0:1], v[180:181], v[52:53]
    v_exp_f32 v0, v0 clamp
    v_exp_f32 v1, v1 clamp
    v_pk_fma_f32 v[180:181], v[180:181], v[48:49], v[62:63]
    v_pk_mul_f32 v[2:3], v[182:183], v[54:55]
    v_exp_f32 v2, v2 clamp
    v_exp_f32 v3, v3 clamp
    v_pk_fma_f32 v[182:183], v[182:183], v[50:51], v[62:63]
    v_max3_f32 v0, v180, v0, s50
    v_max3_f32 v1, v181, v1, s50
    v_max3_f32 v2, v182, v2, s50
    v_max3_f32 v3, v183, v3, s50
    v_cndmask_b32 v180, v180, v0, s[54:55]
    v_cndmask_b32 v181, v181, v1, s[54:55]
    v_cndmask_b32 v182, v182, v2, s[54:55]
    v_cndmask_b32 v183, v183, v3, s[54:55]
    v_cvt_pk_bf16_f32 v178, v180, v181
    v_cvt_pk_bf16_f32 v179, v182, v183
    v_cndmask_b32 v180, v176, v61, s[54:55]
    v_cndmask_b32 v181, v177, v61, s[54:55]
    v_cndmask_b32 v182, v178, v61, s[54:55]
    v_cndmask_b32 v183, v179, v61, s[54:55]
    v_pk_fma_f32 v[208:209], v[58:59], v[32:33], v[208:209] op_sel:[1,0,0] op_sel_hi:[1,1,1]
    v_pk_fma_f32 v[210:211], v[58:59], v[34:35], v[210:211] op_sel:[1,0,0] op_sel_hi:[1,1,1]
    v_pk_mul_f32 v[208:209], v[208:209], v[36:37]
    v_pk_mul_f32 v[210:211], v[210:211], v[38:39]
    v_cvt_pk_bf16_f32 v208, v208, v209
    v_cvt_pk_bf16_f32 v209, v210, v211
    v_pk_fma_f32 v[212:213], v[58:59], v[44:45], v[212:213] op_sel:[1,0,0] op_sel_hi:[1,1,1]
    v_pk_fma_f32 v[214:215], v[58:59], v[46:47], v[214:215] op_sel:[1,0,0] op_sel_hi:[1,1,1]
    v_pk_mul_f32 v[212:213], v[212:213], v[48:49]
    v_pk_mul_f32 v[214:215], v[214:215], v[50:51]
    v_cvt_pk_bf16_f32 v210, v212, v213
    v_cvt_pk_bf16_f32 v211, v214, v215
    v_pk_fma_f32 v[240:241], v[60:61], v[32:33], v[240:241] op_sel:[0,0,0] op_sel_hi:[0,1,1]
    v_pk_fma_f32 v[242:243], v[60:61], v[34:35], v[242:243] op_sel:[0,0,0] op_sel_hi:[0,1,1]
    v_pk_mul_f32 v[240:241], v[240:241], v[36:37]
    v_pk_mul_f32 v[242:243], v[242:243], v[38:39]
    v_cvt_pk_bf16_f32 v240, v240, v241
    v_cvt_pk_bf16_f32 v241, v242, v243
    v_pk_fma_f32 v[244:245], v[60:61], v[44:45], v[244:245] op_sel:[0,0,0] op_sel_hi:[0,1,1]
    v_pk_fma_f32 v[246:247], v[60:61], v[46:47], v[246:247] op_sel:[0,0,0] op_sel_hi:[0,1,1]
    v_pk_mul_f32 v[244:245], v[244:245], v[48:49]
    v_pk_mul_f32 v[246:247], v[246:247], v[50:51]
    v_cvt_pk_bf16_f32 v242, v244, v245
    v_cvt_pk_bf16_f32 v243, v246, v247
    s_waitcnt lgkmcnt(0)
    v_pk_fma_f32 v[120:121], v[56:57], v[4:5], v[120:121] op_sel:[0,0,0] op_sel_hi:[0,1,1]
    v_pk_fma_f32 v[122:123], v[56:57], v[6:7], v[122:123] op_sel:[0,0,0] op_sel_hi:[0,1,1]
    v_pk_mul_f32 v[0:1], v[120:121], v[12:13]
    v_exp_f32 v0, v0 clamp
    v_exp_f32 v1, v1 clamp
    v_mfma_f32_16x16x32_bf16 v[64:67], v[112:115], v[208:211], v[64:67]
    v_pk_fma_f32 v[120:121], v[120:121], v[8:9], s[52:53]
    v_pk_mul_f32 v[2:3], v[122:123], v[14:15]
    v_exp_f32 v2, v2 clamp
    v_exp_f32 v3, v3 clamp
    v_pk_fma_f32 v[122:123], v[122:123], v[10:11], s[52:53]
    v_max3_f32 v120, v120, v0, s50
    v_max3_f32 v121, v121, v1, s50
    v_max3_f32 v122, v122, v2, s50
    v_max3_f32 v123, v123, v3, s50
    v_cvt_pk_bf16_f32 v120, v120, v121
    v_cvt_pk_bf16_f32 v121, v122, v123
    v_pk_fma_f32 v[124:125], v[56:57], v[16:17], v[124:125] op_sel:[0,0,0] op_sel_hi:[0,1,1]
    v_mfma_f32_16x16x32_bf16 v[68:71], v[144:147], v[240:243], v[68:71]
    v_pk_fma_f32 v[126:127], v[56:57], v[18:19], v[126:127] op_sel:[0,0,0] op_sel_hi:[0,1,1]
    v_pk_mul_f32 v[0:1], v[124:125], v[24:25]
    v_exp_f32 v0, v0 clamp
    v_exp_f32 v1, v1 clamp
    v_pk_fma_f32 v[124:125], v[124:125], v[20:21], s[52:53]
    v_pk_mul_f32 v[2:3], v[126:127], v[26:27]
    v_exp_f32 v2, v2 clamp
    v_exp_f32 v3, v3 clamp
    v_pk_fma_f32 v[126:127], v[126:127], v[22:23], s[52:53]
    v_max3_f32 v124, v124, v0, s50
    v_max3_f32 v125, v125, v1, s50
    v_max3_f32 v126, v126, v2, s50
    v_mfma_f32_16x16x32_bf16 v[72:75], v[112:115], v[180:183], v[72:75]
    v_max3_f32 v127, v127, v3, s50
    v_cvt_pk_bf16_f32 v122, v124, v125
    v_cvt_pk_bf16_f32 v123, v126, v127
    v_pk_fma_f32 v[152:153], v[56:57], v[4:5], v[152:153] op_sel:[1,0,0] op_sel_hi:[1,1,1]
    v_pk_fma_f32 v[154:155], v[56:57], v[6:7], v[154:155] op_sel:[1,0,0] op_sel_hi:[1,1,1]
    v_pk_mul_f32 v[0:1], v[152:153], v[12:13]
    v_exp_f32 v0, v0 clamp
    v_exp_f32 v1, v1 clamp
    v_pk_fma_f32 v[152:153], v[152:153], v[8:9], s[52:53]
    v_pk_mul_f32 v[2:3], v[154:155], v[14:15]
    v_exp_f32 v2, v2 clamp
    v_exp_f32 v3, v3 clamp
    v_mfma_f32_16x16x32_bf16 v[76:79], v[144:147], v[180:183], v[76:79]
    v_pk_fma_f32 v[154:155], v[154:155], v[10:11], s[52:53]
    v_max3_f32 v152, v152, v0, s50
    v_max3_f32 v153, v153, v1, s50
    v_max3_f32 v154, v154, v2, s50
    v_max3_f32 v155, v155, v3, s50
    v_cvt_pk_bf16_f32 v152, v152, v153
    v_cvt_pk_bf16_f32 v153, v154, v155
    v_pk_fma_f32 v[156:157], v[56:57], v[16:17], v[156:157] op_sel:[1,0,0] op_sel_hi:[1,1,1]
    v_pk_fma_f32 v[158:159], v[56:57], v[18:19], v[158:159] op_sel:[1,0,0] op_sel_hi:[1,1,1]
    v_pk_mul_f32 v[0:1], v[156:157], v[24:25]
    v_exp_f32 v0, v0 clamp
    v_exp_f32 v1, v1 clamp
    v_mfma_f32_16x16x32_bf16 v[80:83], v[176:179], v[208:211], v[80:83]
    v_pk_fma_f32 v[156:157], v[156:157], v[20:21], s[52:53]
    v_pk_mul_f32 v[2:3], v[158:159], v[26:27]
    v_exp_f32 v2, v2 clamp
    v_exp_f32 v3, v3 clamp
    v_pk_fma_f32 v[158:159], v[158:159], v[22:23], s[52:53]
    v_max3_f32 v156, v156, v0, s50
    v_max3_f32 v157, v157, v1, s50
    v_max3_f32 v158, v158, v2, s50
    v_max3_f32 v159, v159, v3, s50
    v_cvt_pk_bf16_f32 v154, v156, v157
    v_cvt_pk_bf16_f32 v155, v158, v159
    v_pk_fma_f32 v[184:185], v[58:59], v[4:5], v[184:185] op_sel:[0,0,0] op_sel_hi:[0,1,1]
    v_mfma_f32_16x16x32_bf16 v[84:87], v[176:179], v[240:243], v[84:87]
    v_pk_fma_f32 v[186:187], v[58:59], v[6:7], v[186:187] op_sel:[0,0,0] op_sel_hi:[0,1,1]
    v_pk_mul_f32 v[0:1], v[184:185], v[12:13]
    v_exp_f32 v0, v0 clamp
    v_exp_f32 v1, v1 clamp
    v_pk_fma_f32 v[184:185], v[184:185], v[8:9], v[62:63]
    v_pk_mul_f32 v[2:3], v[186:187], v[14:15]
    v_exp_f32 v2, v2 clamp
    v_exp_f32 v3, v3 clamp
    v_pk_fma_f32 v[186:187], v[186:187], v[10:11], v[62:63]
    v_max3_f32 v0, v184, v0, s50
    v_max3_f32 v1, v185, v1, s50
    v_max3_f32 v2, v186, v2, s50
    v_mfma_f32_16x16x32_bf16 v[88:91], v[176:179], v[180:183], v[88:91]
    v_max3_f32 v3, v187, v3, s50
    v_cndmask_b32 v184, v184, v0, s[54:55]
    v_cndmask_b32 v185, v185, v1, s[54:55]
    v_cndmask_b32 v186, v186, v2, s[54:55]
    v_cndmask_b32 v187, v187, v3, s[54:55]
    v_cvt_pk_bf16_f32 v184, v184, v185
    v_cvt_pk_bf16_f32 v185, v186, v187
    v_pk_fma_f32 v[188:189], v[58:59], v[16:17], v[188:189] op_sel:[0,0,0] op_sel_hi:[0,1,1]
    v_pk_fma_f32 v[190:191], v[58:59], v[18:19], v[190:191] op_sel:[0,0,0] op_sel_hi:[0,1,1]
    v_pk_mul_f32 v[0:1], v[188:189], v[24:25]
    v_exp_f32 v0, v0 clamp
    v_exp_f32 v1, v1 clamp
    v_pk_fma_f32 v[188:189], v[188:189], v[20:21], v[62:63]
    v_pk_mul_f32 v[2:3], v[190:191], v[26:27]
    v_exp_f32 v2, v2 clamp
    v_exp_f32 v3, v3 clamp
    v_pk_fma_f32 v[190:191], v[190:191], v[22:23], v[62:63]
    v_max3_f32 v0, v188, v0, s50
    v_max3_f32 v1, v189, v1, s50
    v_max3_f32 v2, v190, v2, s50
    v_max3_f32 v3, v191, v3, s50
    v_cndmask_b32 v188, v188, v0, s[54:55]
    v_cndmask_b32 v189, v189, v1, s[54:55]
    v_cndmask_b32 v190, v190, v2, s[54:55]
    v_cndmask_b32 v191, v191, v3, s[54:55]
    v_cvt_pk_bf16_f32 v186, v188, v189
    v_cvt_pk_bf16_f32 v187, v190, v191
    v_cndmask_b32 v188, v184, v61, s[54:55]
    v_cndmask_b32 v189, v185, v61, s[54:55]
    v_cndmask_b32 v190, v186, v61, s[54:55]
    v_cndmask_b32 v191, v187, v61, s[54:55]
    v_pk_fma_f32 v[216:217], v[58:59], v[4:5], v[216:217] op_sel:[1,0,0] op_sel_hi:[1,1,1]
    v_pk_fma_f32 v[218:219], v[58:59], v[6:7], v[218:219] op_sel:[1,0,0] op_sel_hi:[1,1,1]
    v_pk_mul_f32 v[216:217], v[216:217], v[8:9]
    v_pk_mul_f32 v[218:219], v[218:219], v[10:11]
    v_cvt_pk_bf16_f32 v216, v216, v217
    v_cvt_pk_bf16_f32 v217, v218, v219
    v_pk_fma_f32 v[220:221], v[58:59], v[16:17], v[220:221] op_sel:[1,0,0] op_sel_hi:[1,1,1]
    v_pk_fma_f32 v[222:223], v[58:59], v[18:19], v[222:223] op_sel:[1,0,0] op_sel_hi:[1,1,1]
    v_pk_mul_f32 v[220:221], v[220:221], v[20:21]
    v_pk_mul_f32 v[222:223], v[222:223], v[22:23]
    v_cvt_pk_bf16_f32 v218, v220, v221
    v_cvt_pk_bf16_f32 v219, v222, v223
    v_pk_fma_f32 v[248:249], v[60:61], v[4:5], v[248:249] op_sel:[0,0,0] op_sel_hi:[0,1,1]
    v_pk_fma_f32 v[250:251], v[60:61], v[6:7], v[250:251] op_sel:[0,0,0] op_sel_hi:[0,1,1]
    v_pk_mul_f32 v[248:249], v[248:249], v[8:9]
    v_pk_mul_f32 v[250:251], v[250:251], v[10:11]
    v_cvt_pk_bf16_f32 v248, v248, v249
    v_cvt_pk_bf16_f32 v249, v250, v251
    v_pk_fma_f32 v[252:253], v[60:61], v[16:17], v[252:253] op_sel:[0,0,0] op_sel_hi:[0,1,1]
    v_pk_fma_f32 v[254:255], v[60:61], v[18:19], v[254:255] op_sel:[0,0,0] op_sel_hi:[0,1,1]
    v_pk_mul_f32 v[252:253], v[252:253], v[20:21]
    v_pk_mul_f32 v[254:255], v[254:255], v[22:23]
    v_cvt_pk_bf16_f32 v250, v252, v253
    v_cvt_pk_bf16_f32 v251, v254, v255
    s_nop 1
    v_mfma_f32_16x16x32_bf16 v[64:67], v[120:123], v[216:219], v[64:67]
    v_mfma_f32_16x16x32_bf16 v[68:71], v[152:155], v[248:251], v[68:71]
    v_mfma_f32_16x16x32_bf16 v[72:75], v[120:123], v[188:191], v[72:75]
    v_mfma_f32_16x16x32_bf16 v[76:79], v[152:155], v[188:191], v[76:79]
    v_mfma_f32_16x16x32_bf16 v[80:83], v[184:187], v[216:219], v[80:83]
    v_mfma_f32_16x16x32_bf16 v[84:87], v[184:187], v[248:251], v[84:87]
    v_mfma_f32_16x16x32_bf16 v[88:91], v[184:187], v[188:191], v[88:91]
    v_mbcnt_lo_u32_b32 v2, -1, 0
    v_mbcnt_hi_u32_b32 v2, -1, v2
    v_mov_b32 v9, 0x7ff00000
    v_lshlrev_b32 v10, 2, v2
    v_cmp_gt_u32 vcc, 18, v2
    v_add_u32 v11, 256, v10
    v_add_u32 v12, 512, v10
    v_add_u32 v13, 768, v10
    v_cndmask_b32 v13, v9, v13, vcc
    ds_write_b128 v28, v[64:67]
    ds_write_b128 v29, v[68:71]
    ds_write_b128 v30, v[72:75]
    ds_write_b128 v31, v[76:79]
    ds_write_b128 v92, v[80:83]
    ds_write_b128 v93, v[84:87]
    ds_write_b128 v94, v[88:91]
    v_mov_b32 v6, 61312
    v_mov_b32 v7, 1
    s_mov_b64 exec, 1
    ds_add_u32 v6, v7
    s_mov_b64 exec, -1
    s_mul_i32 s4, s9, 1696
    v_add_u32 v5, s4, v10
    s_lshl_b32 s5, s9, 2
    s_add_u32 s5, s5, 59904
    v_mov_b32 v8, s5
    ds_read_b32 v28, v8
    s_add_u32 s44, s34, 11288576
    s_addc_u32 s45, s35, 0
    s_and_b32 s45, s45, 0xffff
    s_mov_b32 s46, 65536
    s_mov_b32 s47, 0x00020000
    s_lshl_b32 s4, s7, 2
    s_add_u32 s13, s4, s9
    s_lshl_b32 s4, s13, 11
g1_kv_spin:
    ds_read_b32 v7, v6 offset:0
    s_waitcnt lgkmcnt(0)
    v_readfirstlane_b32 s5, v7
    s_cmp_lt_u32 s5, 4
    s_cbranch_scc1 g1_kv_spin
    ds_read_b32 v32, v5 offset:40960
    ds_read_b32 v40, v5 offset:47744
    ds_read_b32 v33, v5 offset:41216
    ds_read_b32 v41, v5 offset:48000
    ds_read_b32 v34, v5 offset:41472
    ds_read_b32 v42, v5 offset:48256
    ds_read_b32 v35, v5 offset:41728
    ds_read_b32 v43, v5 offset:48512
    ds_read_b32 v36, v5 offset:41800
    ds_read_b32 v44, v5 offset:48584
    ds_read_b32 v37, v5 offset:42056
    ds_read_b32 v45, v5 offset:48840
    ds_read_b32 v38, v5 offset:42312
    ds_read_b32 v46, v5 offset:49096
    ds_read_b32 v39, v5 offset:42568
    ds_read_b32 v47, v5 offset:49352
    v_readfirstlane_b32 s5, v28
    s_waitcnt lgkmcnt(8)
    v_add_f32 v32, v32, v40
    v_add_f32 v33, v33, v41
    v_add_f32 v34, v34, v42
    v_add_f32 v35, v35, v43
    s_waitcnt lgkmcnt(0)
    v_add_f32 v36, v36, v44
    v_add_f32 v37, v37, v45
    v_add_f32 v38, v38, v46
    v_add_f32 v39, v39, v47
    s_bitcmp1_b32 s5, 16
    s_cbranch_scc0 g1_kv_slow
g1_kv_fast:
    buffer_atomic_add_f32 v32, v10, s[44:47], s4 offen offset:0 sc1
    buffer_atomic_add_f32 v33, v11, s[44:47], s4 offen offset:0 sc1
    buffer_atomic_add_f32 v34, v12, s[44:47], s4 offen offset:0 sc1
    buffer_atomic_add_f32 v35, v13, s[44:47], s4 offen offset:0 sc1
    buffer_atomic_add_f32 v36, v10, s[44:47], s4 offen offset:840 sc1
    buffer_atomic_add_f32 v37, v11, s[44:47], s4 offen offset:840 sc1
    buffer_atomic_add_f32 v38, v12, s[44:47], s4 offen offset:840 sc1
    buffer_atomic_add_f32 v39, v13, s[44:47], s4 offen offset:840 sc1
    s_branch g1_done
g1_kv_slow:
    s_add_u32 s84, s34, 16384
    s_addc_u32 s85, s35, 0
    s_and_b32 s85, s85, 0xffff
    s_mov_b32 s86, 524288
    s_mov_b32 s87, 0x00020000
    s_mov_b32 s80, s32
    s_mov_b32 s81, s33
    s_and_b32 s81, s81, 0xffff
    s_mov_b32 s82, 256
    s_mov_b32 s83, 0x00020000
    s_mul_i32 s5, s6, 65536
    s_add_u32 s5, s5, s4
    buffer_store_dword v32, v10, s[84:87], s5 offen offset:0 sc1
    buffer_store_dword v33, v11, s[84:87], s5 offen offset:0 sc1
    buffer_store_dword v34, v12, s[84:87], s5 offen offset:0 sc1
    buffer_store_dword v35, v13, s[84:87], s5 offen offset:0 sc1
    buffer_store_dword v36, v10, s[84:87], s5 offen offset:840 sc1
    buffer_store_dword v37, v11, s[84:87], s5 offen offset:840 sc1
    buffer_store_dword v38, v12, s[84:87], s5 offen offset:840 sc1
    buffer_store_dword v39, v13, s[84:87], s5 offen offset:840 sc1
    s_lshl_b32 s5, s6, 1
    s_lshl_b32 s5, 3, s5
    v_mov_b32 v30, s5
    v_mov_b32 v31, 0
    s_lshl_b32 s5, s13, 2
    s_waitcnt vmcnt(0)
    s_mov_b64 exec, 1
    buffer_atomic_or v30, v31, s[80:83], s5 offen sc0 sc1
    s_waitcnt vmcnt(0)
    s_mov_b64 exec, -1
    s_nop 0
    v_readfirstlane_b32 s5, v30
    s_bitcmp1_b32 s5, 16
    s_cbranch_scc1 g1_kv_fast
    s_movk_i32 s89, 0x101
    s_branch g1_done
g1_loader:
    s_setprio 3
    v_lshrrev_b32 v5, 3, v2
    v_and_b32 v6, 7, v2
    v_xor_b32 v6, v6, v5
    v_mul_u32_u24 v10, 1280, v5
    v_lshl_add_u32 v10, v6, 4, v10
    s_mul_i32 s4, s9, 81920
    v_add_u32 v10, s4, v10
    v_add_u32 v11, 10240, v10
    v_add_u32 v12, 20480, v10
    v_add_u32 v13, 30720, v10
    v_add_u32 v14, 40960, v10
    v_add_u32 v15, 51200, v10
    v_add_u32 v16, 61440, v10
    v_add_u32 v17, 71680, v10
    s_lshl_b32 s52, s9, 13
    s_mul_i32 s53, s9, 3072
    s_add_u32 s53, s53, 98304
    v_lshrrev_b32 v5, 2, v2
    v_mul_lo_u32 v5, v5, s14
    v_lshrrev_b32 v6, 4, v2
    v_and_b32 v6, 2, v6
    v_and_b32 v7, 3, v2
    v_xor_b32 v6, v6, v7
    v_lshl_add_u32 v5, v6, 4, v5
    s_lshl_b32 s54, s14, 4
    s_lshl_b32 s55, s14, 5
    s_sub_u32 s4, s7, 8
    s_cmp_lt_u32 s4, 4
    s_cselect_b32 s4, s11, 0
    s_lshl_b32 s4, s4, 1
    s_sub_u32 s56, 6, s4
    s_mul_i32 s57, s12, 3
    s_add_u32 s4, s57, 0
    s_lshr_b32 s5, s4, 1
    s_lshl_b32 s5, s5, 6
    s_add_u32 s5, s5, s15
    s_bitcmp1_b32 s4, 0
    s_cselect_b32 s13, s54, 0
    s_add_u32 s5, s5, s13
    s_cmp_lt_u32 s4, s56
    s_cselect_b32 s5, s5, 0x7ff00000
    v_add_u32 v18, s5, v5
    s_add_u32 s4, s57, 1
    s_lshr_b32 s5, s4, 1
    s_lshl_b32 s5, s5, 6
    s_add_u32 s5, s5, s15
    s_bitcmp1_b32 s4, 0
    s_cselect_b32 s13, s54, 0
    s_add_u32 s5, s5, s13
    s_cmp_lt_u32 s4, s56
    s_cselect_b32 s5, s5, 0x7ff00000
    v_add_u32 v19, s5, v5
    s_add_u32 s4, s57, 2
    s_lshr_b32 s5, s4, 1
    s_lshl_b32 s5, s5, 6
    s_add_u32 s5, s5, s15
    s_bitcmp1_b32 s4, 0
    s_cselect_b32 s13, s54, 0
    s_add_u32 s5, s5, s13
    s_cmp_lt_u32 s4, s56
    s_cselect_b32 s5, s5, 0x7ff00000
    v_add_u32 v20, s5, v5
    s_mov_b32 s13, 0
    s_waitcnt lgkmcnt(0)
    s_mov_b32 s36, s16
    s_and_b32 s37, s17, 0xffff
    s_cmp_eq_u32 s11, 0
    s_cselect_b64 s[44:45], s[24:25], s[26:27]
    s_cmp_ge_u32 s7, 12
    s_cselect_b64 s[44:45], s[44:45], s[18:19]
    s_and_b32 s45, s45, 0xffff
    s_lshl_b32 s4, s9, 6
    v_add_u32 v80, s4, v2
    v_mul_u32_u24 v80, 1280, v80
    s_lshl_b32 s4, s12, 5
    v_lshrrev_b32 v5, 1, v2
    v_add_u32 v5, s4, v5
    v_mul_lo_u32 v5, v5, s14
    v_and_b32 v6, 1, v2
    v_lshl_add_u32 v5, v6, 7, v5
    v_add_u32 v81, s15, v5
    s_mul_i32 s4, s7, 86
    s_lshr_b32 s4, s4, 8
    s_mul_i32 s4, s4, 3
    s_sub_u32 s64, s7, s4
    v_and_b32 v3, 15, v2
    v_lshrrev_b32 v4, 4, v2
    v_lshrrev_b32 v5, 5, v2
    v_lshrrev_b32 v6, 2, v3
    v_lshl_add_u32 v5, v5, 2, v6
    v_lshl_add_u32 v5, v5, 6, s53
    v_and_b32 v6, 1, v4
    v_lshl_add_u32 v5, v6, 5, v5
    v_and_b32 v6, 3, v3
    v_lshl_add_u32 v78, v6, 3, v5
    v_xor_b32 v79, 32, v78
    v_add_u32 v79, 512, v79
    v_mov_b32 v70, 0
    v_mov_b32 v71, 0
    v_mov_b32 v72, 0
    v_mov_b32 v73, 0
    v_mov_b32 v74, 0
    v_mov_b32 v75, 0
    s_mov_b32 s61, 0x3f803f80
    v_xor_b32 v5, v3, v4
    v_and_b32 v5, 1, v5
    v_cmp_eq_u32 vcc, 0, v5
    v_mov_b32 v5, s61
    s_nop 0
    v_cndmask_b32 v66, 0, v5, vcc
    v_cndmask_b32 v67, 0, v5, vcc
    v_cndmask_b32 v68, 0, v5, vcc
    v_cndmask_b32 v69, 0, v5, vcc
    s_mov_b32 s80, s32
    s_mov_b32 s81, s33
    s_and_b32 s81, s81, 0xffff
    s_mov_b32 s82, 256
    s_mov_b32 s83, 0x00020000
    s_mov_b32 s40, s34
    s_mov_b32 s41, s35
    s_and_b32 s41, s41, 0xffff
    s_mov_b32 s42, 16384
    s_mov_b32 s43, 0x00020000
    s_mul_i32 s4, s9, 384
    s_add_u32 s4, s4, 54528
    v_and_b32 v5, 31, v2
    v_lshl_add_u32 v83, v5, 2, s4
    s_lshl_b32 s62, s7, 4
    s_and_b32 s62, s62, 127
    v_and_b32 v5, 3, v2
    v_lshl_add_u32 v84, v5, 2, s62
    s_lshl_b32 s63, s6, 2
    s_add_u32 s63, s63, s9
    s_lshl_b32 s63, s63, 2
    v_writelane_b32 v84, s63, 4
    s_movk_i32 s4, 128
    v_writelane_b32 v84, s4, 5
    s_cmp_lt_u32 s7, 8
    s_cbranch_scc1 g1_lkv
    s_cmp_lt_u32 s7, 12
    s_cbranch_scc1 g1_lq
    v_and_b32 v30, 1, v5
    v_lshlrev_b32 v30, 3, v30
    v_lshrrev_b32 v31, 1, v5
    v_lshl_add_u32 v30, v31, 2, v30
    s_mul_i32 s4, s12, 48
    v_add_u32 v30, s4, v30
    v_add_u32 v86, 0, v30
    v_add_u32 v87, 16, v30
    v_add_u32 v88, 32, v30
    v_add_u32 v89, 96, v30
    v_add_u32 v90, 112, v30
    v_add_u32 v91, 128, v30
    s_branch g1_lj
g1_lq:
    s_mul_i32 s4, s12, 80
    v_mul_u32_u24 v30, 20, v5
    v_add_u32 v86, s4, v30
    v_add_u32 v87, 4, v86
    v_add_u32 v88, 8, v86
    v_add_u32 v89, 12, v86
    v_add_u32 v90, 16, v86
    v_mov_b32 v91, v86
    s_branch g1_lj
g1_lkv:
    s_and_b32 s4, s7, 1
    s_lshl_b32 s4, s4, 4
    s_mul_i32 s5, s12, 40
    s_add_u32 s4, s4, s5
    v_lshl_add_u32 v86, v5, 2, s4
    v_add_u32 v87, 20, v86
    v_add_u32 v89, 96, v86
    v_add_u32 v90, 116, v86
    v_and_b32 v30, 1, v5
    v_mul_u32_u24 v30, 20, v30
    v_lshrrev_b32 v31, 1, v5
    v_mul_u32_u24 v31, 96, v31
    s_add_u32 s4, s4, 16
    v_add3_u32 v88, v30, v31, s4
    v_mov_b32 v91, v86
g1_lj:
    s_mov_b32 s4, 54528
    v_lshrrev_b32 v6, 5, v86
    v_lshl_add_u32 v86, v86, 2, s4
    v_lshl_add_u32 v86, v6, 7, v86
    v_lshrrev_b32 v6, 5, v87
    v_lshl_add_u32 v87, v87, 2, s4
    v_lshl_add_u32 v87, v6, 7, v87
    v_lshrrev_b32 v6, 5, v88
    v_lshl_add_u32 v88, v88, 2, s4
    v_lshl_add_u32 v88, v6, 7, v88
    v_lshrrev_b32 v6, 5, v89
    v_lshl_add_u32 v89, v89, 2, s4
    v_lshl_add_u32 v89, v6, 7, v89
    v_lshrrev_b32 v6, 5, v90
    v_lshl_add_u32 v90, v90, 2, s4
    v_lshl_add_u32 v90, v6, 7, v90
    v_lshrrev_b32 v6, 5, v91
    v_lshl_add_u32 v91, v91, 2, s4
    v_lshl_add_u32 v91, v6, 7, v91
    s_mul_i32 s4, s12, 384
    s_add_u32 s4, s4, 56064
    v_lshl_add_u32 v92, v5, 4, s4
    s_lshr_b32 s4, s2, 3
    s_lshl_b32 s4, s4, 2
    s_add_u32 s4, s4, s9
    s_mov_b32 s92, s28
    s_mov_b32 s93, s29
    s_and_b32 s93, s93, 0xffff
    s_mov_b32 s94, 2211840
    s_mov_b32 s95, 0x00020000
    s_mov_b32 s72, s20
    s_mov_b32 s73, s21
    s_and_b32 s73, s73, 0xffff
    s_mov_b32 s74, 819200
    s_mov_b32 s75, 0x00020000
    s_mul_i32 s76, s4, 10240
    s_mul_i32 s77, s4, 4736
    v_lshrrev_b32 v101, 3, v2
    v_mul_u32_u24 v101, 1280, v101
    v_and_b32 v100, 7, v2
    v_lshl_add_u32 v100, v100, 7, v101
    s_barrier
    s_add_u32 s4, s10, 0
    s_add_u32 m0, s52, 0
    s_nop 0
    buffer_load_dwordx4 v10, s[36:39], s4 offen lds
    s_add_u32 m0, s52, 1024
    s_nop 0
    buffer_load_dwordx4 v11, s[36:39], s4 offen lds
    s_add_u32 m0, s52, 2048
    s_nop 0
    buffer_load_dwordx4 v12, s[36:39], s4 offen lds
    s_add_u32 m0, s52, 3072
    s_nop 0
    buffer_load_dwordx4 v13, s[36:39], s4 offen lds
    s_add_u32 m0, s53, 0
    s_nop 0
    buffer_load_dwordx4 v18, s[44:47], s13 offen lds
    s_add_u32 m0, s53, 1024
    s_nop 0
    buffer_load_dwordx4 v19, s[44:47], s13 offen lds
    s_add_u32 m0, s53, 2048
    s_nop 0
    buffer_load_dwordx4 v20, s[44:47], s13 offen lds
    s_add_u32 s13, s13, s55
    s_add_u32 s4, s10, 0
    s_add_u32 m0, s52, 4096
    s_nop 0
    buffer_load_dwordx4 v14, s[36:39], s4 offen lds
    s_add_u32 m0, s52, 5120
    s_nop 0
    buffer_load_dwordx4 v15, s[36:39], s4 offen lds
    s_add_u32 m0, s52, 6144
    s_nop 0
    buffer_load_dwordx4 v16, s[36:39], s4 offen lds
    s_add_u32 m0, s52, 7168
    s_nop 0
    buffer_load_dwordx4 v17, s[36:39], s4 offen lds
    s_add_u32 m0, s53, 12288
    s_nop 0
    buffer_load_dwordx4 v18, s[44:47], s13 offen lds
    s_add_u32 m0, s53, 13312
    s_nop 0
    buffer_load_dwordx4 v19, s[44:47], s13 offen lds
    s_add_u32 m0, s53, 14336
    s_nop 0
    buffer_load_dwordx4 v20, s[44:47], s13 offen lds
    s_add_u32 s13, s13, s55
    s_add_u32 s4, s10, 128
    s_add_u32 m0, s52, 32768
    s_nop 0
    buffer_load_dwordx4 v10, s[36:39], s4 offen lds
    s_add_u32 m0, s52, 33792
    s_nop 0
    buffer_load_dwordx4 v11, s[36:39], s4 offen lds
    s_add_u32 m0, s52, 34816
    s_nop 0
    buffer_load_dwordx4 v12, s[36:39], s4 offen lds
    s_add_u32 m0, s52, 35840
    s_nop 0
    buffer_load_dwordx4 v13, s[36:39], s4 offen lds
    s_waitcnt vmcnt(7)
    s_barrier
    ds_read_b64_tr_b16 v[42:43], v78 offset:0
    ds_read_b64_tr_b16 v[44:45], v79 offset:0
    ds_read_b64_tr_b16 v[46:47], v78 offset:1024
    ds_read_b64_tr_b16 v[48:49], v79 offset:1024
    ds_read_b64_tr_b16 v[50:51], v78 offset:2048
    ds_read_b64_tr_b16 v[52:53], v79 offset:2048
    s_add_u32 m0, s53, 24576
    s_nop 0
    buffer_load_dwordx4 v18, s[44:47], s13 offen lds
    s_add_u32 m0, s53, 25600
    s_nop 0
    buffer_load_dwordx4 v19, s[44:47], s13 offen lds
    s_add_u32 m0, s53, 26624
    s_nop 0
    buffer_load_dwordx4 v20, s[44:47], s13 offen lds
    s_add_u32 s13, s13, s55
    s_add_u32 s4, s10, 128
    s_add_u32 m0, s52, 36864
    s_nop 0
    buffer_load_dwordx4 v14, s[36:39], s4 offen lds
    s_add_u32 m0, s52, 37888
    s_nop 0
    buffer_load_dwordx4 v15, s[36:39], s4 offen lds
    s_add_u32 m0, s52, 38912
    s_nop 0
    buffer_load_dwordx4 v16, s[36:39], s4 offen lds
    s_add_u32 m0, s52, 39936
    s_nop 0
    buffer_load_dwordx4 v17, s[36:39], s4 offen lds
    s_add_u32 m0, s53, 36864
    s_nop 0
    buffer_load_dwordx4 v18, s[44:47], s13 offen lds
    s_add_u32 m0, s53, 37888
    s_nop 0
    buffer_load_dwordx4 v19, s[44:47], s13 offen lds
    s_add_u32 m0, s53, 38912
    s_nop 0
    buffer_load_dwordx4 v20, s[44:47], s13 offen lds
    s_add_u32 s13, s13, s55
    s_add_u32 s4, s10, 256
    s_add_u32 m0, s52, 65536
    s_nop 0
    buffer_load_dwordx4 v10, s[36:39], s4 offen lds
    s_add_u32 m0, s52, 66560
    s_nop 0
    buffer_load_dwordx4 v11, s[36:39], s4 offen lds
    s_add_u32 m0, s52, 67584
    s_nop 0
    buffer_load_dwordx4 v12, s[36:39], s4 offen lds
    s_add_u32 m0, s52, 68608
    s_nop 0
    buffer_load_dwordx4 v13, s[36:39], s4 offen lds
    s_waitcnt vmcnt(18)
    s_barrier
    ds_read_b64_tr_b16 v[30:31], v78 offset:12288
    ds_read_b64_tr_b16 v[32:33], v79 offset:12288
    ds_read_b64_tr_b16 v[34:35], v78 offset:13312
    ds_read_b64_tr_b16 v[36:37], v79 offset:13312
    ds_read_b64_tr_b16 v[38:39], v78 offset:14336
    ds_read_b64_tr_b16 v[40:41], v79 offset:14336
    s_waitcnt lgkmcnt(6)
    s_add_u32 m0, s53, 49152
    v_mfma_f32_16x16x32_bf16 v[54:57], v[66:69], v[42:45], 0
    buffer_load_dwordx4 v18, s[44:47], s13 offen lds
    s_add_u32 m0, s53, 50176
    v_mfma_f32_16x16x32_bf16 v[58:61], v[66:69], v[46:49], 0
    buffer_load_dwordx4 v19, s[44:47], s13 offen lds
    s_add_u32 m0, s53, 51200
    v_mfma_f32_16x16x32_bf16 v[62:65], v[66:69], v[50:53], 0
    buffer_load_dwordx4 v20, s[44:47], s13 offen lds
    s_add_u32 s13, s13, s55
    s_add_u32 s4, s10, 256
    s_add_u32 m0, s52, 69632
    s_nop 0
    buffer_load_dwordx4 v14, s[36:39], s4 offen lds
    s_add_u32 m0, s52, 70656
    s_nop 0
    buffer_load_dwordx4 v15, s[36:39], s4 offen lds
    s_add_u32 m0, s52, 71680
    s_nop 0
    buffer_load_dwordx4 v16, s[36:39], s4 offen lds
    s_add_u32 m0, s52, 72704
    s_nop 0
    buffer_load_dwordx4 v17, s[36:39], s4 offen lds
    s_add_u32 m0, s53, 0
    s_nop 0
    buffer_load_dwordx4 v18, s[44:47], s13 offen lds
    s_add_u32 m0, s53, 1024
    s_nop 0
    buffer_load_dwordx4 v19, s[44:47], s13 offen lds
    s_add_u32 m0, s53, 2048
    s_nop 0
    buffer_load_dwordx4 v20, s[44:47], s13 offen lds
    s_add_u32 s13, s13, s55
    s_and_b32 s56, s2, 7
    s_mul_i32 s56, s56, 30
    s_lshl_b32 s57, s7, 3
    s_max_u32 s58, s57, s56
    s_add_u32 s59, s57, 8
    s_add_u32 s56, s56, 30
    s_min_u32 s59, s59, s56
    s_sub_u32 s56, s59, s58
    s_add_u32 s57, s57, s6
    s_sub_u32 s57, s57, s58
    s_mov_b32 s59, 12
    s_cmp_eq_u32 s56, 6
    s_cselect_b32 s59, 16, s59
    s_cmp_eq_u32 s56, 4
    s_cselect_b32 s59, 24, s59
    s_cmp_eq_u32 s56, 2
    s_cselect_b32 s59, 32, s59
    s_lshl1_add_u32 s57, s57, s12
    s_mul_i32 s57, s57, s59
    s_lshl_b32 s58, s12, 5
    s_sub_u32 s57, s57, s58
    s_add_u32 s57, s57, 192
    s_mul_i32 s57, s57, s14
    v_add_u32 v95, s57, v81
    s_lshl_b32 s59, s59, 1
    s_lshl_b32 s58, s14, 5
    v_cmpx_gt_i32 vcc, s59, v2
    buffer_load_dword v94, v95, s[44:47], 0 offen
    s_mov_b64 exec, -1
    s_cmp_lg_u32 s64, 0
    s_cbranch_scc1 g1_tx3
    s_add_u32 s4, s10, 384
    buffer_load_dword v93, v80, s[36:39], s4 offen
g1_tx3:
    s_cmp_lg_u32 s64, 1
    s_cbranch_scc1 g1_tx4
    s_add_u32 s4, s10, 512
    buffer_load_dword v93, v80, s[36:39], s4 offen
g1_tx4:
    s_cmp_lg_u32 s64, 2
    s_cbranch_scc1 g1_tx5
    s_add_u32 s4, s10, 640
    buffer_load_dword v93, v80, s[36:39], s4 offen
g1_tx5:
    s_waitcnt vmcnt(17)
    s_barrier
    ds_read_b64_tr_b16 v[42:43], v78 offset:24576
    ds_read_b64_tr_b16 v[44:45], v79 offset:24576
    ds_read_b64_tr_b16 v[46:47], v78 offset:25600
    ds_read_b64_tr_b16 v[48:49], v79 offset:25600
    ds_read_b64_tr_b16 v[50:51], v78 offset:26624
    ds_read_b64_tr_b16 v[52:53], v79 offset:26624
    s_waitcnt lgkmcnt(6)
    v_mfma_f32_16x16x32_bf16 v[54:57], v[66:69], v[30:33], v[54:57]
    v_mfma_f32_16x16x32_bf16 v[58:61], v[66:69], v[34:37], v[58:61]
    v_mfma_f32_16x16x32_bf16 v[62:65], v[66:69], v[38:41], v[62:65]
    s_waitcnt vmcnt(14)
    s_barrier
    ds_read_b64_tr_b16 v[30:31], v78 offset:36864
    ds_read_b64_tr_b16 v[32:33], v79 offset:36864
    ds_read_b64_tr_b16 v[34:35], v78 offset:37888
    ds_read_b64_tr_b16 v[36:37], v79 offset:37888
    ds_read_b64_tr_b16 v[38:39], v78 offset:38912
    ds_read_b64_tr_b16 v[40:41], v79 offset:38912
    s_waitcnt lgkmcnt(6)
    v_mfma_f32_16x16x32_bf16 v[54:57], v[66:69], v[42:45], v[54:57]
    v_mfma_f32_16x16x32_bf16 v[58:61], v[66:69], v[46:49], v[58:61]
    v_mfma_f32_16x16x32_bf16 v[62:65], v[66:69], v[50:53], v[62:65]
    s_waitcnt vmcnt(3)
    s_barrier
    ds_read_b64_tr_b16 v[42:43], v78 offset:49152
    ds_read_b64_tr_b16 v[44:45], v79 offset:49152
    ds_read_b64_tr_b16 v[46:47], v78 offset:50176
    ds_read_b64_tr_b16 v[48:49], v79 offset:50176
    ds_read_b64_tr_b16 v[50:51], v78 offset:51200
    ds_read_b64_tr_b16 v[52:53], v79 offset:51200
    s_waitcnt lgkmcnt(6)
    s_add_u32 s4, s10, 384
    s_add_u32 m0, s52, 0
    v_mfma_f32_16x16x32_bf16 v[54:57], v[66:69], v[30:33], v[54:57]
    buffer_load_dwordx4 v10, s[36:39], s4 offen lds
    s_add_u32 m0, s52, 1024
    v_mfma_f32_16x16x32_bf16 v[58:61], v[66:69], v[34:37], v[58:61]
    buffer_load_dwordx4 v11, s[36:39], s4 offen lds
    s_add_u32 m0, s52, 2048
    v_mfma_f32_16x16x32_bf16 v[62:65], v[66:69], v[38:41], v[62:65]
    buffer_load_dwordx4 v12, s[36:39], s4 offen lds
    s_add_u32 m0, s52, 3072
    s_nop 0
    buffer_load_dwordx4 v13, s[36:39], s4 offen lds
    s_add_u32 m0, s53, 12288
    s_nop 0
    buffer_load_dwordx4 v18, s[44:47], s13 offen lds
    s_add_u32 m0, s53, 13312
    s_nop 0
    buffer_load_dwordx4 v19, s[44:47], s13 offen lds
    s_add_u32 m0, s53, 14336
    s_nop 0
    buffer_load_dwordx4 v20, s[44:47], s13 offen lds
    s_add_u32 s13, s13, s55
    s_add_u32 s4, s10, 384
    s_add_u32 m0, s52, 4096
    s_nop 0
    buffer_load_dwordx4 v14, s[36:39], s4 offen lds
    s_add_u32 m0, s52, 5120
    s_nop 0
    buffer_load_dwordx4 v15, s[36:39], s4 offen lds
    s_add_u32 m0, s52, 6144
    s_nop 0
    buffer_load_dwordx4 v16, s[36:39], s4 offen lds
    s_add_u32 m0, s52, 7168
    s_nop 0
    buffer_load_dwordx4 v17, s[36:39], s4 offen lds
    s_waitcnt vmcnt(11)
    s_barrier
    ds_read_b64_tr_b16 v[30:31], v78 offset:0
    ds_read_b64_tr_b16 v[32:33], v79 offset:0
    ds_read_b64_tr_b16 v[34:35], v78 offset:1024
    ds_read_b64_tr_b16 v[36:37], v79 offset:1024
    ds_read_b64_tr_b16 v[38:39], v78 offset:2048
    ds_read_b64_tr_b16 v[40:41], v79 offset:2048
    s_waitcnt lgkmcnt(6)
    s_add_u32 m0, s53, 24576
    v_mfma_f32_16x16x32_bf16 v[54:57], v[66:69], v[42:45], v[54:57]
    buffer_load_dwordx4 v18, s[44:47], s13 offen lds
    s_add_u32 m0, s53, 25600
    v_mfma_f32_16x16x32_bf16 v[58:61], v[66:69], v[46:49], v[58:61]
    buffer_load_dwordx4 v19, s[44:47], s13 offen lds
    s_add_u32 m0, s53, 26624
    v_mfma_f32_16x16x32_bf16 v[62:65], v[66:69], v[50:53], v[62:65]
    buffer_load_dwordx4 v20, s[44:47], s13 offen lds
    s_add_u32 s13, s13, s55
    s_add_u32 s4, s10, 512
    s_add_u32 m0, s52, 32768
    s_nop 0
    buffer_load_dwordx4 v10, s[36:39], s4 offen lds
    s_add_u32 m0, s52, 33792
    s_nop 0
    buffer_load_dwordx4 v11, s[36:39], s4 offen lds
    s_add_u32 m0, s52, 34816
    s_nop 0
    buffer_load_dwordx4 v12, s[36:39], s4 offen lds
    s_add_u32 m0, s52, 35840
    s_nop 0
    buffer_load_dwordx4 v13, s[36:39], s4 offen lds
    s_add_u32 m0, s53, 36864
    s_nop 0
    buffer_load_dwordx4 v18, s[44:47], s13 offen lds
    s_add_u32 m0, s53, 37888
    s_nop 0
    buffer_load_dwordx4 v19, s[44:47], s13 offen lds
    s_add_u32 m0, s53, 38912
    s_nop 0
    buffer_load_dwordx4 v20, s[44:47], s13 offen lds
    s_add_u32 s13, s13, s55
    s_waitcnt vmcnt(10)
    s_barrier
    ds_read_b64_tr_b16 v[42:43], v78 offset:12288
    ds_read_b64_tr_b16 v[44:45], v79 offset:12288
    ds_read_b64_tr_b16 v[46:47], v78 offset:13312
    ds_read_b64_tr_b16 v[48:49], v79 offset:13312
    ds_read_b64_tr_b16 v[50:51], v78 offset:14336
    ds_read_b64_tr_b16 v[52:53], v79 offset:14336
    s_waitcnt lgkmcnt(6)
    s_add_u32 s4, s10, 512
    s_add_u32 m0, s52, 36864
    v_mfma_f32_16x16x32_bf16 v[54:57], v[66:69], v[30:33], v[54:57]
    buffer_load_dwordx4 v14, s[36:39], s4 offen lds
    s_add_u32 m0, s52, 37888
    v_mfma_f32_16x16x32_bf16 v[58:61], v[66:69], v[34:37], v[58:61]
    buffer_load_dwordx4 v15, s[36:39], s4 offen lds
    s_add_u32 m0, s52, 38912
    v_mfma_f32_16x16x32_bf16 v[62:65], v[66:69], v[38:41], v[62:65]
    buffer_load_dwordx4 v16, s[36:39], s4 offen lds
    s_add_u32 m0, s52, 39936
    s_nop 0
    buffer_load_dwordx4 v17, s[36:39], s4 offen lds
    s_add_u32 m0, s53, 49152
    s_nop 0
    buffer_load_dwordx4 v18, s[44:47], s13 offen lds
    s_add_u32 m0, s53, 50176
    s_nop 0
    buffer_load_dwordx4 v19, s[44:47], s13 offen lds
    s_add_u32 m0, s53, 51200
    s_nop 0
    buffer_load_dwordx4 v20, s[44:47], s13 offen lds
    s_add_u32 s13, s13, s55
    s_add_u32 s4, s10, 640
    s_add_u32 m0, s52, 65536
    s_nop 0
    buffer_load_dwordx4 v10, s[36:39], s4 offen lds
    s_add_u32 m0, s52, 66560
    s_nop 0
    buffer_load_dwordx4 v11, s[36:39], s4 offen lds
    s_add_u32 m0, s52, 67584
    s_nop 0
    buffer_load_dwordx4 v12, s[36:39], s4 offen lds
    s_add_u32 m0, s52, 68608
    s_nop 0
    buffer_load_dwordx4 v13, s[36:39], s4 offen lds
    s_waitcnt vmcnt(18)
    s_barrier
    ds_read_b64_tr_b16 v[30:31], v78 offset:24576
    ds_read_b64_tr_b16 v[32:33], v79 offset:24576
    ds_read_b64_tr_b16 v[34:35], v78 offset:25600
    ds_read_b64_tr_b16 v[36:37], v79 offset:25600
    ds_read_b64_tr_b16 v[38:39], v78 offset:26624
    ds_read_b64_tr_b16 v[40:41], v79 offset:26624
    s_waitcnt lgkmcnt(6)
    s_add_u32 m0, s53, 0
    v_mfma_f32_16x16x32_bf16 v[54:57], v[66:69], v[42:45], v[54:57]
    buffer_load_dwordx4 v18, s[44:47], s13 offen lds
    s_add_u32 m0, s53, 1024
    v_mfma_f32_16x16x32_bf16 v[58:61], v[66:69], v[46:49], v[58:61]
    buffer_load_dwordx4 v19, s[44:47], s13 offen lds
    s_add_u32 m0, s53, 2048
    v_mfma_f32_16x16x32_bf16 v[62:65], v[66:69], v[50:53], v[62:65]
    buffer_load_dwordx4 v20, s[44:47], s13 offen lds
    s_add_u32 s13, s13, s55
    s_add_u32 s4, s10, 640
    s_add_u32 m0, s52, 69632
    s_nop 0
    buffer_load_dwordx4 v14, s[36:39], s4 offen lds
    s_add_u32 m0, s52, 70656
    s_nop 0
    buffer_load_dwordx4 v15, s[36:39], s4 offen lds
    s_add_u32 m0, s52, 71680
    s_nop 0
    buffer_load_dwordx4 v16, s[36:39], s4 offen lds
    s_add_u32 m0, s52, 72704
    s_nop 0
    buffer_load_dwordx4 v17, s[36:39], s4 offen lds
    s_add_u32 m0, s53, 12288
    s_nop 0
    buffer_load_dwordx4 v18, s[44:47], s13 offen lds
    s_add_u32 m0, s53, 13312
    s_nop 0
    buffer_load_dwordx4 v19, s[44:47], s13 offen lds
    s_add_u32 m0, s53, 14336
    s_nop 0
    buffer_load_dwordx4 v20, s[44:47], s13 offen lds
    s_add_u32 s13, s13, s55
    s_and_b32 s56, s2, 7
    s_mul_i32 s56, s56, 30
    s_lshl_b32 s57, s7, 3
    s_max_u32 s58, s57, s56
    s_add_u32 s59, s57, 8
    s_add_u32 s56, s56, 30
    s_min_u32 s59, s59, s56
    s_sub_u32 s56, s59, s58
    s_add_u32 s57, s57, s6
    s_sub_u32 s57, s57, s58
    s_mov_b32 s59, 16
    s_cmp_eq_u32 s56, 6
    s_cselect_b32 s59, 22, s59
    s_cmp_eq_u32 s56, 4
    s_cselect_b32 s59, 32, s59
    s_cmp_eq_u32 s56, 2
    s_cselect_b32 s59, 32, s59
    s_lshl1_add_u32 s57, s57, s12
    s_mul_i32 s57, s57, s59
    s_lshl_b32 s58, s12, 5
    s_sub_u32 s57, s57, s58
    s_add_u32 s57, s57, 384
    s_mul_i32 s57, s57, s14
    v_add_u32 v95, s57, v81
    s_lshl_b32 s59, s59, 1
    s_lshl_b32 s58, s14, 5
    v_cmpx_gt_i32 vcc, s59, v2
    buffer_load_dword v94, v95, s[44:47], 0 offen
    s_mov_b64 exec, -1
    s_cmp_lg_u32 s64, 0
    s_cbranch_scc1 g1_tx6
    s_add_u32 s4, s10, 768
    buffer_load_dword v93, v80, s[36:39], s4 offen
g1_tx6:
    s_cmp_lg_u32 s64, 1
    s_cbranch_scc1 g1_tx7
    s_add_u32 s4, s10, 896
    buffer_load_dword v93, v80, s[36:39], s4 offen
g1_tx7:
    s_cmp_lg_u32 s64, 2
    s_cbranch_scc1 g1_tx8
    s_add_u32 s4, s10, 1024
    buffer_load_dword v93, v80, s[36:39], s4 offen
g1_tx8:
    s_cmp_eq_u32 s9, 3
    s_cselect_b32 s4, 0, s9
    s_cmp_lg_u32 s64, s4
    s_cbranch_scc1 g1_tx9
    s_add_u32 s4, s10, 1152
    buffer_load_dword v93, v80, s[36:39], s4 offen
g1_tx9:
    s_waitcnt vmcnt(17)
    s_barrier
    ds_read_b64_tr_b16 v[42:43], v78 offset:36864
    ds_read_b64_tr_b16 v[44:45], v79 offset:36864
    ds_read_b64_tr_b16 v[46:47], v78 offset:37888
    ds_read_b64_tr_b16 v[48:49], v79 offset:37888
    ds_read_b64_tr_b16 v[50:51], v78 offset:38912
    ds_read_b64_tr_b16 v[52:53], v79 offset:38912
    s_waitcnt lgkmcnt(6)
    v_mfma_f32_16x16x32_bf16 v[54:57], v[66:69], v[30:33], v[54:57]
    v_mfma_f32_16x16x32_bf16 v[58:61], v[66:69], v[34:37], v[58:61]
    v_mfma_f32_16x16x32_bf16 v[62:65], v[66:69], v[38:41], v[62:65]
    s_waitcnt vmcnt(14)
    s_barrier
    ds_read_b64_tr_b16 v[30:31], v78 offset:49152
    ds_read_b64_tr_b16 v[32:33], v79 offset:49152
    ds_read_b64_tr_b16 v[34:35], v78 offset:50176
    ds_read_b64_tr_b16 v[36:37], v79 offset:50176
    ds_read_b64_tr_b16 v[38:39], v78 offset:51200
    ds_read_b64_tr_b16 v[40:41], v79 offset:51200
    s_waitcnt lgkmcnt(6)
    v_mfma_f32_16x16x32_bf16 v[54:57], v[66:69], v[42:45], v[54:57]
    v_mfma_f32_16x16x32_bf16 v[58:61], v[66:69], v[46:49], v[58:61]
    v_mfma_f32_16x16x32_bf16 v[62:65], v[66:69], v[50:53], v[62:65]
    s_waitcnt vmcnt(3)
    s_barrier
    ds_read_b64_tr_b16 v[42:43], v78 offset:0
    ds_read_b64_tr_b16 v[44:45], v79 offset:0
    ds_read_b64_tr_b16 v[46:47], v78 offset:1024
    ds_read_b64_tr_b16 v[48:49], v79 offset:1024
    ds_read_b64_tr_b16 v[50:51], v78 offset:2048
    ds_read_b64_tr_b16 v[52:53], v79 offset:2048
    s_waitcnt lgkmcnt(6)
    s_add_u32 s4, s10, 768
    s_add_u32 m0, s52, 0
    v_mfma_f32_16x16x32_bf16 v[54:57], v[66:69], v[30:33], v[54:57]
    buffer_load_dwordx4 v10, s[36:39], s4 offen lds
    s_add_u32 m0, s52, 1024
    v_mfma_f32_16x16x32_bf16 v[58:61], v[66:69], v[34:37], v[58:61]
    buffer_load_dwordx4 v11, s[36:39], s4 offen lds
    s_add_u32 m0, s52, 2048
    v_mfma_f32_16x16x32_bf16 v[62:65], v[66:69], v[38:41], v[62:65]
    buffer_load_dwordx4 v12, s[36:39], s4 offen lds
    s_add_u32 m0, s52, 3072
    s_nop 0
    buffer_load_dwordx4 v13, s[36:39], s4 offen lds
    s_add_u32 m0, s53, 24576
    s_nop 0
    buffer_load_dwordx4 v18, s[44:47], s13 offen lds
    s_add_u32 m0, s53, 25600
    s_nop 0
    buffer_load_dwordx4 v19, s[44:47], s13 offen lds
    s_add_u32 m0, s53, 26624
    s_nop 0
    buffer_load_dwordx4 v20, s[44:47], s13 offen lds
    s_add_u32 s13, s13, s55
    s_add_u32 s4, s10, 768
    s_add_u32 m0, s52, 4096
    s_nop 0
    buffer_load_dwordx4 v14, s[36:39], s4 offen lds
    s_add_u32 m0, s52, 5120
    s_nop 0
    buffer_load_dwordx4 v15, s[36:39], s4 offen lds
    s_add_u32 m0, s52, 6144
    s_nop 0
    buffer_load_dwordx4 v16, s[36:39], s4 offen lds
    s_add_u32 m0, s52, 7168
    s_nop 0
    buffer_load_dwordx4 v17, s[36:39], s4 offen lds
    s_waitcnt vmcnt(11)
    s_barrier
    ds_read_b64_tr_b16 v[30:31], v78 offset:12288
    ds_read_b64_tr_b16 v[32:33], v79 offset:12288
    ds_read_b64_tr_b16 v[34:35], v78 offset:13312
    ds_read_b64_tr_b16 v[36:37], v79 offset:13312
    ds_read_b64_tr_b16 v[38:39], v78 offset:14336
    ds_read_b64_tr_b16 v[40:41], v79 offset:14336
    s_waitcnt lgkmcnt(6)
    s_add_u32 m0, s53, 36864
    v_mfma_f32_16x16x32_bf16 v[54:57], v[66:69], v[42:45], v[54:57]
    buffer_load_dwordx4 v18, s[44:47], s13 offen lds
    s_add_u32 m0, s53, 37888
    v_mfma_f32_16x16x32_bf16 v[58:61], v[66:69], v[46:49], v[58:61]
    buffer_load_dwordx4 v19, s[44:47], s13 offen lds
    s_add_u32 m0, s53, 38912
    v_mfma_f32_16x16x32_bf16 v[62:65], v[66:69], v[50:53], v[62:65]
    buffer_load_dwordx4 v20, s[44:47], s13 offen lds
    s_add_u32 s13, s13, s55
    s_add_u32 s4, s10, 896
    s_add_u32 m0, s52, 32768
    s_nop 0
    buffer_load_dwordx4 v10, s[36:39], s4 offen lds
    s_add_u32 m0, s52, 33792
    s_nop 0
    buffer_load_dwordx4 v11, s[36:39], s4 offen lds
    s_add_u32 m0, s52, 34816
    s_nop 0
    buffer_load_dwordx4 v12, s[36:39], s4 offen lds
    s_add_u32 m0, s52, 35840
    s_nop 0
    buffer_load_dwordx4 v13, s[36:39], s4 offen lds
    s_add_u32 m0, s53, 49152
    s_nop 0
    buffer_load_dwordx4 v18, s[44:47], s13 offen lds
    s_add_u32 m0, s53, 50176
    s_nop 0
    buffer_load_dwordx4 v19, s[44:47], s13 offen lds
    s_add_u32 m0, s53, 51200
    s_nop 0
    buffer_load_dwordx4 v20, s[44:47], s13 offen lds
    s_add_u32 s13, s13, s55
    s_waitcnt vmcnt(10)
    s_barrier
    ds_read_b64_tr_b16 v[42:43], v78 offset:24576
    ds_read_b64_tr_b16 v[44:45], v79 offset:24576
    ds_read_b64_tr_b16 v[46:47], v78 offset:25600
    ds_read_b64_tr_b16 v[48:49], v79 offset:25600
    ds_read_b64_tr_b16 v[50:51], v78 offset:26624
    ds_read_b64_tr_b16 v[52:53], v79 offset:26624
    s_waitcnt lgkmcnt(6)
    s_add_u32 s4, s10, 896
    s_add_u32 m0, s52, 36864
    v_mfma_f32_16x16x32_bf16 v[54:57], v[66:69], v[30:33], v[54:57]
    buffer_load_dwordx4 v14, s[36:39], s4 offen lds
    s_add_u32 m0, s52, 37888
    v_mfma_f32_16x16x32_bf16 v[58:61], v[66:69], v[34:37], v[58:61]
    buffer_load_dwordx4 v15, s[36:39], s4 offen lds
    s_add_u32 m0, s52, 38912
    v_mfma_f32_16x16x32_bf16 v[62:65], v[66:69], v[38:41], v[62:65]
    buffer_load_dwordx4 v16, s[36:39], s4 offen lds
    s_add_u32 m0, s52, 39936
    s_nop 0
    buffer_load_dwordx4 v17, s[36:39], s4 offen lds
    s_add_u32 m0, s53, 0
    s_nop 0
    buffer_load_dwordx4 v18, s[44:47], s13 offen lds
    s_add_u32 m0, s53, 1024
    s_nop 0
    buffer_load_dwordx4 v19, s[44:47], s13 offen lds
    s_add_u32 m0, s53, 2048
    s_nop 0
    buffer_load_dwordx4 v20, s[44:47], s13 offen lds
    s_add_u32 s13, s13, s55
    s_add_u32 s4, s10, 1024
    s_add_u32 m0, s52, 65536
    s_nop 0
    buffer_load_dwordx4 v10, s[36:39], s4 offen lds
    s_add_u32 m0, s52, 66560
    s_nop 0
    buffer_load_dwordx4 v11, s[36:39], s4 offen lds
    s_add_u32 m0, s52, 67584
    s_nop 0
    buffer_load_dwordx4 v12, s[36:39], s4 offen lds
    s_add_u32 m0, s52, 68608
    s_nop 0
    buffer_load_dwordx4 v13, s[36:39], s4 offen lds
    s_waitcnt vmcnt(18)
    s_barrier
    ds_read_b64_tr_b16 v[30:31], v78 offset:36864
    ds_read_b64_tr_b16 v[32:33], v79 offset:36864
    ds_read_b64_tr_b16 v[34:35], v78 offset:37888
    ds_read_b64_tr_b16 v[36:37], v79 offset:37888
    ds_read_b64_tr_b16 v[38:39], v78 offset:38912
    ds_read_b64_tr_b16 v[40:41], v79 offset:38912
    s_waitcnt lgkmcnt(6)
    s_add_u32 m0, s53, 12288
    v_mfma_f32_16x16x32_bf16 v[54:57], v[66:69], v[42:45], v[54:57]
    buffer_load_dwordx4 v18, s[44:47], s13 offen lds
    s_add_u32 m0, s53, 13312
    v_mfma_f32_16x16x32_bf16 v[58:61], v[66:69], v[46:49], v[58:61]
    buffer_load_dwordx4 v19, s[44:47], s13 offen lds
    s_add_u32 m0, s53, 14336
    v_mfma_f32_16x16x32_bf16 v[62:65], v[66:69], v[50:53], v[62:65]
    buffer_load_dwordx4 v20, s[44:47], s13 offen lds
    s_add_u32 s13, s13, s55
    s_add_u32 s4, s10, 1024
    s_add_u32 m0, s52, 69632
    s_nop 0
    buffer_load_dwordx4 v14, s[36:39], s4 offen lds
    s_add_u32 m0, s52, 70656
    s_nop 0
    buffer_load_dwordx4 v15, s[36:39], s4 offen lds
    s_add_u32 m0, s52, 71680
    s_nop 0
    buffer_load_dwordx4 v16, s[36:39], s4 offen lds
    s_add_u32 m0, s52, 72704
    s_nop 0
    buffer_load_dwordx4 v17, s[36:39], s4 offen lds
    s_add_u32 m0, s53, 24576
    s_nop 0
    buffer_load_dwordx4 v18, s[44:47], s13 offen lds
    s_add_u32 m0, s53, 25600
    s_nop 0
    buffer_load_dwordx4 v19, s[44:47], s13 offen lds
    s_add_u32 m0, s53, 26624
    s_nop 0
    buffer_load_dwordx4 v20, s[44:47], s13 offen lds
    s_add_u32 s13, s13, s55
    s_waitcnt vmcnt(17)
    s_barrier
    ds_read_b64_tr_b16 v[42:43], v78 offset:49152
    ds_read_b64_tr_b16 v[44:45], v79 offset:49152
    ds_read_b64_tr_b16 v[46:47], v78 offset:50176
    ds_read_b64_tr_b16 v[48:49], v79 offset:50176
    ds_read_b64_tr_b16 v[50:51], v78 offset:51200
    ds_read_b64_tr_b16 v[52:53], v79 offset:51200
    s_waitcnt lgkmcnt(6)
    s_add_u32 s4, s10, 1152
    s_add_u32 m0, s52, 0
    v_mfma_f32_16x16x32_bf16 v[54:57], v[66:69], v[30:33], v[54:57]
    buffer_load_dwordx4 v10, s[36:39], s4 offen lds
    s_add_u32 m0, s52, 1024
    v_mfma_f32_16x16x32_bf16 v[58:61], v[66:69], v[34:37], v[58:61]
    buffer_load_dwordx4 v11, s[36:39], s4 offen lds
    s_add_u32 m0, s52, 2048
    v_mfma_f32_16x16x32_bf16 v[62:65], v[66:69], v[38:41], v[62:65]
    buffer_load_dwordx4 v12, s[36:39], s4 offen lds
    s_add_u32 m0, s52, 3072
    s_nop 0
    buffer_load_dwordx4 v13, s[36:39], s4 offen lds
    s_add_u32 m0, s53, 36864
    s_nop 0
    buffer_load_dwordx4 v18, s[44:47], s13 offen lds
    s_add_u32 m0, s53, 37888
    s_nop 0
    buffer_load_dwordx4 v19, s[44:47], s13 offen lds
    s_add_u32 m0, s53, 38912
    s_nop 0
    buffer_load_dwordx4 v20, s[44:47], s13 offen lds
    s_add_u32 s13, s13, s55
    s_waitcnt lgkmcnt(0)
    s_waitcnt vmcnt(21)
    s_barrier
    s_add_u32 s4, s10, 1152
    s_add_u32 m0, s52, 4096
    v_mfma_f32_16x16x32_bf16 v[54:57], v[66:69], v[42:45], v[54:57]
    buffer_load_dwordx4 v14, s[36:39], s4 offen lds
    s_add_u32 m0, s52, 5120
    v_mfma_f32_16x16x32_bf16 v[58:61], v[66:69], v[46:49], v[58:61]
    buffer_load_dwordx4 v15, s[36:39], s4 offen lds
    s_add_u32 m0, s52, 6144
    v_mfma_f32_16x16x32_bf16 v[62:65], v[66:69], v[50:53], v[62:65]
    buffer_load_dwordx4 v16, s[36:39], s4 offen lds
    s_add_u32 m0, s52, 7168
    s_nop 0
    buffer_load_dwordx4 v17, s[36:39], s4 offen lds
    s_add_u32 m0, s53, 49152
    s_nop 0
    buffer_load_dwordx4 v18, s[44:47], s13 offen lds
    s_add_u32 m0, s53, 50176
    s_nop 0
    buffer_load_dwordx4 v19, s[44:47], s13 offen lds
    s_add_u32 m0, s53, 51200
    s_nop 0
    buffer_load_dwordx4 v20, s[44:47], s13 offen lds
    s_add_u32 s13, s13, s55
    s_and_b32 s4, s2, 7
    s_lshl_b32 s4, s4, 3
    s_lshl_b64 exec, 0xff, s4
    buffer_load_dword v102, v100, s[92:95], s76 offen
    s_add_u32 s4, s76, 1310720
    buffer_load_dword v102, v100, s[92:95], s4 offen
    s_sub_u32 s4, 1300480, s76
    buffer_load_dword v102, v100, s[72:75], s4 offen
    s_mov_b64 exec, -1
    s_load_dwordx4 s[56:59], s[32:33], s62
    s_load_dword s60, s[32:33], s63
    s_mov_b32 s89, 0
    s_waitcnt vmcnt(20)
    s_barrier
    s_waitcnt lgkmcnt(0)
    v_writelane_b32 v82, s56, 0
    v_writelane_b32 v82, s57, 1
    v_writelane_b32 v82, s58, 2
    v_writelane_b32 v82, s59, 3
    s_and_b32 s4, s56, s57
    s_and_b32 s5, s58, s59
    s_and_b32 s4, s4, s5
    s_cmp_lt_u32 s7, 8
    s_cselect_b32 s4, s4, -1
    s_and_b32 s4, s4, 0x10000
    s_and_b32 s5, s60, 0xf00000
    s_or_b32 s4, s4, s5
    v_writelane_b32 v82, s89, 5
    s_or_b32 s4, s4, 16
    s_cmp_lg_u32 s4, 0xf10010
    s_cbranch_scc1 g1_l_chk2
g1_l_fbsj:
    s_lshl_b32 s4, s63, 7
    v_lshlrev_b32 v5, 3, v2
    buffer_load_dword v95, off, s[80:83], 0 offset:128 sc1
    buffer_load_dwordx2 v[96:97], v5, s[40:43], s4 offen sc1
    ds_read_b64_tr_b16 v[30:31], v78 offset:0
    ds_read_b64_tr_b16 v[32:33], v79 offset:0
    ds_read_b64_tr_b16 v[34:35], v78 offset:1024
    ds_read_b64_tr_b16 v[36:37], v79 offset:1024
    ds_read_b64_tr_b16 v[38:39], v78 offset:2048
    ds_read_b64_tr_b16 v[40:41], v79 offset:2048
    ds_read_b64_tr_b16 v[42:43], v78 offset:12288
    ds_read_b64_tr_b16 v[44:45], v79 offset:12288
    ds_read_b64_tr_b16 v[46:47], v78 offset:13312
    ds_read_b64_tr_b16 v[48:49], v79 offset:13312
    ds_read_b64_tr_b16 v[50:51], v78 offset:14336
    ds_read_b64_tr_b16 v[52:53], v79 offset:14336
    s_mov_b32 s4, 59904
    v_lshl_add_u32 v24, v2, 2, s4
    v_mov_b32 v25, 0
    s_waitcnt lgkmcnt(6)
    v_mfma_f32_16x16x32_bf16 v[54:57], v[66:69], v[30:33], v[54:57]
    v_mfma_f32_16x16x32_bf16 v[58:61], v[66:69], v[34:37], v[58:61]
    v_mfma_f32_16x16x32_bf16 v[62:65], v[66:69], v[38:41], v[62:65]
    s_mov_b64 exec, 63
    ds_write_b32 v24, v82
    s_mov_b32 exec_lo, -1
    ds_write_b32 v24, v25 offset:1408
    s_mov_b64 exec, -1
    s_waitcnt lgkmcnt(2)
    v_mfma_f32_16x16x32_bf16 v[54:57], v[66:69], v[42:45], v[54:57]
    v_mfma_f32_16x16x32_bf16 v[58:61], v[66:69], v[46:49], v[58:61]
    v_mfma_f32_16x16x32_bf16 v[62:65], v[66:69], v[50:53], v[62:65]
    s_waitcnt lgkmcnt(0)
    s_waitcnt vmcnt(5)
    s_barrier
    ds_read_b64_tr_b16 v[30:31], v78 offset:24576
    ds_read_b64_tr_b16 v[32:33], v79 offset:24576
    ds_read_b64_tr_b16 v[34:35], v78 offset:25600
    ds_read_b64_tr_b16 v[36:37], v79 offset:25600
    ds_read_b64_tr_b16 v[38:39], v78 offset:26624
    ds_read_b64_tr_b16 v[40:41], v79 offset:26624
    ds_read_b64_tr_b16 v[42:43], v78 offset:36864
    ds_read_b64_tr_b16 v[44:45], v79 offset:36864
    ds_read_b64_tr_b16 v[46:47], v78 offset:37888
    ds_read_b64_tr_b16 v[48:49], v79 offset:37888
    ds_read_b64_tr_b16 v[50:51], v78 offset:38912
    ds_read_b64_tr_b16 v[52:53], v79 offset:38912
    s_mov_b32 s65, 0xbfb8aa3b
    s_cmp_lt_u32 s7, 12
    s_cselect_b32 s65, 0x3fb8aa3b, s65
    s_lshl_b32 s4, s9, 6
    v_add_u32 v24, s4, v2
    s_mov_b32 s4, 40960
    s_mov_b32 s5, 56832
    v_lshl_add_u32 v25, v24, 4, s4
    v_lshl_add_u32 v26, v24, 2, s5
    s_waitcnt lgkmcnt(6)
    v_mfma_f32_16x16x32_bf16 v[54:57], v[66:69], v[30:33], v[54:57]
    v_mfma_f32_16x16x32_bf16 v[58:61], v[66:69], v[34:37], v[58:61]
    v_mfma_f32_16x16x32_bf16 v[62:65], v[66:69], v[38:41], v[62:65]
    ds_read_b64_tr_b16 v[30:31], v78 offset:49152
    ds_read_b64_tr_b16 v[32:33], v79 offset:49152
    ds_read_b64_tr_b16 v[34:35], v78 offset:50176
    ds_read_b64_tr_b16 v[36:37], v79 offset:50176
    ds_read_b64_tr_b16 v[38:39], v78 offset:51200
    ds_read_b64_tr_b16 v[40:41], v79 offset:51200
    s_waitcnt lgkmcnt(6)
    v_mfma_f32_16x16x32_bf16 v[54:57], v[66:69], v[42:45], v[54:57]
    v_mfma_f32_16x16x32_bf16 v[58:61], v[66:69], v[46:49], v[58:61]
    v_mfma_f32_16x16x32_bf16 v[62:65], v[66:69], v[50:53], v[62:65]
    v_and_b32 v24, 1, v4
    v_cmp_eq_u32 vcc, 0, v24
    v_mov_b32 v28, 61312
    v_mov_b32 v29, 1
    s_waitcnt lgkmcnt(0)
    v_mfma_f32_16x16x32_bf16 v[54:57], v[66:69], v[30:33], v[54:57]
    v_mfma_f32_16x16x32_bf16 v[58:61], v[66:69], v[34:37], v[58:61]
    v_mfma_f32_16x16x32_bf16 v[62:65], v[66:69], v[38:41], v[62:65]
    s_waitcnt vmcnt(0)
    v_rcp_f32 v98, v97
    v_readfirstlane_b32 s89, v95
    v_mov_b32 v94, 59924
    ds_write_b32 v94, v95
    ds_write_b32 v26, v96
    v_mul_f32 v99, s65, v98
    ds_write_b32 v26, v98 offset:1024
    ds_write_b128 v25, v[96:99]
    ds_write_b32 v26, v99 offset:2048
    s_nop 5
    v_cndmask_b32 v70, v55, v54, vcc
    ds_write_b32 v83, v70 offset:0
    v_cndmask_b32 v71, v59, v58, vcc
    ds_write_b32 v83, v71 offset:128
    v_cndmask_b32 v72, v63, v62, vcc
    ds_write_b32 v83, v72 offset:256
    s_mov_b64 exec, 1
    ds_add_u32 v28, v29 offset:96
    s_mov_b64 exec, -1
    s_mov_b32 s3, s2
    s_mov_b32 s88, 0
    v_mbcnt_lo_u32_b32 v9, -1, 0
    v_mbcnt_hi_u32_b32 v9, -1, v9
    s_and_b32 s9, s8, 3
    s_bfe_u32 s7, s3, 0x30003
    s_and_b32 s6, s3, 7
    s_lshl_b32 s6, s6, 2
    s_lshr_b32 s4, s3, 6
    s_add_u32 s6, s6, s4
    v_and_b32 v10, 15, v9
    v_lshrrev_b32 v11, 4, v9
    v_lshlrev_b32 v0, 4, v9
    s_lshl_b32 s10, s9, 12
    s_lshl_b32 s22, s9, 10
    s_lshl_b32 s11, s9, 3
    s_lshr_b32 s11, 0x270f0908, s11
    s_and_b32 s11, s11, 255
    s_lshl_b32 s11, s11, 12
    s_mov_b32 s48, s16
    s_mov_b32 s49, s17
    s_and_b32 s49, s49, 0xffff
    s_mov_b32 s50, 2621440
    s_mov_b32 s51, 0x00020000
    s_mov_b32 s52, s30
    s_mov_b32 s53, s31
    s_and_b32 s53, s53, 0xffff
    s_mov_b32 s54, 2621440
    s_mov_b32 s55, 0x00020000
    s_mov_b32 s80, s32
    s_mov_b32 s81, s33
    s_and_b32 s81, s81, 0xffff
    s_mov_b32 s82, 256
    s_mov_b32 s83, 0x00020000
    s_add_u32 s84, s34, 13713408
    s_addc_u32 s85, s35, 0
    s_and_b32 s85, s85, 0xffff
    s_mov_b32 s86, 606208
    s_mov_b32 s87, 0x00020000
    s_mul_i32 s76, s7, 74
    s_mul_i32 s77, s9, 5
    s_add_u32 s77, s77, s76
    s_add_u32 s77, s77, 54
    s_lshl_b32 s77, s77, 10
    s_mov_b32 s36, s28
    s_mov_b32 s37, s29
    s_and_b32 s37, s37, 0xffff
    s_mov_b32 s38, 2211840
    s_mov_b32 s39, 0x00020000
    s_mov_b32 s40, s20
    s_mov_b32 s41, s21
    s_and_b32 s41, s41, 0xffff
    s_mov_b32 s42, 819200
    s_mov_b32 s43, 0x00020000
    s_mul_i32 s14, s9, 14
    s_cmp_eq_u32 s9, 3
    s_cselect_b32 s4, 1, 0
    s_sub_u32 s14, s14, s4
    s_mul_i32 s12, s14, 40960
    s_mul_i32 s13, s9, 204800
    s_add_u32 s76, s76, s14
    s_lshl_b32 s76, s76, 10
    v_lshrrev_b32 v25, 3, v9
    v_and_b32 v24, 7, v9
    v_and_b32 v26, 2, v25
    v_xor_b32 v24, v24, v26
    s_lshl_b32 s4, s7, 7
    v_lshl_add_u32 v24, v24, 4, s4
    s_movk_i32 s5, 1280
    v_mad_u32_u24 v1, v25, s5, v24
    v_xor_b32 v2, 64, v1
    v_lshrrev_b32 v12, 2, v25
    v_mad_u32_u24 v12, v12, 16, v25
    v_mad_u32_u24 v12, v12, s5, v24
    v_xor_b32 v13, 64, v12
    s_add_u32 s15, s10, 65536
    v_lshrrev_b32 v24, 2, v10
    v_and_b32 v25, 3, v10
    v_lshl_add_u32 v25, v25, 3, s15
    v_and_b32 v4, 1, v11
    v_lshl_add_u32 v25, v11, 10, v25
    v_lshl_add_u32 v25, v24, 7, v25
    v_lshrrev_b32 v24, 1, v24
    v_lshl_add_u32 v24, v4, 1, v24
    v_xor_b32 v4, 0, v24
    v_lshl_add_u32 v4, v4, 5, v25
    v_xor_b32 v5, 1, v24
    v_lshl_add_u32 v5, v5, 5, v25
    v_xor_b32 v6, 2, v24
    v_lshl_add_u32 v6, v6, 5, v25
    v_xor_b32 v7, 3, v24
    v_lshl_add_u32 v7, v7, 5, v25
    v_add_u32 v8, s11, v0
    s_add_u32 m0, s11, 0
    s_add_u32 s4, s12, 0
    buffer_load_dwordx4 v1, s[36:39], s4 offen lds
    s_add_u32 m0, s11, 1024
    s_add_u32 s4, s12, 10240
    buffer_load_dwordx4 v2, s[36:39], s4 offen lds
    s_add_u32 m0, s11, 2048
    s_add_u32 s4, s12, 20480
    buffer_load_dwordx4 v1, s[36:39], s4 offen lds
    s_add_u32 m0, s11, 3072
    s_add_u32 s4, s12, 30720
    buffer_load_dwordx4 v2, s[36:39], s4 offen lds
    s_add_u32 m0, s10, 98304
    s_add_u32 s4, s12, 40960
    buffer_load_dwordx4 v1, s[36:39], s4 offen lds
    s_add_u32 m0, s10, 99328
    s_add_u32 s4, s12, 51200
    buffer_load_dwordx4 v2, s[36:39], s4 offen lds
    s_add_u32 m0, s10, 100352
    s_add_u32 s4, s12, 61440
    buffer_load_dwordx4 v1, s[36:39], s4 offen lds
    s_add_u32 m0, s10, 101376
    s_add_u32 s4, s12, 71680
    buffer_load_dwordx4 v2, s[36:39], s4 offen lds
g1_l_lc:
    ds_read_b32 v27, v28 offset:96
    s_waitcnt lgkmcnt(0)
    v_readfirstlane_b32 s4, v27
    s_cmp_lt_u32 s4, 4
    s_cbranch_scc1 g1_l_lc
    ds_read_b128 v[30:33], v86
    ds_read_b128 v[34:37], v86 offset:128
    ds_read_b128 v[38:41], v87
    ds_read_b128 v[42:45], v87 offset:128
    ds_read_b128 v[46:49], v88
    ds_read_b128 v[50:53], v88 offset:128
    ds_read_b128 v[54:57], v89
    ds_read_b128 v[58:61], v89 offset:128
    ds_read_b128 v[62:65], v90
    ds_read_b128 v[66:69], v90 offset:128
    ds_read_b128 v[70:73], v91
    ds_read_b128 v[74:77], v91 offset:128
    s_waitcnt lgkmcnt(10)
    v_add_f32 v30, v30, v34
    v_add_f32 v31, v31, v35
    v_add_f32 v32, v32, v36
    v_add_f32 v33, v33, v37
    ds_write_b128 v92, v[30:33] offset:0
    s_waitcnt lgkmcnt(9)
    v_add_f32 v38, v38, v42
    v_add_f32 v39, v39, v43
    v_add_f32 v40, v40, v44
    v_add_f32 v41, v41, v45
    ds_write_b128 v92, v[38:41] offset:64
    s_waitcnt lgkmcnt(8)
    v_add_f32 v46, v46, v50
    v_add_f32 v47, v47, v51
    v_add_f32 v48, v48, v52
    v_add_f32 v49, v49, v53
    ds_write_b128 v92, v[46:49] offset:128
    s_waitcnt lgkmcnt(7)
    v_add_f32 v54, v54, v58
    v_add_f32 v55, v55, v59
    v_add_f32 v56, v56, v60
    v_add_f32 v57, v57, v61
    ds_write_b128 v92, v[54:57] offset:192
    s_waitcnt lgkmcnt(6)
    v_add_f32 v62, v62, v66
    v_add_f32 v63, v63, v67
    v_add_f32 v64, v64, v68
    v_add_f32 v65, v65, v69
    ds_write_b128 v92, v[62:65] offset:256
    s_waitcnt lgkmcnt(5)
    v_add_f32 v70, v70, v74
    v_add_f32 v71, v71, v75
    v_add_f32 v72, v72, v76
    v_add_f32 v73, v73, v77
    ds_write_b128 v92, v[70:73] offset:320
    s_mov_b64 exec, 1
    ds_add_u32 v28, v29 offset:100
    s_mov_b64 exec, -1
    s_cmp_lg_u32 s89, 16
    s_cbranch_scc1 g1_l_zp
g1_l_zj:
    s_add_u32 s4, s76, 0
    buffer_load_dwordx4 v[132:135], v0, s[84:87], s4 offen sc1
    s_add_u32 s4, s76, 1024
    buffer_load_dwordx4 v[152:155], v0, s[84:87], s4 offen sc1
    s_add_u32 s4, s76, 2048
    buffer_load_dwordx4 v[172:175], v0, s[84:87], s4 offen sc1
    s_add_u32 s4, s76, 3072
    buffer_load_dwordx4 v[192:195], v0, s[84:87], s4 offen sc1
    s_add_u32 s4, s76, 4096
    buffer_load_dwordx4 v[212:215], v0, s[84:87], s4 offen sc1
    s_add_u32 s4, s76, 5120
    buffer_load_dwordx4 v[232:235], v0, s[84:87], s4 offen sc1
    s_add_u32 s4, s76, 6144
    buffer_load_dwordx4 v[252:255], v0, s[84:87], s4 offen sc1
g1_l_c256:
    s_sleep 1
    ds_read_b32 v27, v28 offset:12
    s_waitcnt lgkmcnt(0)
    v_readfirstlane_b32 s4, v27
    s_cmp_lt_u32 s4, 256
    s_cbranch_scc1 g1_l_c256
    s_add_u32 m0, s10, 81920
    s_add_u32 s4, s12, 81920
    buffer_load_dwordx4 v1, s[36:39], s4 offen lds
    s_add_u32 m0, s10, 82944
    s_add_u32 s4, s12, 92160
    buffer_load_dwordx4 v2, s[36:39], s4 offen lds
    s_add_u32 m0, s10, 83968
    s_add_u32 s4, s12, 102400
    buffer_load_dwordx4 v1, s[36:39], s4 offen lds
    s_add_u32 m0, s10, 84992
    s_add_u32 s4, s12, 112640
    buffer_load_dwordx4 v2, s[36:39], s4 offen lds
    s_add_u32 m0, s10, 65536
    s_add_u32 s4, s12, 122880
    buffer_load_dwordx4 v1, s[36:39], s4 offen lds
    s_add_u32 m0, s10, 66560
    s_add_u32 s4, s12, 133120
    buffer_load_dwordx4 v2, s[36:39], s4 offen lds
    s_add_u32 m0, s10, 67584
    s_add_u32 s4, s12, 143360
    buffer_load_dwordx4 v1, s[36:39], s4 offen lds
    s_add_u32 m0, s10, 68608
    s_add_u32 s4, s12, 153600
    buffer_load_dwordx4 v2, s[36:39], s4 offen lds
    s_add_u32 m0, s10, 114688
    s_add_u32 s4, s12, 163840
    buffer_load_dwordx4 v1, s[36:39], s4 offen lds
    s_add_u32 m0, s10, 115712
    s_add_u32 s4, s12, 174080
    buffer_load_dwordx4 v2, s[36:39], s4 offen lds
    s_add_u32 m0, s10, 116736
    s_add_u32 s4, s12, 184320
    buffer_load_dwordx4 v1, s[36:39], s4 offen lds
    s_add_u32 m0, s10, 117760
    s_add_u32 s4, s12, 194560
    buffer_load_dwordx4 v2, s[36:39], s4 offen lds
    s_waitcnt vmcnt(23)
    s_sub_u32 s4, s11, s15
    v_add_u32 v14, s4, v4
    v_add_u32 v15, s4, v5
    v_add_u32 v16, s4, v6
    v_add_u32 v17, s4, v7
    ds_read_b64_tr_b16 v[116:117], v14 offset:0
    ds_read_b64_tr_b16 v[118:119], v14 offset:512
    ds_read_b64_tr_b16 v[120:121], v15 offset:0
    ds_read_b64_tr_b16 v[122:123], v15 offset:512
    ds_read_b64_tr_b16 v[124:125], v16 offset:0
    ds_read_b64_tr_b16 v[126:127], v16 offset:512
    ds_read_b64_tr_b16 v[128:129], v17 offset:0
    ds_read_b64_tr_b16 v[130:131], v17 offset:512
    s_waitcnt lgkmcnt(0)
    s_add_u32 m0, s11, 0
    s_add_u32 s4, s12, 204800
    buffer_load_dwordx4 v1, s[36:39], s4 offen lds
    s_add_u32 m0, s11, 1024
    s_add_u32 s4, s12, 215040
    buffer_load_dwordx4 v2, s[36:39], s4 offen lds
    s_add_u32 m0, s11, 2048
    s_add_u32 s4, s12, 225280
    buffer_load_dwordx4 v1, s[36:39], s4 offen lds
    s_add_u32 m0, s11, 3072
    s_add_u32 s4, s12, 235520
    buffer_load_dwordx4 v2, s[36:39], s4 offen lds
    s_waitcnt vmcnt(23)
    ds_read_b64_tr_b16 v[136:137], v4 offset:32768
    ds_read_b64_tr_b16 v[138:139], v4 offset:33280
    ds_read_b64_tr_b16 v[140:141], v5 offset:32768
    ds_read_b64_tr_b16 v[142:143], v5 offset:33280
    ds_read_b64_tr_b16 v[144:145], v6 offset:32768
    ds_read_b64_tr_b16 v[146:147], v6 offset:33280
    ds_read_b64_tr_b16 v[148:149], v7 offset:32768
    ds_read_b64_tr_b16 v[150:151], v7 offset:33280
    s_waitcnt lgkmcnt(0)
    s_add_u32 m0, s10, 98304
    s_add_u32 s4, s12, 286720
    buffer_load_dwordx4 v1, s[36:39], s4 offen lds
    s_add_u32 m0, s10, 99328
    s_add_u32 s4, s12, 296960
    buffer_load_dwordx4 v2, s[36:39], s4 offen lds
    s_add_u32 m0, s10, 100352
    s_add_u32 s4, s12, 307200
    buffer_load_dwordx4 v1, s[36:39], s4 offen lds
    s_add_u32 m0, s10, 101376
    s_add_u32 s4, s12, 317440
    buffer_load_dwordx4 v2, s[36:39], s4 offen lds
g1_l_c512:
    s_sleep 1
    ds_read_b32 v27, v28 offset:12
    s_waitcnt lgkmcnt(0)
    v_readfirstlane_b32 s4, v27
    s_cmp_lt_u32 s4, 512
    s_cbranch_scc1 g1_l_c512
    s_add_u32 m0, s10, 131072
    s_add_u32 s4, s12, 245760
    buffer_load_dwordx4 v1, s[36:39], s4 offen lds
    s_add_u32 m0, s10, 132096
    s_add_u32 s4, s12, 256000
    buffer_load_dwordx4 v2, s[36:39], s4 offen lds
    s_add_u32 m0, s10, 133120
    s_add_u32 s4, s12, 266240
    buffer_load_dwordx4 v1, s[36:39], s4 offen lds
    s_add_u32 m0, s10, 134144
    s_add_u32 s4, s12, 276480
    buffer_load_dwordx4 v2, s[36:39], s4 offen lds
g1_l_c768:
    s_sleep 1
    ds_read_b32 v27, v28 offset:12
    s_waitcnt lgkmcnt(0)
    v_readfirstlane_b32 s4, v27
    s_cmp_lt_u32 s4, 768
    s_cbranch_scc1 g1_l_c768
    s_cmp_eq_u32 s89, 16
    s_cbranch_scc1 p2_P_e
    s_waitcnt vmcnt(0)
    s_branch p2_P
g1_l_zp:
    s_mov_b32 s78, 8
g1_l_zp1:
    buffer_load_dword v27, off, s[80:83], 0 offset:128 sc1
    s_waitcnt vmcnt(0)
    s_nop 0
    v_readfirstlane_b32 s89, v27
    s_cmp_eq_u32 s89, 16
    s_cbranch_scc1 g1_l_zp2
    s_sleep 4
    s_sub_u32 s78, s78, 1
    s_cbranch_scc0 g1_l_zp1
    s_mov_b32 s76, 0x7ff00000
    s_branch g1_l_zj
g1_l_zp2:
    v_mov_b32 v30, 59924
    ds_write_b32 v30, v27
    s_waitcnt lgkmcnt(0)
    s_branch g1_l_zj
g1_l_chk2:
    s_mov_b32 s56, 4
g1_l_chk3:
    buffer_load_dword v82, v84, s[80:83], 0 offen sc1
    s_waitcnt vmcnt(0)
    s_nop 0
    v_readlane_b32 s4, v82, 4
    v_readlane_b32 s89, v82, 5
    v_readlane_b32 s57, v82, 0
    v_readlane_b32 s58, v82, 1
    v_readlane_b32 s59, v82, 2
    v_readlane_b32 s60, v82, 3
    s_and_b32 s4, s4, 0xf00000
    s_and_b32 s57, s57, s58
    s_and_b32 s59, s59, s60
    s_and_b32 s57, s57, s59
    s_cmp_lt_u32 s7, 8
    s_cselect_b32 s57, s57, -1
    s_and_b32 s57, s57, 0x10000
    s_or_b32 s57, s57, s4
    s_or_b32 s57, s57, 16
    s_cmp_eq_u32 s57, 0xf10010
    s_cbranch_scc1 g1_l_fbsj
    s_sub_u32 s56, s56, 1
    s_cbranch_scc0 g1_l_chk3
    s_cmp_eq_u32 s4, 0xf00000
    s_cbranch_scc1 g1_l_fbsj
    s_mov_b32 s84, s16
    s_mov_b32 s85, s17
    s_and_b32 s85, s85, 0xffff
    s_mov_b32 s86, 2621440
    s_mov_b32 s87, 0x00020000
    s_lshl_b32 s96, s63, 4
    s_mov_b32 s97, 4
g1_l_fbs_loop:
    v_lshrrev_b32 v5, 3, v2
    v_and_b32 v6, 7, v2
    v_add_u32 v5, s96, v5
    v_mul_u32_u24 v7, 1280, v5
    v_lshl_add_u32 v7, v6, 4, v7
    v_add_u32 v8, 10240, v7
    buffer_load_dwordx4 v[116:119], v7, s[84:87], 0 offen offset:0
    buffer_load_dwordx4 v[120:123], v7, s[84:87], 0 offen offset:128
    buffer_load_dwordx4 v[124:127], v7, s[84:87], 0 offen offset:256
    buffer_load_dwordx4 v[128:131], v7, s[84:87], 0 offen offset:384
    buffer_load_dwordx4 v[132:135], v7, s[84:87], 0 offen offset:512
    buffer_load_dwordx4 v[136:139], v7, s[84:87], 0 offen offset:640
    buffer_load_dwordx4 v[140:143], v7, s[84:87], 0 offen offset:768
    buffer_load_dwordx4 v[144:147], v7, s[84:87], 0 offen offset:896
    buffer_load_dwordx4 v[148:151], v7, s[84:87], 0 offen offset:1024
    buffer_load_dwordx4 v[152:155], v7, s[84:87], 0 offen offset:1152
    buffer_load_dwordx4 v[156:159], v8, s[84:87], 0 offen offset:0
    buffer_load_dwordx4 v[160:163], v8, s[84:87], 0 offen offset:128
    buffer_load_dwordx4 v[164:167], v8, s[84:87], 0 offen offset:256
    buffer_load_dwordx4 v[168:171], v8, s[84:87], 0 offen offset:384
    buffer_load_dwordx4 v[172:175], v8, s[84:87], 0 offen offset:512
    buffer_load_dwordx4 v[176:179], v8, s[84:87], 0 offen offset:640
    buffer_load_dwordx4 v[180:183], v8, s[84:87], 0 offen offset:768
    buffer_load_dwordx4 v[184:187], v8, s[84:87], 0 offen offset:896
    buffer_load_dwordx4 v[188:191], v8, s[84:87], 0 offen offset:1024
    buffer_load_dwordx4 v[192:195], v8, s[84:87], 0 offen offset:1152
    s_mov_b32 s4, 0x3f803f80
    v_mov_b32 v20, 0
    v_mov_b32 v21, 0
    v_mov_b32 v22, 0
    v_mov_b32 v23, 0
    v_mov_b32 v24, 0
    v_mov_b32 v25, 0
    v_mov_b32 v26, 0
    v_mov_b32 v27, 0
    s_waitcnt vmcnt(19)
    v_dot2_f32_bf16 v20, v116, s4, v20
    v_dot2_f32_bf16 v22, v116, v116, v22
    v_dot2_f32_bf16 v21, v117, s4, v21
    v_dot2_f32_bf16 v23, v117, v117, v23
    v_dot2_f32_bf16 v20, v118, s4, v20
    v_dot2_f32_bf16 v22, v118, v118, v22
    v_dot2_f32_bf16 v21, v119, s4, v21
    v_dot2_f32_bf16 v23, v119, v119, v23
    s_waitcnt vmcnt(18)
    v_dot2_f32_bf16 v20, v120, s4, v20
    v_dot2_f32_bf16 v22, v120, v120, v22
    v_dot2_f32_bf16 v21, v121, s4, v21
    v_dot2_f32_bf16 v23, v121, v121, v23
    v_dot2_f32_bf16 v20, v122, s4, v20
    v_dot2_f32_bf16 v22, v122, v122, v22
    v_dot2_f32_bf16 v21, v123, s4, v21
    v_dot2_f32_bf16 v23, v123, v123, v23
    s_waitcnt vmcnt(17)
    v_dot2_f32_bf16 v20, v124, s4, v20
    v_dot2_f32_bf16 v22, v124, v124, v22
    v_dot2_f32_bf16 v21, v125, s4, v21
    v_dot2_f32_bf16 v23, v125, v125, v23
    v_dot2_f32_bf16 v20, v126, s4, v20
    v_dot2_f32_bf16 v22, v126, v126, v22
    v_dot2_f32_bf16 v21, v127, s4, v21
    v_dot2_f32_bf16 v23, v127, v127, v23
    s_waitcnt vmcnt(16)
    v_dot2_f32_bf16 v20, v128, s4, v20
    v_dot2_f32_bf16 v22, v128, v128, v22
    v_dot2_f32_bf16 v21, v129, s4, v21
    v_dot2_f32_bf16 v23, v129, v129, v23
    v_dot2_f32_bf16 v20, v130, s4, v20
    v_dot2_f32_bf16 v22, v130, v130, v22
    v_dot2_f32_bf16 v21, v131, s4, v21
    v_dot2_f32_bf16 v23, v131, v131, v23
    s_waitcnt vmcnt(15)
    v_dot2_f32_bf16 v20, v132, s4, v20
    v_dot2_f32_bf16 v22, v132, v132, v22
    v_dot2_f32_bf16 v21, v133, s4, v21
    v_dot2_f32_bf16 v23, v133, v133, v23
    v_dot2_f32_bf16 v20, v134, s4, v20
    v_dot2_f32_bf16 v22, v134, v134, v22
    v_dot2_f32_bf16 v21, v135, s4, v21
    v_dot2_f32_bf16 v23, v135, v135, v23
    s_waitcnt vmcnt(14)
    v_dot2_f32_bf16 v20, v136, s4, v20
    v_dot2_f32_bf16 v22, v136, v136, v22
    v_dot2_f32_bf16 v21, v137, s4, v21
    v_dot2_f32_bf16 v23, v137, v137, v23
    v_dot2_f32_bf16 v20, v138, s4, v20
    v_dot2_f32_bf16 v22, v138, v138, v22
    v_dot2_f32_bf16 v21, v139, s4, v21
    v_dot2_f32_bf16 v23, v139, v139, v23
    s_waitcnt vmcnt(13)
    v_dot2_f32_bf16 v20, v140, s4, v20
    v_dot2_f32_bf16 v22, v140, v140, v22
    v_dot2_f32_bf16 v21, v141, s4, v21
    v_dot2_f32_bf16 v23, v141, v141, v23
    v_dot2_f32_bf16 v20, v142, s4, v20
    v_dot2_f32_bf16 v22, v142, v142, v22
    v_dot2_f32_bf16 v21, v143, s4, v21
    v_dot2_f32_bf16 v23, v143, v143, v23
    s_waitcnt vmcnt(12)
    v_dot2_f32_bf16 v20, v144, s4, v20
    v_dot2_f32_bf16 v22, v144, v144, v22
    v_dot2_f32_bf16 v21, v145, s4, v21
    v_dot2_f32_bf16 v23, v145, v145, v23
    v_dot2_f32_bf16 v20, v146, s4, v20
    v_dot2_f32_bf16 v22, v146, v146, v22
    v_dot2_f32_bf16 v21, v147, s4, v21
    v_dot2_f32_bf16 v23, v147, v147, v23
    s_waitcnt vmcnt(11)
    v_dot2_f32_bf16 v20, v148, s4, v20
    v_dot2_f32_bf16 v22, v148, v148, v22
    v_dot2_f32_bf16 v21, v149, s4, v21
    v_dot2_f32_bf16 v23, v149, v149, v23
    v_dot2_f32_bf16 v20, v150, s4, v20
    v_dot2_f32_bf16 v22, v150, v150, v22
    v_dot2_f32_bf16 v21, v151, s4, v21
    v_dot2_f32_bf16 v23, v151, v151, v23
    s_waitcnt vmcnt(10)
    v_dot2_f32_bf16 v20, v152, s4, v20
    v_dot2_f32_bf16 v22, v152, v152, v22
    v_dot2_f32_bf16 v21, v153, s4, v21
    v_dot2_f32_bf16 v23, v153, v153, v23
    v_dot2_f32_bf16 v20, v154, s4, v20
    v_dot2_f32_bf16 v22, v154, v154, v22
    v_dot2_f32_bf16 v21, v155, s4, v21
    v_dot2_f32_bf16 v23, v155, v155, v23
    s_waitcnt vmcnt(9)
    v_dot2_f32_bf16 v24, v156, s4, v24
    v_dot2_f32_bf16 v26, v156, v156, v26
    v_dot2_f32_bf16 v25, v157, s4, v25
    v_dot2_f32_bf16 v27, v157, v157, v27
    v_dot2_f32_bf16 v24, v158, s4, v24
    v_dot2_f32_bf16 v26, v158, v158, v26
    v_dot2_f32_bf16 v25, v159, s4, v25
    v_dot2_f32_bf16 v27, v159, v159, v27
    s_waitcnt vmcnt(8)
    v_dot2_f32_bf16 v24, v160, s4, v24
    v_dot2_f32_bf16 v26, v160, v160, v26
    v_dot2_f32_bf16 v25, v161, s4, v25
    v_dot2_f32_bf16 v27, v161, v161, v27
    v_dot2_f32_bf16 v24, v162, s4, v24
    v_dot2_f32_bf16 v26, v162, v162, v26
    v_dot2_f32_bf16 v25, v163, s4, v25
    v_dot2_f32_bf16 v27, v163, v163, v27
    s_waitcnt vmcnt(7)
    v_dot2_f32_bf16 v24, v164, s4, v24
    v_dot2_f32_bf16 v26, v164, v164, v26
    v_dot2_f32_bf16 v25, v165, s4, v25
    v_dot2_f32_bf16 v27, v165, v165, v27
    v_dot2_f32_bf16 v24, v166, s4, v24
    v_dot2_f32_bf16 v26, v166, v166, v26
    v_dot2_f32_bf16 v25, v167, s4, v25
    v_dot2_f32_bf16 v27, v167, v167, v27
    s_waitcnt vmcnt(6)
    v_dot2_f32_bf16 v24, v168, s4, v24
    v_dot2_f32_bf16 v26, v168, v168, v26
    v_dot2_f32_bf16 v25, v169, s4, v25
    v_dot2_f32_bf16 v27, v169, v169, v27
    v_dot2_f32_bf16 v24, v170, s4, v24
    v_dot2_f32_bf16 v26, v170, v170, v26
    v_dot2_f32_bf16 v25, v171, s4, v25
    v_dot2_f32_bf16 v27, v171, v171, v27
    s_waitcnt vmcnt(5)
    v_dot2_f32_bf16 v24, v172, s4, v24
    v_dot2_f32_bf16 v26, v172, v172, v26
    v_dot2_f32_bf16 v25, v173, s4, v25
    v_dot2_f32_bf16 v27, v173, v173, v27
    v_dot2_f32_bf16 v24, v174, s4, v24
    v_dot2_f32_bf16 v26, v174, v174, v26
    v_dot2_f32_bf16 v25, v175, s4, v25
    v_dot2_f32_bf16 v27, v175, v175, v27
    s_waitcnt vmcnt(4)
    v_dot2_f32_bf16 v24, v176, s4, v24
    v_dot2_f32_bf16 v26, v176, v176, v26
    v_dot2_f32_bf16 v25, v177, s4, v25
    v_dot2_f32_bf16 v27, v177, v177, v27
    v_dot2_f32_bf16 v24, v178, s4, v24
    v_dot2_f32_bf16 v26, v178, v178, v26
    v_dot2_f32_bf16 v25, v179, s4, v25
    v_dot2_f32_bf16 v27, v179, v179, v27
    s_waitcnt vmcnt(3)
    v_dot2_f32_bf16 v24, v180, s4, v24
    v_dot2_f32_bf16 v26, v180, v180, v26
    v_dot2_f32_bf16 v25, v181, s4, v25
    v_dot2_f32_bf16 v27, v181, v181, v27
    v_dot2_f32_bf16 v24, v182, s4, v24
    v_dot2_f32_bf16 v26, v182, v182, v26
    v_dot2_f32_bf16 v25, v183, s4, v25
    v_dot2_f32_bf16 v27, v183, v183, v27
    s_waitcnt vmcnt(2)
    v_dot2_f32_bf16 v24, v184, s4, v24
    v_dot2_f32_bf16 v26, v184, v184, v26
    v_dot2_f32_bf16 v25, v185, s4, v25
    v_dot2_f32_bf16 v27, v185, v185, v27
    v_dot2_f32_bf16 v24, v186, s4, v24
    v_dot2_f32_bf16 v26, v186, v186, v26
    v_dot2_f32_bf16 v25, v187, s4, v25
    v_dot2_f32_bf16 v27, v187, v187, v27
    s_waitcnt vmcnt(1)
    v_dot2_f32_bf16 v24, v188, s4, v24
    v_dot2_f32_bf16 v26, v188, v188, v26
    v_dot2_f32_bf16 v25, v189, s4, v25
    v_dot2_f32_bf16 v27, v189, v189, v27
    v_dot2_f32_bf16 v24, v190, s4, v24
    v_dot2_f32_bf16 v26, v190, v190, v26
    v_dot2_f32_bf16 v25, v191, s4, v25
    v_dot2_f32_bf16 v27, v191, v191, v27
    s_waitcnt vmcnt(0)
    v_dot2_f32_bf16 v24, v192, s4, v24
    v_dot2_f32_bf16 v26, v192, v192, v26
    v_dot2_f32_bf16 v25, v193, s4, v25
    v_dot2_f32_bf16 v27, v193, v193, v27
    v_dot2_f32_bf16 v24, v194, s4, v24
    v_dot2_f32_bf16 v26, v194, v194, v26
    v_dot2_f32_bf16 v25, v195, s4, v25
    v_dot2_f32_bf16 v27, v195, v195, v27
    s_nop 2
    v_add_f32 v20, v20, v21
    v_add_f32 v22, v22, v23
    v_add_f32 v24, v24, v25
    v_add_f32 v26, v26, v27
    s_nop 1
    v_add_f32_dpp v20, v20, v20 quad_perm:[1,0,3,2] row_mask:0xf bank_mask:0xf
    v_add_f32_dpp v22, v22, v22 quad_perm:[1,0,3,2] row_mask:0xf bank_mask:0xf
    v_add_f32_dpp v24, v24, v24 quad_perm:[1,0,3,2] row_mask:0xf bank_mask:0xf
    v_add_f32_dpp v26, v26, v26 quad_perm:[1,0,3,2] row_mask:0xf bank_mask:0xf
    s_nop 1
    v_add_f32_dpp v20, v20, v20 quad_perm:[2,3,0,1] row_mask:0xf bank_mask:0xf
    v_add_f32_dpp v22, v22, v22 quad_perm:[2,3,0,1] row_mask:0xf bank_mask:0xf
    v_add_f32_dpp v24, v24, v24 quad_perm:[2,3,0,1] row_mask:0xf bank_mask:0xf
    v_add_f32_dpp v26, v26, v26 quad_perm:[2,3,0,1] row_mask:0xf bank_mask:0xf
    s_nop 1
    v_add_f32_dpp v20, v20, v20 row_half_mirror row_mask:0xf bank_mask:0xf
    v_add_f32_dpp v22, v22, v22 row_half_mirror row_mask:0xf bank_mask:0xf
    v_add_f32_dpp v24, v24, v24 row_half_mirror row_mask:0xf bank_mask:0xf
    v_add_f32_dpp v26, v26, v26 row_half_mirror row_mask:0xf bank_mask:0xf
    v_mul_f32 v20, 0x3acccccd, v20
    v_mul_f32 v22, 0x3acccccd, v22
    v_fma_f32 v22, -v20, v20, v22
    v_cvt_pk_bf16_f32 v9, v20, v22
    v_lshlrev_b32 v20, 16, v9
    v_and_b32 v22, 0xffff0000, v9
    v_add_f32 v22, 0x3727c5ac, v22
    v_mul_f32 v24, 0x3acccccd, v24
    v_mul_f32 v26, 0x3acccccd, v26
    v_fma_f32 v26, -v24, v24, v26
    v_cvt_pk_bf16_f32 v9, v24, v26
    v_lshlrev_b32 v24, 16, v9
    v_and_b32 v26, 0xffff0000, v9
    v_add_f32 v26, 0x3727c5ac, v26
    v_cvt_pk_bf16_f32 v9, v22, v26
    v_lshlrev_b32 v22, 16, v9
    v_and_b32 v26, 0xffff0000, v9
    v_sqrt_f32 v22, v22
    v_sqrt_f32 v26, v26
    s_nop 0
    v_cvt_pk_bf16_f32 v9, v22, v26
    v_lshlrev_b32 v22, 16, v9
    v_and_b32 v26, 0xffff0000, v9
    v_mov_b32 v23, v22
    v_mov_b32 v27, v26
    v_xor_b32 v22, 0x80000000, v20
    v_xor_b32 v26, 0x80000000, v24
    v_lshlrev_b32 v5, 3, v5
    v_mov_b32 v9, 0x7ff00000
    v_cmp_eq_u32 vcc, 0, v6
    s_nop 1
    v_cndmask_b32 v5, v9, v5, vcc
    buffer_store_dwordx2 v[22:23], v5, s[40:43], 0 offen sc1
    buffer_store_dwordx2 v[26:27], v5, s[40:43], 0 offen offset:64 sc1
    s_add_u32 s96, s96, 16
    s_sub_u32 s97, s97, 1
    s_cmp_lg_u32 s97, 0
    s_cbranch_scc1 g1_l_fbs_loop
    s_waitcnt vmcnt(0)
    s_branch g1_l_fbsj
g1_pack:
    v_lshlrev_b32 v1, 4, v2
    s_sub_u32 s15, s2, 240
    s_lshl_b32 s15, s15, 3
    s_add_u32 s15, s15, s8
    s_lshl_b32 s96, s15, 4
    v_mov_b32 v19, 0
    s_waitcnt lgkmcnt(0)
    s_mov_b32 s84, s16
    s_mov_b32 s85, s17
    s_and_b32 s85, s85, 0xffff
    s_mov_b32 s86, 2621440
    s_mov_b32 s87, 0x00020000
    v_lshrrev_b32 v5, 3, v2
    v_and_b32 v6, 7, v2
    v_add_u32 v5, s96, v5
    v_mul_u32_u24 v7, 1280, v5
    v_lshl_add_u32 v7, v6, 4, v7
    v_add_u32 v8, 10240, v7
    buffer_load_dwordx4 v[30:33], v7, s[84:87], 0 offen offset:0
    buffer_load_dwordx4 v[34:37], v7, s[84:87], 0 offen offset:128
    buffer_load_dwordx4 v[38:41], v7, s[84:87], 0 offen offset:256
    buffer_load_dwordx4 v[42:45], v7, s[84:87], 0 offen offset:384
    buffer_load_dwordx4 v[46:49], v7, s[84:87], 0 offen offset:512
    buffer_load_dwordx4 v[50:53], v7, s[84:87], 0 offen offset:640
    buffer_load_dwordx4 v[54:57], v7, s[84:87], 0 offen offset:768
    buffer_load_dwordx4 v[58:61], v7, s[84:87], 0 offen offset:896
    buffer_load_dwordx4 v[62:65], v7, s[84:87], 0 offen offset:1024
    buffer_load_dwordx4 v[66:69], v7, s[84:87], 0 offen offset:1152
    buffer_load_dwordx4 v[70:73], v8, s[84:87], 0 offen offset:0
    buffer_load_dwordx4 v[74:77], v8, s[84:87], 0 offen offset:128
    buffer_load_dwordx4 v[78:81], v8, s[84:87], 0 offen offset:256
    buffer_load_dwordx4 v[82:85], v8, s[84:87], 0 offen offset:384
    buffer_load_dwordx4 v[86:89], v8, s[84:87], 0 offen offset:512
    buffer_load_dwordx4 v[90:93], v8, s[84:87], 0 offen offset:640
    buffer_load_dwordx4 v[94:97], v8, s[84:87], 0 offen offset:768
    buffer_load_dwordx4 v[98:101], v8, s[84:87], 0 offen offset:896
    buffer_load_dwordx4 v[102:105], v8, s[84:87], 0 offen offset:1024
    buffer_load_dwordx4 v[106:109], v8, s[84:87], 0 offen offset:1152
    s_mov_b32 s80, s32
    s_mov_b32 s81, s33
    s_and_b32 s81, s81, 0xffff
    s_mov_b32 s82, 256
    s_mov_b32 s83, 0x00020000
    s_mov_b32 s40, s34
    s_mov_b32 s41, s35
    s_and_b32 s41, s41, 0xffff
    s_mov_b32 s42, 16384
    s_mov_b32 s43, 0x00020000
    s_add_u32 s44, s34, 11288576
    s_addc_u32 s45, s35, 0
    s_and_b32 s45, s45, 0xffff
    s_mov_b32 s46, 65536
    s_mov_b32 s47, 0x00020000
    v_mov_b32 v24, 0
    v_mov_b32 v25, 0
    v_mov_b32 v26, 0
    v_mov_b32 v27, 0
    s_sub_u32 s7, s2, 240
    s_lshl_b32 s7, s7, 2
    s_add_u32 s7, s7, s8
    s_cmp_lt_u32 s8, 4
    s_cselect_b32 s7, s7, 64
    s_cmp_lt_u32 s7, 32
    s_cselect_b32 s7, s7, 64
    s_lshl_b32 s4, s7, 11
    buffer_store_dwordx4 v[24:27], v1, s[44:47], s4 offen offset:0 sc1
    buffer_store_dwordx4 v[24:27], v1, s[44:47], s4 offen offset:1024 sc1
    s_add_u32 s48, s34, 11419648
    s_addc_u32 s49, s35, 0
    s_and_b32 s49, s49, 0xffff
    s_mov_b32 s50, 524288
    s_mov_b32 s51, 0x00020000
    s_sub_u32 s4, s15, 126
    s_mul_i32 s4, s4, 262144
    s_cmp_lt_u32 s15, 126
    s_cselect_b32 s4, 524288, s4
    v_mul_u32_u24 v10, 4096, v2
    buffer_store_dwordx4 v[24:27], v10, s[48:51], s4 offen sc1
    s_sub_u32 s10, s2, 240
    s_mul_i32 s10, s10, 5
    s_add_u32 s10, s10, s8
    s_cmp_lt_u32 s8, 5
    s_cselect_b32 s10, s10, 127
    s_sub_u32 s4, s10, 54
    s_mul_i32 s5, s4, 52
    s_lshr_b32 s5, s5, 8
    s_mul_i32 s6, s5, 5
    s_sub_u32 s6, s4, s6
    s_mul_i32 s5, s5, 204800
    s_mul_i32 s11, s6, 51200
    s_cmp_eq_u32 s6, 4
    s_cselect_b32 s11, 20480, s11
    s_cselect_b32 s12, 80, 20
    s_cselect_b32 s13, 20, 1
    s_movk_i32 s14, 5120
    s_cselect_b32 s14, 1280, s14
    s_add_u32 s11, s11, s5
    s_mul_i32 s5, s10, 40960
    s_cmp_lt_u32 s10, 54
    s_cselect_b32 s11, s5, s11
    s_cselect_b32 s12, 4, s12
    s_cselect_b32 s13, 1, s13
    s_cselect_b32 s14, 10240, s14
    s_cselect_b64 s[52:53], s[28:29], s[20:21]
    s_mov_b32 s54, 819200
    s_cselect_b32 s54, 2211840, s54
    s_and_b32 s53, s53, 0xffff
    s_mov_b32 s55, 0x00020000
    s_cmp_lt_u32 s10, 74
    s_cselect_b32 s11, s11, 0x7ff00000
    v_lshrrev_b32 v10, 5, v2
    v_bfe_u32 v11, v2, 3, 2
    v_mul_lo_u32 v10, v10, s12
    v_mul_lo_u32 v12, v11, s13
    v_add_u32 v10, v10, v12
    v_mul_u32_u24 v10, 1280, v10
    v_and_b32 v11, 2, v11
    v_and_b32 v12, 7, v2
    v_xor_b32 v11, v11, v12
    v_lshl_add_u32 v10, v11, 4, v10
    v_add_u32 v10, 1024, v10
    v_xor_b32 v11, 64, v10
    s_lshl_b32 s12, s8, 13
    s_add_u32 m0, s12, 0
    s_nop 0
    buffer_load_dwordx4 v10, s[52:55], s11 offen offset:0 lds
    s_add_u32 m0, s12, 3968
    s_nop 0
    buffer_load_dwordx4 v10, s[52:55], s11 offen offset:128 lds
    s_add_u32 s11, s11, s14
    s_add_u32 m0, s12, 1024
    s_nop 0
    buffer_load_dwordx4 v11, s[52:55], s11 offen offset:0 lds
    s_add_u32 m0, s12, 4992
    s_nop 0
    buffer_load_dwordx4 v11, s[52:55], s11 offen offset:128 lds
    s_add_u32 s11, s11, s14
    s_add_u32 m0, s12, 2048
    s_nop 0
    buffer_load_dwordx4 v10, s[52:55], s11 offen offset:0 lds
    s_add_u32 m0, s12, 6016
    s_nop 0
    buffer_load_dwordx4 v10, s[52:55], s11 offen offset:128 lds
    s_add_u32 s11, s11, s14
    s_add_u32 m0, s12, 3072
    s_nop 0
    buffer_load_dwordx4 v11, s[52:55], s11 offen offset:0 lds
    s_add_u32 m0, s12, 7040
    s_nop 0
    buffer_load_dwordx4 v11, s[52:55], s11 offen offset:128 lds
    s_mov_b32 s4, 0x3f803f80
    v_mov_b32 v20, 0
    v_mov_b32 v21, 0
    v_mov_b32 v22, 0
    v_mov_b32 v23, 0
    v_mov_b32 v24, 0
    v_mov_b32 v25, 0
    v_mov_b32 v26, 0
    v_mov_b32 v27, 0
    s_waitcnt vmcnt(30)
    v_dot2_f32_bf16 v20, v30, s4, v20
    v_dot2_f32_bf16 v22, v30, v30, v22
    v_dot2_f32_bf16 v21, v31, s4, v21
    v_dot2_f32_bf16 v23, v31, v31, v23
    v_dot2_f32_bf16 v20, v32, s4, v20
    v_dot2_f32_bf16 v22, v32, v32, v22
    v_dot2_f32_bf16 v21, v33, s4, v21
    v_dot2_f32_bf16 v23, v33, v33, v23
    s_waitcnt vmcnt(29)
    v_dot2_f32_bf16 v20, v34, s4, v20
    v_dot2_f32_bf16 v22, v34, v34, v22
    v_dot2_f32_bf16 v21, v35, s4, v21
    v_dot2_f32_bf16 v23, v35, v35, v23
    v_dot2_f32_bf16 v20, v36, s4, v20
    v_dot2_f32_bf16 v22, v36, v36, v22
    v_dot2_f32_bf16 v21, v37, s4, v21
    v_dot2_f32_bf16 v23, v37, v37, v23
    s_waitcnt vmcnt(28)
    v_dot2_f32_bf16 v20, v38, s4, v20
    v_dot2_f32_bf16 v22, v38, v38, v22
    v_dot2_f32_bf16 v21, v39, s4, v21
    v_dot2_f32_bf16 v23, v39, v39, v23
    v_dot2_f32_bf16 v20, v40, s4, v20
    v_dot2_f32_bf16 v22, v40, v40, v22
    v_dot2_f32_bf16 v21, v41, s4, v21
    v_dot2_f32_bf16 v23, v41, v41, v23
    s_waitcnt vmcnt(27)
    v_dot2_f32_bf16 v20, v42, s4, v20
    v_dot2_f32_bf16 v22, v42, v42, v22
    v_dot2_f32_bf16 v21, v43, s4, v21
    v_dot2_f32_bf16 v23, v43, v43, v23
    v_dot2_f32_bf16 v20, v44, s4, v20
    v_dot2_f32_bf16 v22, v44, v44, v22
    v_dot2_f32_bf16 v21, v45, s4, v21
    v_dot2_f32_bf16 v23, v45, v45, v23
    s_waitcnt vmcnt(26)
    v_dot2_f32_bf16 v20, v46, s4, v20
    v_dot2_f32_bf16 v22, v46, v46, v22
    v_dot2_f32_bf16 v21, v47, s4, v21
    v_dot2_f32_bf16 v23, v47, v47, v23
    v_dot2_f32_bf16 v20, v48, s4, v20
    v_dot2_f32_bf16 v22, v48, v48, v22
    v_dot2_f32_bf16 v21, v49, s4, v21
    v_dot2_f32_bf16 v23, v49, v49, v23
    s_waitcnt vmcnt(25)
    v_dot2_f32_bf16 v20, v50, s4, v20
    v_dot2_f32_bf16 v22, v50, v50, v22
    v_dot2_f32_bf16 v21, v51, s4, v21
    v_dot2_f32_bf16 v23, v51, v51, v23
    v_dot2_f32_bf16 v20, v52, s4, v20
    v_dot2_f32_bf16 v22, v52, v52, v22
    v_dot2_f32_bf16 v21, v53, s4, v21
    v_dot2_f32_bf16 v23, v53, v53, v23
    s_waitcnt vmcnt(24)
    v_dot2_f32_bf16 v20, v54, s4, v20
    v_dot2_f32_bf16 v22, v54, v54, v22
    v_dot2_f32_bf16 v21, v55, s4, v21
    v_dot2_f32_bf16 v23, v55, v55, v23
    v_dot2_f32_bf16 v20, v56, s4, v20
    v_dot2_f32_bf16 v22, v56, v56, v22
    v_dot2_f32_bf16 v21, v57, s4, v21
    v_dot2_f32_bf16 v23, v57, v57, v23
    s_waitcnt vmcnt(23)
    v_dot2_f32_bf16 v20, v58, s4, v20
    v_dot2_f32_bf16 v22, v58, v58, v22
    v_dot2_f32_bf16 v21, v59, s4, v21
    v_dot2_f32_bf16 v23, v59, v59, v23
    v_dot2_f32_bf16 v20, v60, s4, v20
    v_dot2_f32_bf16 v22, v60, v60, v22
    v_dot2_f32_bf16 v21, v61, s4, v21
    v_dot2_f32_bf16 v23, v61, v61, v23
    s_waitcnt vmcnt(22)
    v_dot2_f32_bf16 v20, v62, s4, v20
    v_dot2_f32_bf16 v22, v62, v62, v22
    v_dot2_f32_bf16 v21, v63, s4, v21
    v_dot2_f32_bf16 v23, v63, v63, v23
    v_dot2_f32_bf16 v20, v64, s4, v20
    v_dot2_f32_bf16 v22, v64, v64, v22
    v_dot2_f32_bf16 v21, v65, s4, v21
    v_dot2_f32_bf16 v23, v65, v65, v23
    s_waitcnt vmcnt(21)
    v_dot2_f32_bf16 v20, v66, s4, v20
    v_dot2_f32_bf16 v22, v66, v66, v22
    v_dot2_f32_bf16 v21, v67, s4, v21
    v_dot2_f32_bf16 v23, v67, v67, v23
    v_dot2_f32_bf16 v20, v68, s4, v20
    v_dot2_f32_bf16 v22, v68, v68, v22
    v_dot2_f32_bf16 v21, v69, s4, v21
    v_dot2_f32_bf16 v23, v69, v69, v23
    s_waitcnt vmcnt(20)
    v_dot2_f32_bf16 v24, v70, s4, v24
    v_dot2_f32_bf16 v26, v70, v70, v26
    v_dot2_f32_bf16 v25, v71, s4, v25
    v_dot2_f32_bf16 v27, v71, v71, v27
    v_dot2_f32_bf16 v24, v72, s4, v24
    v_dot2_f32_bf16 v26, v72, v72, v26
    v_dot2_f32_bf16 v25, v73, s4, v25
    v_dot2_f32_bf16 v27, v73, v73, v27
    s_waitcnt vmcnt(19)
    v_dot2_f32_bf16 v24, v74, s4, v24
    v_dot2_f32_bf16 v26, v74, v74, v26
    v_dot2_f32_bf16 v25, v75, s4, v25
    v_dot2_f32_bf16 v27, v75, v75, v27
    v_dot2_f32_bf16 v24, v76, s4, v24
    v_dot2_f32_bf16 v26, v76, v76, v26
    v_dot2_f32_bf16 v25, v77, s4, v25
    v_dot2_f32_bf16 v27, v77, v77, v27
    s_waitcnt vmcnt(18)
    v_dot2_f32_bf16 v24, v78, s4, v24
    v_dot2_f32_bf16 v26, v78, v78, v26
    v_dot2_f32_bf16 v25, v79, s4, v25
    v_dot2_f32_bf16 v27, v79, v79, v27
    v_dot2_f32_bf16 v24, v80, s4, v24
    v_dot2_f32_bf16 v26, v80, v80, v26
    v_dot2_f32_bf16 v25, v81, s4, v25
    v_dot2_f32_bf16 v27, v81, v81, v27
    s_waitcnt vmcnt(17)
    v_dot2_f32_bf16 v24, v82, s4, v24
    v_dot2_f32_bf16 v26, v82, v82, v26
    v_dot2_f32_bf16 v25, v83, s4, v25
    v_dot2_f32_bf16 v27, v83, v83, v27
    v_dot2_f32_bf16 v24, v84, s4, v24
    v_dot2_f32_bf16 v26, v84, v84, v26
    v_dot2_f32_bf16 v25, v85, s4, v25
    v_dot2_f32_bf16 v27, v85, v85, v27
    s_waitcnt vmcnt(16)
    v_dot2_f32_bf16 v24, v86, s4, v24
    v_dot2_f32_bf16 v26, v86, v86, v26
    v_dot2_f32_bf16 v25, v87, s4, v25
    v_dot2_f32_bf16 v27, v87, v87, v27
    v_dot2_f32_bf16 v24, v88, s4, v24
    v_dot2_f32_bf16 v26, v88, v88, v26
    v_dot2_f32_bf16 v25, v89, s4, v25
    v_dot2_f32_bf16 v27, v89, v89, v27
    s_waitcnt vmcnt(15)
    v_dot2_f32_bf16 v24, v90, s4, v24
    v_dot2_f32_bf16 v26, v90, v90, v26
    v_dot2_f32_bf16 v25, v91, s4, v25
    v_dot2_f32_bf16 v27, v91, v91, v27
    v_dot2_f32_bf16 v24, v92, s4, v24
    v_dot2_f32_bf16 v26, v92, v92, v26
    v_dot2_f32_bf16 v25, v93, s4, v25
    v_dot2_f32_bf16 v27, v93, v93, v27
    s_waitcnt vmcnt(14)
    v_dot2_f32_bf16 v24, v94, s4, v24
    v_dot2_f32_bf16 v26, v94, v94, v26
    v_dot2_f32_bf16 v25, v95, s4, v25
    v_dot2_f32_bf16 v27, v95, v95, v27
    v_dot2_f32_bf16 v24, v96, s4, v24
    v_dot2_f32_bf16 v26, v96, v96, v26
    v_dot2_f32_bf16 v25, v97, s4, v25
    v_dot2_f32_bf16 v27, v97, v97, v27
    s_waitcnt vmcnt(13)
    v_dot2_f32_bf16 v24, v98, s4, v24
    v_dot2_f32_bf16 v26, v98, v98, v26
    v_dot2_f32_bf16 v25, v99, s4, v25
    v_dot2_f32_bf16 v27, v99, v99, v27
    v_dot2_f32_bf16 v24, v100, s4, v24
    v_dot2_f32_bf16 v26, v100, v100, v26
    v_dot2_f32_bf16 v25, v101, s4, v25
    v_dot2_f32_bf16 v27, v101, v101, v27
    s_waitcnt vmcnt(12)
    v_dot2_f32_bf16 v24, v102, s4, v24
    v_dot2_f32_bf16 v26, v102, v102, v26
    v_dot2_f32_bf16 v25, v103, s4, v25
    v_dot2_f32_bf16 v27, v103, v103, v27
    v_dot2_f32_bf16 v24, v104, s4, v24
    v_dot2_f32_bf16 v26, v104, v104, v26
    v_dot2_f32_bf16 v25, v105, s4, v25
    v_dot2_f32_bf16 v27, v105, v105, v27
    s_waitcnt vmcnt(11)
    v_dot2_f32_bf16 v24, v106, s4, v24
    v_dot2_f32_bf16 v26, v106, v106, v26
    v_dot2_f32_bf16 v25, v107, s4, v25
    v_dot2_f32_bf16 v27, v107, v107, v27
    v_dot2_f32_bf16 v24, v108, s4, v24
    v_dot2_f32_bf16 v26, v108, v108, v26
    v_dot2_f32_bf16 v25, v109, s4, v25
    v_dot2_f32_bf16 v27, v109, v109, v27
    s_nop 2
    v_add_f32 v20, v20, v21
    v_add_f32 v22, v22, v23
    v_add_f32 v24, v24, v25
    v_add_f32 v26, v26, v27
    s_nop 1
    v_add_f32_dpp v20, v20, v20 quad_perm:[1,0,3,2] row_mask:0xf bank_mask:0xf
    v_add_f32_dpp v22, v22, v22 quad_perm:[1,0,3,2] row_mask:0xf bank_mask:0xf
    v_add_f32_dpp v24, v24, v24 quad_perm:[1,0,3,2] row_mask:0xf bank_mask:0xf
    v_add_f32_dpp v26, v26, v26 quad_perm:[1,0,3,2] row_mask:0xf bank_mask:0xf
    s_nop 1
    v_add_f32_dpp v20, v20, v20 quad_perm:[2,3,0,1] row_mask:0xf bank_mask:0xf
    v_add_f32_dpp v22, v22, v22 quad_perm:[2,3,0,1] row_mask:0xf bank_mask:0xf
    v_add_f32_dpp v24, v24, v24 quad_perm:[2,3,0,1] row_mask:0xf bank_mask:0xf
    v_add_f32_dpp v26, v26, v26 quad_perm:[2,3,0,1] row_mask:0xf bank_mask:0xf
    s_nop 1
    v_add_f32_dpp v20, v20, v20 row_half_mirror row_mask:0xf bank_mask:0xf
    v_add_f32_dpp v22, v22, v22 row_half_mirror row_mask:0xf bank_mask:0xf
    v_add_f32_dpp v24, v24, v24 row_half_mirror row_mask:0xf bank_mask:0xf
    v_add_f32_dpp v26, v26, v26 row_half_mirror row_mask:0xf bank_mask:0xf
    v_mul_f32 v20, 0x3acccccd, v20
    v_mul_f32 v22, 0x3acccccd, v22
    v_fma_f32 v22, -v20, v20, v22
    v_cvt_pk_bf16_f32 v9, v20, v22
    v_lshlrev_b32 v20, 16, v9
    v_and_b32 v22, 0xffff0000, v9
    v_add_f32 v22, 0x3727c5ac, v22
    v_mul_f32 v24, 0x3acccccd, v24
    v_mul_f32 v26, 0x3acccccd, v26
    v_fma_f32 v26, -v24, v24, v26
    v_cvt_pk_bf16_f32 v9, v24, v26
    v_lshlrev_b32 v24, 16, v9
    v_and_b32 v26, 0xffff0000, v9
    v_add_f32 v26, 0x3727c5ac, v26
    v_cvt_pk_bf16_f32 v9, v22, v26
    v_lshlrev_b32 v22, 16, v9
    v_and_b32 v26, 0xffff0000, v9
    v_sqrt_f32 v22, v22
    v_sqrt_f32 v26, v26
    s_nop 0
    v_cvt_pk_bf16_f32 v9, v22, v26
    v_lshlrev_b32 v22, 16, v9
    v_and_b32 v26, 0xffff0000, v9
    v_mov_b32 v23, v22
    v_mov_b32 v27, v26
    v_xor_b32 v22, 0x80000000, v20
    v_xor_b32 v26, 0x80000000, v24
    v_lshlrev_b32 v5, 3, v5
    v_mov_b32 v9, 0x7ff00000
    v_cmp_eq_u32 vcc, 0, v6
    s_nop 1
    v_cndmask_b32 v5, v9, v5, vcc
    buffer_store_dwordx2 v[22:23], v5, s[40:43], 0 offen sc1
    buffer_store_dwordx2 v[26:27], v5, s[40:43], 0 offen offset:64 sc1
    s_lshr_b32 s4, s15, 2
    s_lshl_b32 s4, s4, 2
    s_and_b32 s5, s15, 3
    s_lshl_b32 s5, 0x100000, s5
    v_mov_b32 v15, s5
    v_mov_b32 v16, 0x10000
    s_lshl_b32 s5, s7, 2
    s_waitcnt vmcnt(0)
    s_mov_b64 exec, 1
    buffer_atomic_or v15, v19, s[80:83], s4 offen sc1
    buffer_atomic_or v16, v19, s[80:83], s5 offen sc0 sc1
    s_mov_b64 exec, -1
    v_and_b32 v10, 15, v2
    v_lshrrev_b32 v11, 4, v2
    v_lshrrev_b32 v12, 2, v10
    v_and_b32 v13, 3, v10
    v_lshl_add_u32 v13, v13, 3, s12
    v_and_b32 v4, 1, v11
    v_lshl_add_u32 v13, v11, 10, v13
    v_lshl_add_u32 v13, v12, 7, v13
    v_lshrrev_b32 v12, 1, v12
    v_lshl_add_u32 v12, v4, 1, v12
    v_xor_b32 v4, 0, v12
    v_lshl_add_u32 v4, v4, 5, v13
    v_xor_b32 v5, 1, v12
    v_lshl_add_u32 v5, v5, 5, v13
    v_xor_b32 v6, 2, v12
    v_lshl_add_u32 v6, v6, 5, v13
    v_xor_b32 v7, 3, v12
    v_lshl_add_u32 v7, v7, 5, v13
    s_add_u32 s52, s34, 13713408
    s_addc_u32 s53, s35, 0
    s_and_b32 s53, s53, 0xffff
    s_mov_b32 s54, 606208
    s_mov_b32 s55, 0x00020000
    s_lshl_b32 s4, s10, 10
    s_cmp_lt_u32 s10, 74
    s_cselect_b32 s4, s4, 0x7ff00000
    ds_read_b64_tr_b16 v[30:31], v4 offset:0
    ds_read_b64_tr_b16 v[32:33], v4 offset:512
    ds_read_b64_tr_b16 v[34:35], v5 offset:0
    ds_read_b64_tr_b16 v[36:37], v5 offset:512
    ds_read_b64_tr_b16 v[38:39], v6 offset:0
    ds_read_b64_tr_b16 v[40:41], v6 offset:512
    ds_read_b64_tr_b16 v[42:43], v7 offset:0
    ds_read_b64_tr_b16 v[44:45], v7 offset:512
    ds_read_b64_tr_b16 v[50:51], v4 offset:4096
    ds_read_b64_tr_b16 v[52:53], v4 offset:4608
    ds_read_b64_tr_b16 v[54:55], v5 offset:4096
    ds_read_b64_tr_b16 v[56:57], v5 offset:4608
    ds_read_b64_tr_b16 v[58:59], v6 offset:4096
    ds_read_b64_tr_b16 v[60:61], v6 offset:4608
    ds_read_b64_tr_b16 v[62:63], v7 offset:4096
    ds_read_b64_tr_b16 v[64:65], v7 offset:4608
    s_waitcnt lgkmcnt(14)
    buffer_store_dwordx4 v[30:33], v1, s[52:55], s4 offen sc1
    s_add_u32 s4, s4, 75776
    s_waitcnt lgkmcnt(12)
    buffer_store_dwordx4 v[34:37], v1, s[52:55], s4 offen sc1
    s_add_u32 s4, s4, 75776
    s_waitcnt lgkmcnt(10)
    buffer_store_dwordx4 v[38:41], v1, s[52:55], s4 offen sc1
    s_add_u32 s4, s4, 75776
    s_waitcnt lgkmcnt(8)
    buffer_store_dwordx4 v[42:45], v1, s[52:55], s4 offen sc1
    s_add_u32 s4, s4, 75776
    s_waitcnt lgkmcnt(6)
    buffer_store_dwordx4 v[50:53], v1, s[52:55], s4 offen sc1
    s_add_u32 s4, s4, 75776
    s_waitcnt lgkmcnt(4)
    buffer_store_dwordx4 v[54:57], v1, s[52:55], s4 offen sc1
    s_add_u32 s4, s4, 75776
    s_waitcnt lgkmcnt(2)
    buffer_store_dwordx4 v[58:61], v1, s[52:55], s4 offen sc1
    s_add_u32 s4, s4, 75776
    s_waitcnt lgkmcnt(0)
    buffer_store_dwordx4 v[62:65], v1, s[52:55], s4 offen sc1
g1_pk_exit:
    s_cmp_ge_u32 s7, 32
    s_cbranch_scc1 g1_cl_done
    s_waitcnt vmcnt(0)
    s_nop 0
    v_readfirstlane_b32 s52, v16
    s_and_b32 s52, s52, 0xffff
    s_cmp_eq_u32 s52, 0
    s_cbranch_scc1 g1_cl_done
    s_add_u32 s84, s34, 16384
    s_addc_u32 s85, s35, 0
    s_and_b32 s85, s85, 0xffff
    s_mov_b32 s86, 524288
    s_mov_b32 s87, 0x00020000
    v_mov_b32 v9, 0x7ff00000
    v_lshlrev_b32 v10, 2, v2
    v_cmp_gt_u32 vcc, 18, v2
    v_add_u32 v11, 256, v10
    v_add_u32 v12, 512, v10
    v_add_u32 v13, 768, v10
    v_cndmask_b32 v13, v9, v13, vcc
g1_cl_loop:
    s_ff1_i32_b32 s4, s52
    s_cmp_lt_i32 s4, 0
    s_cbranch_scc1 g1_cl_done
    s_bitset0_b32 s52, s4
    s_and_b32 s5, s4, 1
    s_mul_i32 s5, s5, 840
    s_lshl_b32 s6, s7, 11
    s_add_u32 s5, s5, s6
    s_lshr_b32 s4, s4, 1
    s_mul_i32 s4, s4, 65536
    s_add_u32 s4, s4, s5
    buffer_load_dword v20, v10, s[84:87], s4 offen sc1
    buffer_load_dword v21, v11, s[84:87], s4 offen sc1
    buffer_load_dword v22, v12, s[84:87], s4 offen sc1
    buffer_load_dword v23, v13, s[84:87], s4 offen sc1
    s_waitcnt vmcnt(0)
    buffer_atomic_add_f32 v20, v10, s[44:47], s5 offen sc1
    buffer_atomic_add_f32 v21, v11, s[44:47], s5 offen sc1
    buffer_atomic_add_f32 v22, v12, s[44:47], s5 offen sc1
    buffer_atomic_add_f32 v23, v13, s[44:47], s5 offen sc1
    s_waitcnt vmcnt(0)
    s_branch g1_cl_loop
g1_cl_done:
    s_mov_b64 exec, -1
    s_waitcnt vmcnt(0)
    s_barrier
    v_mov_b32 v15, 0
    s_cmp_lg_u32 s8, 0
    s_cbranch_scc1 g1_sp_nof
    v_mov_b32 v15, 1
    v_lshlrev_b32 v19, 2, v2
    v_sub_u32 v19, 132, v19
    s_mov_b64 exec, 3
    buffer_atomic_add v15, v19, s[80:83], 0 offen sc0 sc1
    s_mov_b64 exec, -1
g1_sp_nof:
    s_mov_b32 s4, s15
    s_mov_b32 s92, s28
    s_mov_b32 s93, s29
    s_and_b32 s93, s93, 0xffff
    s_mov_b32 s94, 2211840
    s_mov_b32 s95, 0x00020000
    s_mov_b32 s72, s20
    s_mov_b32 s73, s21
    s_and_b32 s73, s73, 0xffff
    s_mov_b32 s74, 819200
    s_mov_b32 s75, 0x00020000
    s_mul_i32 s76, s4, 10240
    s_mul_i32 s77, s4, 4736
    v_lshrrev_b32 v117, 3, v2
    v_mul_u32_u24 v117, 1280, v117
    v_and_b32 v116, 7, v2
    v_lshl_add_u32 v116, v116, 7, v117
    buffer_load_dword v118, v116, s[92:95], s76 offen
    s_add_u32 s4, s76, 1310720
    buffer_load_dword v118, v116, s[92:95], s4 offen
    s_sub_u32 s4, 1300480, s76
    buffer_load_dword v118, v116, s[72:75], s4 offen
    s_mov_b32 s3, s2
    s_mov_b32 s88, 0
    s_mov_b32 s89, 0
    s_waitcnt vmcnt(0)
    s_branch p2_entry
g1_done:
    v_mov_b32 v6, 61316
    v_mov_b32 v7, s89
    v_mov_b32 v15, 0
    v_mov_b32 v9, 59924
    ds_read_b32 v8, v9
    s_mov_b32 s80, s32
    s_mov_b32 s81, s33
    s_and_b32 s81, s81, 0xffff
    s_mov_b32 s82, 256
    s_mov_b32 s83, 0x00020000
    s_add_u32 s84, s34, 11419648
    s_addc_u32 s85, s35, 0
    s_and_b32 s85, s85, 0xffff
    s_mov_b32 s86, 524288
    s_mov_b32 s87, 0x00020000
    v_mbcnt_lo_u32_b32 v2, -1, 0
    v_mbcnt_hi_u32_b32 v2, -1, v2
    v_and_b32 v5, 56, v2
    v_add_u32 v5, v5, v2
    v_mul_u32_u24 v5, 4096, v5
    v_mov_b32 v4, 1
    s_mul_i32 s5, s6, 4096
    s_mov_b32 s12, 1
    s_mov_b32 s13, 0
    s_cmp_lt_u32 s7, 8
    s_cselect_b32 s5, 0, s5
    s_cselect_b32 s12, 255, s12
    s_cselect_b32 s13, 0, s13
    s_cmp_lt_u32 s7, 12
    s_cselect_b32 s4, 32768, 0
    s_add_u32 s5, s5, s4
    s_mov_b32 s79, 0
    s_mov_b64 exec, 1
    s_waitcnt vmcnt(0)
    ds_add_rtn_u32 v7, v6, v7
    s_waitcnt lgkmcnt(0)
    v_readfirstlane_b32 s4, v7
    v_readfirstlane_b32 s14, v8
    s_add_u32 s4, s4, s89
    s_bitcmp1_b32 s4, 2
    s_cbranch_scc0 g1_nosig
    s_cmp_eq_u32 s4, 4
    s_cselect_b32 s14, s14, 0
    s_mov_b32 s79, 1
    s_cmp_lg_u32 s14, 16
    s_cbranch_scc1 g1_nocnt
    s_mov_b64 exec, s[12:13]
    buffer_atomic_add v4, v5, s[84:87], s5 offen sc1
    s_mov_b64 exec, 1
g1_nocnt:
    v_mov_b32 v15, 1
    buffer_atomic_add v15, v5, s[80:83], 0 offen offset:132 sc0 sc1
g1_nosig:
    s_mov_b64 exec, -1
    s_mov_b32 s3, s2
    s_mov_b32 s88, 0
    s_branch p2_Q
p2_entry:
    v_mbcnt_lo_u32_b32 v9, -1, 0
    v_lshlrev_b32 v9, 2, v9
    v_mov_b32 v10, 0
    v_writelane_b32 v10, 4, 1
    s_mov_b64 exec, 0xffff
    ds_write_b32 v9, v10 offset:61312
    s_mov_b64 exec, -1
    s_cmp_eq_u32 s8, 0
    s_cselect_b32 s79, 1, 0
    s_waitcnt lgkmcnt(0)
    s_barrier
    s_cmp_lt_u32 s8, 4
    s_cbranch_scc1 p2_Q
p2_P:
    v_mbcnt_lo_u32_b32 v9, -1, 0
    v_mbcnt_hi_u32_b32 v9, -1, v9
    s_and_b32 s9, s8, 3
    s_bfe_u32 s7, s3, 0x30003
    s_and_b32 s6, s3, 7
    s_lshl_b32 s6, s6, 2
    s_lshr_b32 s4, s3, 6
    s_add_u32 s6, s6, s4
    v_and_b32 v10, 15, v9
    v_lshrrev_b32 v11, 4, v9
    v_lshlrev_b32 v0, 4, v9
    s_lshl_b32 s10, s9, 12
    s_lshl_b32 s22, s9, 10
    s_lshl_b32 s11, s9, 3
    s_lshr_b32 s11, 0x270f0908, s11
    s_and_b32 s11, s11, 255
    s_lshl_b32 s11, s11, 12
    s_mov_b32 s48, s16
    s_mov_b32 s49, s17
    s_and_b32 s49, s49, 0xffff
    s_mov_b32 s50, 2621440
    s_mov_b32 s51, 0x00020000
    s_mov_b32 s52, s30
    s_mov_b32 s53, s31
    s_and_b32 s53, s53, 0xffff
    s_mov_b32 s54, 2621440
    s_mov_b32 s55, 0x00020000
    s_mov_b32 s80, s32
    s_mov_b32 s81, s33
    s_and_b32 s81, s81, 0xffff
    s_mov_b32 s82, 256
    s_mov_b32 s83, 0x00020000
    s_add_u32 s84, s34, 13713408
    s_addc_u32 s85, s35, 0
    s_and_b32 s85, s85, 0xffff
    s_mov_b32 s86, 606208
    s_mov_b32 s87, 0x00020000
    s_mul_i32 s76, s7, 74
    s_mul_i32 s77, s9, 5
    s_add_u32 s77, s77, s76
    s_add_u32 s77, s77, 54
    s_lshl_b32 s77, s77, 10
    s_mov_b32 s36, s28
    s_mov_b32 s37, s29
    s_and_b32 s37, s37, 0xffff
    s_mov_b32 s38, 2211840
    s_mov_b32 s39, 0x00020000
    s_mov_b32 s40, s20
    s_mov_b32 s41, s21
    s_and_b32 s41, s41, 0xffff
    s_mov_b32 s42, 819200
    s_mov_b32 s43, 0x00020000
    s_mul_i32 s14, s9, 14
    s_cmp_eq_u32 s9, 3
    s_cselect_b32 s4, 1, 0
    s_sub_u32 s14, s14, s4
    s_mul_i32 s12, s14, 40960
    s_mul_i32 s13, s9, 204800
    s_add_u32 s76, s76, s14
    s_lshl_b32 s76, s76, 10
    v_lshrrev_b32 v25, 3, v9
    v_and_b32 v24, 7, v9
    v_and_b32 v26, 2, v25
    v_xor_b32 v24, v24, v26
    s_lshl_b32 s4, s7, 7
    v_lshl_add_u32 v24, v24, 4, s4
    s_movk_i32 s5, 1280
    v_mad_u32_u24 v1, v25, s5, v24
    v_xor_b32 v2, 64, v1
    v_lshrrev_b32 v12, 2, v25
    v_mad_u32_u24 v12, v12, 16, v25
    v_mad_u32_u24 v12, v12, s5, v24
    v_xor_b32 v13, 64, v12
    s_add_u32 s15, s10, 65536
    v_lshrrev_b32 v24, 2, v10
    v_and_b32 v25, 3, v10
    v_lshl_add_u32 v25, v25, 3, s15
    v_and_b32 v4, 1, v11
    v_lshl_add_u32 v25, v11, 10, v25
    v_lshl_add_u32 v25, v24, 7, v25
    v_lshrrev_b32 v24, 1, v24
    v_lshl_add_u32 v24, v4, 1, v24
    v_xor_b32 v4, 0, v24
    v_lshl_add_u32 v4, v4, 5, v25
    v_xor_b32 v5, 1, v24
    v_lshl_add_u32 v5, v5, 5, v25
    v_xor_b32 v6, 2, v24
    v_lshl_add_u32 v6, v6, 5, v25
    v_xor_b32 v7, 3, v24
    v_lshl_add_u32 v7, v7, 5, v25
    v_add_u32 v8, s11, v0
    s_cmp_lg_u32 s88, 0
    s_cselect_b32 s89, 16, s89
    s_movk_i32 s78, 320
    v_mov_b32 v24, 0
p2_z:
    s_cmp_eq_u32 s89, 16
    s_cbranch_scc1 p2_zj
    s_sub_u32 s78, s78, 1
    s_cbranch_scc1 p2_zj
    buffer_load_dword v25, v24, s[80:83], 0 offen offset:128 sc1
    s_sleep 8
    s_waitcnt vmcnt(0)
    v_readfirstlane_b32 s89, v25
    s_branch p2_z
p2_zj:
    s_cmp_eq_u32 s89, 16
    s_cselect_b32 s76, s76, 0x7ff00000
    s_cselect_b32 s77, s77, 0x7ff00000
    s_add_u32 m0, s11, 0
    s_add_u32 s4, s12, 0
    buffer_load_dwordx4 v1, s[36:39], s4 offen lds
    s_add_u32 m0, s11, 1024
    s_add_u32 s4, s12, 10240
    buffer_load_dwordx4 v2, s[36:39], s4 offen lds
    s_add_u32 m0, s11, 2048
    s_add_u32 s4, s12, 20480
    buffer_load_dwordx4 v1, s[36:39], s4 offen lds
    s_add_u32 m0, s11, 3072
    s_add_u32 s4, s12, 30720
    buffer_load_dwordx4 v2, s[36:39], s4 offen lds
    s_add_u32 m0, s10, 98304
    s_add_u32 s4, s12, 40960
    buffer_load_dwordx4 v1, s[36:39], s4 offen lds
    s_add_u32 m0, s10, 99328
    s_add_u32 s4, s12, 51200
    buffer_load_dwordx4 v2, s[36:39], s4 offen lds
    s_add_u32 m0, s10, 100352
    s_add_u32 s4, s12, 61440
    buffer_load_dwordx4 v1, s[36:39], s4 offen lds
    s_add_u32 m0, s10, 101376
    s_add_u32 s4, s12, 71680
    buffer_load_dwordx4 v2, s[36:39], s4 offen lds
    s_add_u32 s4, s76, 0
    buffer_load_dwordx4 v[132:135], v0, s[84:87], s4 offen sc1
    s_add_u32 s4, s76, 1024
    buffer_load_dwordx4 v[152:155], v0, s[84:87], s4 offen sc1
    s_add_u32 s4, s76, 2048
    buffer_load_dwordx4 v[172:175], v0, s[84:87], s4 offen sc1
    s_add_u32 s4, s76, 3072
    buffer_load_dwordx4 v[192:195], v0, s[84:87], s4 offen sc1
    s_add_u32 s4, s76, 4096
    buffer_load_dwordx4 v[212:215], v0, s[84:87], s4 offen sc1
    s_add_u32 s4, s76, 5120
    buffer_load_dwordx4 v[232:235], v0, s[84:87], s4 offen sc1
    s_add_u32 s4, s76, 6144
    buffer_load_dwordx4 v[252:255], v0, s[84:87], s4 offen sc1
    s_add_u32 m0, s10, 81920
    s_add_u32 s4, s12, 81920
    buffer_load_dwordx4 v1, s[36:39], s4 offen lds
    s_add_u32 m0, s10, 82944
    s_add_u32 s4, s12, 92160
    buffer_load_dwordx4 v2, s[36:39], s4 offen lds
    s_add_u32 m0, s10, 83968
    s_add_u32 s4, s12, 102400
    buffer_load_dwordx4 v1, s[36:39], s4 offen lds
    s_add_u32 m0, s10, 84992
    s_add_u32 s4, s12, 112640
    buffer_load_dwordx4 v2, s[36:39], s4 offen lds
    s_add_u32 m0, s10, 65536
    s_add_u32 s4, s12, 122880
    buffer_load_dwordx4 v1, s[36:39], s4 offen lds
    s_add_u32 m0, s10, 66560
    s_add_u32 s4, s12, 133120
    buffer_load_dwordx4 v2, s[36:39], s4 offen lds
    s_add_u32 m0, s10, 67584
    s_add_u32 s4, s12, 143360
    buffer_load_dwordx4 v1, s[36:39], s4 offen lds
    s_add_u32 m0, s10, 68608
    s_add_u32 s4, s12, 153600
    buffer_load_dwordx4 v2, s[36:39], s4 offen lds
    s_add_u32 m0, s10, 114688
    s_add_u32 s4, s12, 163840
    buffer_load_dwordx4 v1, s[36:39], s4 offen lds
    s_add_u32 m0, s10, 115712
    s_add_u32 s4, s12, 174080
    buffer_load_dwordx4 v2, s[36:39], s4 offen lds
    s_add_u32 m0, s10, 116736
    s_add_u32 s4, s12, 184320
    buffer_load_dwordx4 v1, s[36:39], s4 offen lds
    s_add_u32 m0, s10, 117760
    s_add_u32 s4, s12, 194560
    buffer_load_dwordx4 v2, s[36:39], s4 offen lds
    s_waitcnt vmcnt(23)
    s_sub_u32 s4, s11, s15
    v_add_u32 v14, s4, v4
    v_add_u32 v15, s4, v5
    v_add_u32 v16, s4, v6
    v_add_u32 v17, s4, v7
    ds_read_b64_tr_b16 v[116:117], v14 offset:0
    ds_read_b64_tr_b16 v[118:119], v14 offset:512
    ds_read_b64_tr_b16 v[120:121], v15 offset:0
    ds_read_b64_tr_b16 v[122:123], v15 offset:512
    ds_read_b64_tr_b16 v[124:125], v16 offset:0
    ds_read_b64_tr_b16 v[126:127], v16 offset:512
    ds_read_b64_tr_b16 v[128:129], v17 offset:0
    ds_read_b64_tr_b16 v[130:131], v17 offset:512
    s_waitcnt lgkmcnt(0)
    s_add_u32 m0, s11, 0
    s_add_u32 s4, s12, 204800
    buffer_load_dwordx4 v1, s[36:39], s4 offen lds
    s_add_u32 m0, s11, 1024
    s_add_u32 s4, s12, 215040
    buffer_load_dwordx4 v2, s[36:39], s4 offen lds
    s_add_u32 m0, s11, 2048
    s_add_u32 s4, s12, 225280
    buffer_load_dwordx4 v1, s[36:39], s4 offen lds
    s_add_u32 m0, s11, 3072
    s_add_u32 s4, s12, 235520
    buffer_load_dwordx4 v2, s[36:39], s4 offen lds
    s_waitcnt vmcnt(23)
    ds_read_b64_tr_b16 v[136:137], v4 offset:32768
    ds_read_b64_tr_b16 v[138:139], v4 offset:33280
    ds_read_b64_tr_b16 v[140:141], v5 offset:32768
    ds_read_b64_tr_b16 v[142:143], v5 offset:33280
    ds_read_b64_tr_b16 v[144:145], v6 offset:32768
    ds_read_b64_tr_b16 v[146:147], v6 offset:33280
    ds_read_b64_tr_b16 v[148:149], v7 offset:32768
    ds_read_b64_tr_b16 v[150:151], v7 offset:33280
    s_waitcnt lgkmcnt(0)
    s_add_u32 m0, s10, 98304
    s_add_u32 s4, s12, 286720
    buffer_load_dwordx4 v1, s[36:39], s4 offen lds
    s_add_u32 m0, s10, 99328
    s_add_u32 s4, s12, 296960
    buffer_load_dwordx4 v2, s[36:39], s4 offen lds
    s_add_u32 m0, s10, 100352
    s_add_u32 s4, s12, 307200
    buffer_load_dwordx4 v1, s[36:39], s4 offen lds
    s_add_u32 m0, s10, 101376
    s_add_u32 s4, s12, 317440
    buffer_load_dwordx4 v2, s[36:39], s4 offen lds
    s_add_u32 m0, s10, 131072
    s_add_u32 s4, s12, 245760
    buffer_load_dwordx4 v1, s[36:39], s4 offen lds
    s_add_u32 m0, s10, 132096
    s_add_u32 s4, s12, 256000
    buffer_load_dwordx4 v2, s[36:39], s4 offen lds
    s_add_u32 m0, s10, 133120
    s_add_u32 s4, s12, 266240
    buffer_load_dwordx4 v1, s[36:39], s4 offen lds
    s_add_u32 m0, s10, 134144
    s_add_u32 s4, s12, 276480
    buffer_load_dwordx4 v2, s[36:39], s4 offen lds
p2_P_e:
    s_setprio 0
    s_waitcnt vmcnt(20)
    ds_read_b64_tr_b16 v[156:157], v4 offset:16384
    ds_read_b64_tr_b16 v[158:159], v4 offset:16896
    ds_read_b64_tr_b16 v[160:161], v5 offset:16384
    ds_read_b64_tr_b16 v[162:163], v5 offset:16896
    ds_read_b64_tr_b16 v[164:165], v6 offset:16384
    ds_read_b64_tr_b16 v[166:167], v6 offset:16896
    ds_read_b64_tr_b16 v[168:169], v7 offset:16384
    ds_read_b64_tr_b16 v[170:171], v7 offset:16896
    s_waitcnt vmcnt(16)
    ds_read_b64_tr_b16 v[176:177], v4 offset:0
    ds_read_b64_tr_b16 v[178:179], v4 offset:512
    ds_read_b64_tr_b16 v[180:181], v5 offset:0
    ds_read_b64_tr_b16 v[182:183], v5 offset:512
    ds_read_b64_tr_b16 v[184:185], v6 offset:0
    ds_read_b64_tr_b16 v[186:187], v6 offset:512
    ds_read_b64_tr_b16 v[188:189], v7 offset:0
    ds_read_b64_tr_b16 v[190:191], v7 offset:512
    s_waitcnt vmcnt(12)
    ds_read_b64_tr_b16 v[196:197], v4 offset:49152
    ds_read_b64_tr_b16 v[198:199], v4 offset:49664
    ds_read_b64_tr_b16 v[200:201], v5 offset:49152
    ds_read_b64_tr_b16 v[202:203], v5 offset:49664
    ds_read_b64_tr_b16 v[204:205], v6 offset:49152
    ds_read_b64_tr_b16 v[206:207], v6 offset:49664
    ds_read_b64_tr_b16 v[208:209], v7 offset:49152
    ds_read_b64_tr_b16 v[210:211], v7 offset:49664
    s_waitcnt lgkmcnt(15)
    s_add_u32 m0, s10, 81920
    s_add_u32 s4, s12, 327680
    buffer_load_dwordx4 v1, s[36:39], s4 offen lds
    s_sleep 2
    s_add_u32 m0, s10, 82944
    s_add_u32 s4, s12, 337920
    buffer_load_dwordx4 v2, s[36:39], s4 offen lds
    s_sleep 2
    s_add_u32 m0, s10, 83968
    s_add_u32 s4, s12, 348160
    buffer_load_dwordx4 v1, s[36:39], s4 offen lds
    s_sleep 2
    s_add_u32 m0, s10, 84992
    s_add_u32 s4, s12, 358400
    buffer_load_dwordx4 v2, s[36:39], s4 offen lds
    s_sleep 2
    s_waitcnt lgkmcnt(8)
    s_add_u32 m0, s10, 65536
    s_add_u32 s4, s12, 368640
    buffer_load_dwordx4 v1, s[36:39], s4 offen lds
    s_sleep 2
    s_add_u32 m0, s10, 66560
    s_add_u32 s4, s12, 378880
    buffer_load_dwordx4 v2, s[36:39], s4 offen lds
    s_sleep 2
    s_add_u32 m0, s10, 67584
    s_add_u32 s4, s12, 389120
    buffer_load_dwordx4 v1, s[36:39], s4 offen lds
    s_sleep 2
    s_add_u32 m0, s10, 68608
    s_add_u32 s4, s12, 399360
    buffer_load_dwordx4 v2, s[36:39], s4 offen lds
    s_sleep 2
    s_waitcnt lgkmcnt(0)
    s_add_u32 m0, s10, 114688
    s_add_u32 s4, s12, 409600
    buffer_load_dwordx4 v1, s[36:39], s4 offen lds
    s_sleep 2
    s_add_u32 m0, s10, 115712
    s_add_u32 s4, s12, 419840
    buffer_load_dwordx4 v2, s[36:39], s4 offen lds
    s_sleep 2
    s_add_u32 m0, s10, 116736
    s_add_u32 s4, s12, 430080
    buffer_load_dwordx4 v1, s[36:39], s4 offen lds
    s_sleep 2
    s_add_u32 m0, s10, 117760
    s_add_u32 s4, s12, 440320
    buffer_load_dwordx4 v2, s[36:39], s4 offen lds
    s_sleep 2
    s_waitcnt vmcnt(20)
    s_sub_u32 s4, s11, s15
    v_add_u32 v14, s4, v4
    v_add_u32 v15, s4, v5
    v_add_u32 v16, s4, v6
    v_add_u32 v17, s4, v7
    ds_read_b64_tr_b16 v[216:217], v14 offset:0
    ds_read_b64_tr_b16 v[218:219], v14 offset:512
    ds_read_b64_tr_b16 v[220:221], v15 offset:0
    ds_read_b64_tr_b16 v[222:223], v15 offset:512
    ds_read_b64_tr_b16 v[224:225], v16 offset:0
    ds_read_b64_tr_b16 v[226:227], v16 offset:512
    ds_read_b64_tr_b16 v[228:229], v17 offset:0
    ds_read_b64_tr_b16 v[230:231], v17 offset:512
    s_waitcnt vmcnt(12)
    s_mov_b32 s4, 65536
    v_add_u32 v18, s4, v4
    v_add_u32 v19, s4, v5
    v_add_u32 v20, s4, v6
    v_add_u32 v21, s4, v7
    ds_read_b64_tr_b16 v[236:237], v18 offset:0
    ds_read_b64_tr_b16 v[238:239], v18 offset:512
    ds_read_b64_tr_b16 v[240:241], v19 offset:0
    ds_read_b64_tr_b16 v[242:243], v19 offset:512
    ds_read_b64_tr_b16 v[244:245], v20 offset:0
    ds_read_b64_tr_b16 v[246:247], v20 offset:512
    ds_read_b64_tr_b16 v[248:249], v21 offset:0
    ds_read_b64_tr_b16 v[250:251], v21 offset:512
    s_waitcnt lgkmcnt(8)
    s_add_u32 m0, s11, 0
    s_add_u32 s4, s76, 7168
    buffer_load_dwordx4 v0, s[84:87], s4 offen sc1 lds
    s_sleep 2
    s_add_u32 m0, s11, 1024
    s_add_u32 s4, s76, 8192
    buffer_load_dwordx4 v0, s[84:87], s4 offen sc1 lds
    s_sleep 2
    s_add_u32 m0, s11, 2048
    s_add_u32 s4, s76, 9216
    buffer_load_dwordx4 v0, s[84:87], s4 offen sc1 lds
    s_sleep 2
    s_add_u32 m0, s11, 3072
    s_add_u32 s4, s76, 10240
    buffer_load_dwordx4 v0, s[84:87], s4 offen sc1 lds
    s_sleep 2
    s_waitcnt lgkmcnt(0)
    s_add_u32 m0, s10, 131072
    s_add_u32 s4, s12, 450560
    buffer_load_dwordx4 v1, s[36:39], s4 offen lds
    s_sleep 2
    s_add_u32 m0, s10, 132096
    s_add_u32 s4, s12, 460800
    buffer_load_dwordx4 v2, s[36:39], s4 offen lds
    s_sleep 2
    s_add_u32 m0, s10, 133120
    s_add_u32 s4, s12, 471040
    buffer_load_dwordx4 v1, s[36:39], s4 offen lds
    s_sleep 2
    s_add_u32 m0, s10, 134144
    s_add_u32 s4, s12, 481280
    buffer_load_dwordx4 v2, s[36:39], s4 offen lds
    s_sleep 2
    s_add_u32 m0, s10, 0
    s_add_u32 s4, s13, 0
    buffer_load_dwordx4 v12, s[40:43], s4 offen lds
    s_sleep 2
    s_add_u32 m0, s10, 1024
    s_add_u32 s4, s13, 5120
    buffer_load_dwordx4 v13, s[40:43], s4 offen lds
    s_sleep 2
    s_add_u32 m0, s10, 2048
    s_add_u32 s4, s13, 10240
    buffer_load_dwordx4 v12, s[40:43], s4 offen lds
    s_sleep 2
    s_add_u32 m0, s10, 3072
    s_add_u32 s4, s13, 15360
    buffer_load_dwordx4 v13, s[40:43], s4 offen lds
    s_sleep 2
    s_add_u32 m0, s22, 147456
    s_add_u32 s4, s77, 0
    buffer_load_dwordx4 v0, s[84:87], s4 offen sc1 lds
    s_sleep 2
    s_add_u32 m0, s10, 16384
    s_add_u32 s4, s13, 51200
    buffer_load_dwordx4 v12, s[40:43], s4 offen lds
    s_sleep 2
    s_add_u32 m0, s10, 17408
    s_add_u32 s4, s13, 56320
    buffer_load_dwordx4 v13, s[40:43], s4 offen lds
    s_sleep 2
    s_add_u32 m0, s10, 18432
    s_add_u32 s4, s13, 61440
    buffer_load_dwordx4 v12, s[40:43], s4 offen lds
    s_sleep 2
    s_add_u32 m0, s10, 19456
    s_add_u32 s4, s13, 66560
    buffer_load_dwordx4 v13, s[40:43], s4 offen lds
    s_sleep 2
    s_add_u32 m0, s22, 151552
    s_add_u32 s4, s77, 1024
    buffer_load_dwordx4 v0, s[84:87], s4 offen sc1 lds
    s_sleep 2
    s_add_u32 m0, s22, 155648
    s_add_u32 s4, s76, 11264
    buffer_load_dwordx4 v0, s[84:87], s4 offen sc1 lds
    s_sleep 2
    s_add_u32 s44, s34, 4210688
    s_addc_u32 s45, s35, 0
    s_and_b32 s45, s45, 0xffff
    s_mov_b32 s46, 7077888
    s_mov_b32 s47, 0x00020000
    s_lshl_b32 s4, s6, 2
    s_mul_i32 s4, s4, 55296
    s_lshl_b32 s5, s14, 10
    s_add_u32 s4, s4, s5
    s_cmp_ge_u32 s9, 2
    s_cselect_b32 s5, 0x7ff00000, s4
    s_add_u32 s56, s4, 0
    s_add_u32 s60, s4, 4096
    s_add_u32 s64, s4, 8192
    s_add_u32 s68, s4, 12288
    s_add_u32 s72, s5, 13312
    s_add_u32 s57, s4, 55296
    s_add_u32 s61, s4, 59392
    s_add_u32 s65, s4, 63488
    s_add_u32 s69, s4, 67584
    s_add_u32 s73, s5, 68608
    s_add_u32 s58, s4, 110592
    s_add_u32 s62, s4, 114688
    s_add_u32 s66, s4, 118784
    s_add_u32 s70, s4, 122880
    s_add_u32 s74, s5, 123904
    s_add_u32 s59, s4, 165888
    s_add_u32 s63, s4, 169984
    s_add_u32 s67, s4, 174080
    s_add_u32 s71, s4, 178176
    s_add_u32 s75, s5, 179200
    s_lshl_b32 s4, s6, 2
    s_add_u32 s4, s4, s9
    s_mul_i32 s4, s4, 20480
    s_lshl_b32 s5, s7, 5
    s_add_u32 s4, s4, s5
    s_add_u32 s15, s4, 1024
    v_mul_u32_u24 v3, 1280, v10
    v_lshl_add_u32 v3, v11, 3, v3
    v_mov_b32 v10, 61312
    s_cmp_eq_u32 s89, 16
    s_cselect_b32 s4, 1, 0x101
    v_mov_b32 v11, s4
    s_waitcnt vmcnt(1)
    s_mov_b64 exec, 1
    ds_add_u32 v10, v11 offset:8
    s_mov_b64 exec, -1
    v_mov_b32 v11, 1
    s_cmp_lg_u32 s8, 4
    s_cbranch_scc1 p2_P_w
p2_P_fa:
    ds_read_b32 v9, v10 offset:8
    s_waitcnt lgkmcnt(0)
    v_readfirstlane_b32 s4, v9
    s_bitcmp0_b32 s4, 2
    s_cbranch_scc1 p2_P_fa
    v_mov_b32 v24, 0
    v_mov_b32 v26, 2
    s_mov_b64 exec, 1
    s_cmp_gt_u32 s4, 4
    s_cbranch_scc1 p2_pp_end
    s_cmp_lg_u32 s88, 0
    s_cbranch_scc1 p2_pp_go
    s_add_u32 s40, s34, 11419648
    s_addc_u32 s41, s35, 0
    s_and_b32 s41, s41, 0xffff
    s_mov_b32 s42, 524288
    s_mov_b32 s43, 0x00020000
    s_and_b32 s5, s3, 7
    s_and_b32 s4, s7, 0
    s_lshl_b32 s4, s4, 4
    s_add_u32 s5, s5, s4
    s_add_u32 s5, s5, 0
    s_mul_i32 s5, s5, 4096
    s_movk_i32 s78, 320
    s_mov_b32 s79, 15
p2_pp:
    s_sub_u32 s78, s78, 1
    s_cbranch_scc1 p2_pp_end
    s_and_b32 s4, s78, s79
    s_cbranch_scc0 p2_pp_f
    buffer_load_dword v25, v24, s[40:43], s5 offen sc1
    s_waitcnt vmcnt(0)
    v_readfirstlane_b32 s4, v25
    s_cmp_eq_u32 s4, 18
    s_cbranch_scc1 p2_pp_go
    s_sleep 8
    s_branch p2_pp
p2_pp_f:
    buffer_load_dword v25, v24, s[80:83], 0 offen offset:132 sc1
    s_mov_b32 s79, 3
    s_waitcnt vmcnt(0)
    v_readfirstlane_b32 s4, v25
    s_cmp_lg_u32 s4, 256
    s_cbranch_scc1 p2_pp
p2_pp_go:
    v_mov_b32 v26, 1
p2_pp_end:
    ds_write_b32 v10, v26 offset:16
    s_mov_b64 exec, -1
p2_P_w:
p2_P_go:
    ds_read_b32 v9, v10 offset:16
    s_waitcnt lgkmcnt(0)
    v_readfirstlane_b32 s4, v9
    s_cmp_lt_u32 s4, 1
    s_cbranch_scc1 p2_P_go
    s_cmp_lg_u32 s4, 1
    s_cbranch_scc1 p2_P_abort
    buffer_load_dwordx4 v[56:59], v0, s[44:47], s56 offen offset:0 sc1
    buffer_load_dwordx4 v[60:63], v0, s[44:47], s56 offen offset:1024 sc1
    buffer_load_dwordx4 v[76:79], v0, s[44:47], s57 offen offset:0 sc1
    buffer_load_dwordx4 v[80:83], v0, s[44:47], s57 offen offset:1024 sc1
    buffer_load_dwordx4 v[96:99], v0, s[44:47], s58 offen offset:0 sc1
    buffer_load_dwordx4 v[100:103], v0, s[44:47], s58 offen offset:1024 sc1
    s_waitcnt vmcnt(5)
    v_mfma_f32_16x16x32_bf16 v[36:39], v[116:119], v[56:59], 0
    v_mfma_f32_16x16x32_bf16 v[40:43], v[120:123], v[56:59], 0
    v_mfma_f32_16x16x32_bf16 v[44:47], v[124:127], v[56:59], 0
    v_mfma_f32_16x16x32_bf16 v[48:51], v[128:131], v[56:59], 0
    v_mfma_f32_16x16x32_bf16 v[52:55], v[132:135], v[56:59], 0
    s_waitcnt vmcnt(4)
    v_mfma_f32_16x16x32_bf16 v[36:39], v[136:139], v[60:63], v[36:39]
    buffer_load_dwordx4 v[12:15], v0, s[44:47], s59 offen offset:0 sc1
    v_mfma_f32_16x16x32_bf16 v[40:43], v[140:143], v[60:63], v[40:43]
    v_mfma_f32_16x16x32_bf16 v[44:47], v[144:147], v[60:63], v[44:47]
    v_mfma_f32_16x16x32_bf16 v[48:51], v[148:151], v[60:63], v[48:51]
    v_mfma_f32_16x16x32_bf16 v[52:55], v[152:155], v[60:63], v[52:55]
    s_waitcnt vmcnt(4)
    v_mfma_f32_16x16x32_bf16 v[56:59], v[116:119], v[76:79], 0
    buffer_load_dwordx4 v[16:19], v0, s[44:47], s59 offen offset:1024 sc1
    v_mfma_f32_16x16x32_bf16 v[60:63], v[120:123], v[76:79], 0
    v_mfma_f32_16x16x32_bf16 v[64:67], v[124:127], v[76:79], 0
    v_mfma_f32_16x16x32_bf16 v[68:71], v[128:131], v[76:79], 0
    v_mfma_f32_16x16x32_bf16 v[72:75], v[132:135], v[76:79], 0
    s_waitcnt vmcnt(4)
    v_mfma_f32_16x16x32_bf16 v[56:59], v[136:139], v[80:83], v[56:59]
    buffer_load_dwordx4 v[20:23], v0, s[44:47], s56 offen offset:2048 sc1
    v_mfma_f32_16x16x32_bf16 v[60:63], v[140:143], v[80:83], v[60:63]
    v_mfma_f32_16x16x32_bf16 v[64:67], v[144:147], v[80:83], v[64:67]
    v_mfma_f32_16x16x32_bf16 v[68:71], v[148:151], v[80:83], v[68:71]
    v_mfma_f32_16x16x32_bf16 v[72:75], v[152:155], v[80:83], v[72:75]
    s_waitcnt vmcnt(4)
    v_mfma_f32_16x16x32_bf16 v[76:79], v[116:119], v[96:99], 0
    buffer_load_dwordx4 v[24:27], v0, s[44:47], s57 offen offset:2048 sc1
    v_mfma_f32_16x16x32_bf16 v[80:83], v[120:123], v[96:99], 0
    v_mfma_f32_16x16x32_bf16 v[84:87], v[124:127], v[96:99], 0
    v_mfma_f32_16x16x32_bf16 v[88:91], v[128:131], v[96:99], 0
    v_mfma_f32_16x16x32_bf16 v[92:95], v[132:135], v[96:99], 0
    s_waitcnt vmcnt(4)
    v_mfma_f32_16x16x32_bf16 v[76:79], v[136:139], v[100:103], v[76:79]
    buffer_load_dwordx4 v[28:31], v0, s[44:47], s58 offen offset:2048 sc1
    v_mfma_f32_16x16x32_bf16 v[80:83], v[140:143], v[100:103], v[80:83]
    v_mfma_f32_16x16x32_bf16 v[84:87], v[144:147], v[100:103], v[84:87]
    v_mfma_f32_16x16x32_bf16 v[88:91], v[148:151], v[100:103], v[88:91]
    v_mfma_f32_16x16x32_bf16 v[92:95], v[152:155], v[100:103], v[92:95]
    s_waitcnt vmcnt(4)
    v_mfma_f32_16x16x32_bf16 v[96:99], v[116:119], v[12:15], 0
    buffer_load_dwordx4 v[32:35], v0, s[44:47], s59 offen offset:2048 sc1
    v_mfma_f32_16x16x32_bf16 v[100:103], v[120:123], v[12:15], 0
    v_mfma_f32_16x16x32_bf16 v[104:107], v[124:127], v[12:15], 0
    v_mfma_f32_16x16x32_bf16 v[108:111], v[128:131], v[12:15], 0
    v_mfma_f32_16x16x32_bf16 v[112:115], v[132:135], v[12:15], 0
    s_waitcnt vmcnt(4)
    v_mfma_f32_16x16x32_bf16 v[96:99], v[136:139], v[16:19], v[96:99]
    buffer_load_dwordx4 v[12:15], v0, s[44:47], s56 offen offset:3072 sc1
    v_mfma_f32_16x16x32_bf16 v[100:103], v[140:143], v[16:19], v[100:103]
    v_mfma_f32_16x16x32_bf16 v[104:107], v[144:147], v[16:19], v[104:107]
    v_mfma_f32_16x16x32_bf16 v[108:111], v[148:151], v[16:19], v[108:111]
    v_mfma_f32_16x16x32_bf16 v[112:115], v[152:155], v[16:19], v[112:115]
    s_waitcnt vmcnt(4)
    v_mfma_f32_16x16x32_bf16 v[36:39], v[156:159], v[20:23], v[36:39]
    buffer_load_dwordx4 v[16:19], v0, s[44:47], s57 offen offset:3072 sc1
    v_mfma_f32_16x16x32_bf16 v[40:43], v[160:163], v[20:23], v[40:43]
    v_mfma_f32_16x16x32_bf16 v[44:47], v[164:167], v[20:23], v[44:47]
    v_mfma_f32_16x16x32_bf16 v[48:51], v[168:171], v[20:23], v[48:51]
    v_mfma_f32_16x16x32_bf16 v[52:55], v[172:175], v[20:23], v[52:55]
    s_waitcnt vmcnt(4)
    v_mfma_f32_16x16x32_bf16 v[56:59], v[156:159], v[24:27], v[56:59]
    buffer_load_dwordx4 v[20:23], v0, s[44:47], s58 offen offset:3072 sc1
    v_mfma_f32_16x16x32_bf16 v[60:63], v[160:163], v[24:27], v[60:63]
    v_mfma_f32_16x16x32_bf16 v[64:67], v[164:167], v[24:27], v[64:67]
    v_mfma_f32_16x16x32_bf16 v[68:71], v[168:171], v[24:27], v[68:71]
    v_mfma_f32_16x16x32_bf16 v[72:75], v[172:175], v[24:27], v[72:75]
    s_waitcnt vmcnt(4)
    v_mfma_f32_16x16x32_bf16 v[76:79], v[156:159], v[28:31], v[76:79]
    buffer_load_dwordx4 v[24:27], v0, s[44:47], s59 offen offset:3072 sc1
    v_mfma_f32_16x16x32_bf16 v[80:83], v[160:163], v[28:31], v[80:83]
    v_mfma_f32_16x16x32_bf16 v[84:87], v[164:167], v[28:31], v[84:87]
    v_mfma_f32_16x16x32_bf16 v[88:91], v[168:171], v[28:31], v[88:91]
    v_mfma_f32_16x16x32_bf16 v[92:95], v[172:175], v[28:31], v[92:95]
    s_waitcnt vmcnt(4)
    v_mfma_f32_16x16x32_bf16 v[96:99], v[156:159], v[32:35], v[96:99]
    buffer_load_dwordx4 v[28:31], v0, s[44:47], s60 offen offset:0 sc1
    v_mfma_f32_16x16x32_bf16 v[100:103], v[160:163], v[32:35], v[100:103]
    v_mfma_f32_16x16x32_bf16 v[104:107], v[164:167], v[32:35], v[104:107]
    v_mfma_f32_16x16x32_bf16 v[108:111], v[168:171], v[32:35], v[108:111]
    v_mfma_f32_16x16x32_bf16 v[112:115], v[172:175], v[32:35], v[112:115]
    s_waitcnt vmcnt(4)
    v_mfma_f32_16x16x32_bf16 v[36:39], v[176:179], v[12:15], v[36:39]
    buffer_load_dwordx4 v[32:35], v0, s[44:47], s61 offen offset:0 sc1
    v_mfma_f32_16x16x32_bf16 v[40:43], v[180:183], v[12:15], v[40:43]
    v_mfma_f32_16x16x32_bf16 v[44:47], v[184:187], v[12:15], v[44:47]
    v_mfma_f32_16x16x32_bf16 v[48:51], v[188:191], v[12:15], v[48:51]
    v_mfma_f32_16x16x32_bf16 v[52:55], v[192:195], v[12:15], v[52:55]
    s_waitcnt vmcnt(4)
    v_mfma_f32_16x16x32_bf16 v[56:59], v[176:179], v[16:19], v[56:59]
    buffer_load_dwordx4 v[12:15], v0, s[44:47], s62 offen offset:0 sc1
    v_mfma_f32_16x16x32_bf16 v[60:63], v[180:183], v[16:19], v[60:63]
    v_mfma_f32_16x16x32_bf16 v[64:67], v[184:187], v[16:19], v[64:67]
    v_mfma_f32_16x16x32_bf16 v[68:71], v[188:191], v[16:19], v[68:71]
    v_mfma_f32_16x16x32_bf16 v[72:75], v[192:195], v[16:19], v[72:75]
    s_waitcnt vmcnt(4)
    v_mfma_f32_16x16x32_bf16 v[76:79], v[176:179], v[20:23], v[76:79]
    buffer_load_dwordx4 v[16:19], v0, s[44:47], s63 offen offset:0 sc1
    v_mfma_f32_16x16x32_bf16 v[80:83], v[180:183], v[20:23], v[80:83]
    v_mfma_f32_16x16x32_bf16 v[84:87], v[184:187], v[20:23], v[84:87]
    v_mfma_f32_16x16x32_bf16 v[88:91], v[188:191], v[20:23], v[88:91]
    v_mfma_f32_16x16x32_bf16 v[92:95], v[192:195], v[20:23], v[92:95]
    s_waitcnt vmcnt(4)
    v_mfma_f32_16x16x32_bf16 v[96:99], v[176:179], v[24:27], v[96:99]
    buffer_load_dwordx4 v[20:23], v0, s[44:47], s60 offen offset:1024 sc1
    v_mfma_f32_16x16x32_bf16 v[100:103], v[180:183], v[24:27], v[100:103]
    v_mfma_f32_16x16x32_bf16 v[104:107], v[184:187], v[24:27], v[104:107]
    v_mfma_f32_16x16x32_bf16 v[108:111], v[188:191], v[24:27], v[108:111]
    v_mfma_f32_16x16x32_bf16 v[112:115], v[192:195], v[24:27], v[112:115]
    s_waitcnt vmcnt(4)
    v_mfma_f32_16x16x32_bf16 v[36:39], v[196:199], v[28:31], v[36:39]
    buffer_load_dwordx4 v[176:179], v0, s[44:47], s61 offen offset:1024 sc1
    v_mfma_f32_16x16x32_bf16 v[40:43], v[200:203], v[28:31], v[40:43]
    v_mfma_f32_16x16x32_bf16 v[44:47], v[204:207], v[28:31], v[44:47]
    v_mfma_f32_16x16x32_bf16 v[48:51], v[208:211], v[28:31], v[48:51]
    v_mfma_f32_16x16x32_bf16 v[52:55], v[212:215], v[28:31], v[52:55]
    s_waitcnt vmcnt(4)
    v_mfma_f32_16x16x32_bf16 v[56:59], v[196:199], v[32:35], v[56:59]
    buffer_load_dwordx4 v[180:183], v0, s[44:47], s62 offen offset:1024 sc1
    v_mfma_f32_16x16x32_bf16 v[60:63], v[200:203], v[32:35], v[60:63]
    v_mfma_f32_16x16x32_bf16 v[64:67], v[204:207], v[32:35], v[64:67]
    v_mfma_f32_16x16x32_bf16 v[68:71], v[208:211], v[32:35], v[68:71]
    v_mfma_f32_16x16x32_bf16 v[72:75], v[212:215], v[32:35], v[72:75]
    s_waitcnt vmcnt(4)
    v_mfma_f32_16x16x32_bf16 v[76:79], v[196:199], v[12:15], v[76:79]
    buffer_load_dwordx4 v[184:187], v0, s[44:47], s63 offen offset:1024 sc1
    v_mfma_f32_16x16x32_bf16 v[80:83], v[200:203], v[12:15], v[80:83]
    v_mfma_f32_16x16x32_bf16 v[84:87], v[204:207], v[12:15], v[84:87]
    v_mfma_f32_16x16x32_bf16 v[88:91], v[208:211], v[12:15], v[88:91]
    v_mfma_f32_16x16x32_bf16 v[92:95], v[212:215], v[12:15], v[92:95]
    s_waitcnt vmcnt(4)
    v_mfma_f32_16x16x32_bf16 v[96:99], v[196:199], v[16:19], v[96:99]
    buffer_load_dwordx4 v[188:191], v0, s[44:47], s60 offen offset:2048 sc1
    v_mfma_f32_16x16x32_bf16 v[100:103], v[200:203], v[16:19], v[100:103]
    v_mfma_f32_16x16x32_bf16 v[104:107], v[204:207], v[16:19], v[104:107]
    v_mfma_f32_16x16x32_bf16 v[108:111], v[208:211], v[16:19], v[108:111]
    v_mfma_f32_16x16x32_bf16 v[112:115], v[212:215], v[16:19], v[112:115]
    s_waitcnt vmcnt(4)
    v_mfma_f32_16x16x32_bf16 v[36:39], v[216:219], v[20:23], v[36:39]
    buffer_load_dwordx4 v[196:199], v0, s[44:47], s61 offen offset:2048 sc1
    v_mfma_f32_16x16x32_bf16 v[40:43], v[220:223], v[20:23], v[40:43]
    v_mfma_f32_16x16x32_bf16 v[44:47], v[224:227], v[20:23], v[44:47]
    v_mfma_f32_16x16x32_bf16 v[48:51], v[228:231], v[20:23], v[48:51]
    v_mfma_f32_16x16x32_bf16 v[52:55], v[232:235], v[20:23], v[52:55]
    s_waitcnt vmcnt(4)
    v_mfma_f32_16x16x32_bf16 v[56:59], v[216:219], v[176:179], v[56:59]
    buffer_load_dwordx4 v[200:203], v0, s[44:47], s62 offen offset:2048 sc1
    v_mfma_f32_16x16x32_bf16 v[60:63], v[220:223], v[176:179], v[60:63]
    v_mfma_f32_16x16x32_bf16 v[64:67], v[224:227], v[176:179], v[64:67]
    v_mfma_f32_16x16x32_bf16 v[68:71], v[228:231], v[176:179], v[68:71]
    v_mfma_f32_16x16x32_bf16 v[72:75], v[232:235], v[176:179], v[72:75]
    s_waitcnt vmcnt(4)
    v_mfma_f32_16x16x32_bf16 v[76:79], v[216:219], v[180:183], v[76:79]
    buffer_load_dwordx4 v[204:207], v0, s[44:47], s63 offen offset:2048 sc1
    v_mfma_f32_16x16x32_bf16 v[80:83], v[220:223], v[180:183], v[80:83]
    v_mfma_f32_16x16x32_bf16 v[84:87], v[224:227], v[180:183], v[84:87]
    v_mfma_f32_16x16x32_bf16 v[88:91], v[228:231], v[180:183], v[88:91]
    v_mfma_f32_16x16x32_bf16 v[92:95], v[232:235], v[180:183], v[92:95]
    s_waitcnt vmcnt(4)
    v_mfma_f32_16x16x32_bf16 v[96:99], v[216:219], v[184:187], v[96:99]
    buffer_load_dwordx4 v[208:211], v0, s[44:47], s60 offen offset:3072 sc1
    v_mfma_f32_16x16x32_bf16 v[100:103], v[220:223], v[184:187], v[100:103]
    v_mfma_f32_16x16x32_bf16 v[104:107], v[224:227], v[184:187], v[104:107]
    v_mfma_f32_16x16x32_bf16 v[108:111], v[228:231], v[184:187], v[108:111]
    v_mfma_f32_16x16x32_bf16 v[112:115], v[232:235], v[184:187], v[112:115]
    s_waitcnt vmcnt(4)
    v_mfma_f32_16x16x32_bf16 v[36:39], v[236:239], v[188:191], v[36:39]
    buffer_load_dwordx4 v[212:215], v0, s[44:47], s61 offen offset:3072 sc1
    v_mfma_f32_16x16x32_bf16 v[40:43], v[240:243], v[188:191], v[40:43]
    v_mfma_f32_16x16x32_bf16 v[44:47], v[244:247], v[188:191], v[44:47]
    v_mfma_f32_16x16x32_bf16 v[48:51], v[248:251], v[188:191], v[48:51]
    v_mfma_f32_16x16x32_bf16 v[52:55], v[252:255], v[188:191], v[52:55]
    s_waitcnt vmcnt(4)
    v_mfma_f32_16x16x32_bf16 v[56:59], v[236:239], v[196:199], v[56:59]
    ds_read_b64_tr_b16 v[216:217], v4 offset:32768
    ds_read_b64_tr_b16 v[218:219], v4 offset:33280
    v_mfma_f32_16x16x32_bf16 v[60:63], v[240:243], v[196:199], v[60:63]
    ds_read_b64_tr_b16 v[220:221], v5 offset:32768
    ds_read_b64_tr_b16 v[222:223], v5 offset:33280
    v_mfma_f32_16x16x32_bf16 v[64:67], v[244:247], v[196:199], v[64:67]
    ds_read_b64_tr_b16 v[224:225], v6 offset:32768
    ds_read_b64_tr_b16 v[226:227], v6 offset:33280
    v_mfma_f32_16x16x32_bf16 v[68:71], v[248:251], v[196:199], v[68:71]
    ds_read_b64_tr_b16 v[228:229], v7 offset:32768
    ds_read_b64_tr_b16 v[230:231], v7 offset:33280
    v_mfma_f32_16x16x32_bf16 v[72:75], v[252:255], v[196:199], v[72:75]
    ds_read_b128 v[232:235], v8 offset:0
    buffer_load_dwordx4 v[176:179], v0, s[44:47], s62 offen offset:3072 sc1
    s_waitcnt vmcnt(4)
    v_mfma_f32_16x16x32_bf16 v[76:79], v[236:239], v[200:203], v[76:79]
    buffer_load_dwordx4 v[196:199], v0, s[44:47], s63 offen offset:3072 sc1
    v_mfma_f32_16x16x32_bf16 v[80:83], v[240:243], v[200:203], v[80:83]
    v_mfma_f32_16x16x32_bf16 v[84:87], v[244:247], v[200:203], v[84:87]
    v_mfma_f32_16x16x32_bf16 v[88:91], v[248:251], v[200:203], v[88:91]
    v_mfma_f32_16x16x32_bf16 v[92:95], v[252:255], v[200:203], v[92:95]
    s_waitcnt vmcnt(4)
    v_mfma_f32_16x16x32_bf16 v[96:99], v[236:239], v[204:207], v[96:99]
    buffer_load_dwordx4 v[200:203], v0, s[44:47], s64 offen offset:0 sc1
    s_waitcnt lgkmcnt(0)
    s_add_u32 m0, s10, 98304
    s_add_u32 s4, s12, 491520
    buffer_load_dwordx4 v1, s[36:39], s4 offen lds
    v_mfma_f32_16x16x32_bf16 v[100:103], v[240:243], v[204:207], v[100:103]
    s_add_u32 m0, s10, 99328
    s_add_u32 s4, s12, 501760
    buffer_load_dwordx4 v2, s[36:39], s4 offen lds
    s_add_u32 m0, s10, 100352
    s_add_u32 s4, s12, 512000
    buffer_load_dwordx4 v1, s[36:39], s4 offen lds
    v_mfma_f32_16x16x32_bf16 v[104:107], v[244:247], v[204:207], v[104:107]
    s_add_u32 m0, s10, 101376
    s_add_u32 s4, s12, 522240
    buffer_load_dwordx4 v2, s[36:39], s4 offen lds
    s_add_u32 m0, s11, 0
    s_add_u32 s4, s76, 12288
    buffer_load_dwordx4 v0, s[84:87], s4 offen sc1 lds
    v_mfma_f32_16x16x32_bf16 v[108:111], v[248:251], v[204:207], v[108:111]
    v_mfma_f32_16x16x32_bf16 v[112:115], v[252:255], v[204:207], v[112:115]
    s_waitcnt vmcnt(9)
    v_mfma_f32_16x16x32_bf16 v[36:39], v[216:219], v[208:211], v[36:39]
    buffer_load_dwordx4 v[204:207], v0, s[44:47], s65 offen offset:0 sc1
    v_mfma_f32_16x16x32_bf16 v[40:43], v[220:223], v[208:211], v[40:43]
    v_mfma_f32_16x16x32_bf16 v[44:47], v[224:227], v[208:211], v[44:47]
    v_mfma_f32_16x16x32_bf16 v[48:51], v[228:231], v[208:211], v[48:51]
    v_mfma_f32_16x16x32_bf16 v[52:55], v[232:235], v[208:211], v[52:55]
    s_waitcnt vmcnt(9)
    v_mfma_f32_16x16x32_bf16 v[56:59], v[216:219], v[212:215], v[56:59]
    ds_read_b64_tr_b16 v[236:237], v4 offset:16384
    ds_read_b64_tr_b16 v[238:239], v4 offset:16896
    v_mfma_f32_16x16x32_bf16 v[60:63], v[220:223], v[212:215], v[60:63]
    ds_read_b64_tr_b16 v[240:241], v5 offset:16384
    ds_read_b64_tr_b16 v[242:243], v5 offset:16896
    v_mfma_f32_16x16x32_bf16 v[64:67], v[224:227], v[212:215], v[64:67]
    ds_read_b64_tr_b16 v[244:245], v6 offset:16384
    ds_read_b64_tr_b16 v[246:247], v6 offset:16896
    v_mfma_f32_16x16x32_bf16 v[68:71], v[228:231], v[212:215], v[68:71]
    ds_read_b64_tr_b16 v[248:249], v7 offset:16384
    ds_read_b64_tr_b16 v[250:251], v7 offset:16896
    v_mfma_f32_16x16x32_bf16 v[72:75], v[232:235], v[212:215], v[72:75]
    ds_read_b128 v[252:255], v8 offset:1024
    buffer_load_dwordx4 v[208:211], v0, s[44:47], s66 offen offset:0 sc1
    s_waitcnt vmcnt(9)
    v_mfma_f32_16x16x32_bf16 v[76:79], v[216:219], v[176:179], v[76:79]
    buffer_load_dwordx4 v[212:215], v0, s[44:47], s67 offen offset:0 sc1
    v_mfma_f32_16x16x32_bf16 v[80:83], v[220:223], v[176:179], v[80:83]
    v_mfma_f32_16x16x32_bf16 v[84:87], v[224:227], v[176:179], v[84:87]
    v_mfma_f32_16x16x32_bf16 v[88:91], v[228:231], v[176:179], v[88:91]
    v_mfma_f32_16x16x32_bf16 v[92:95], v[232:235], v[176:179], v[92:95]
    s_waitcnt vmcnt(9)
    v_mfma_f32_16x16x32_bf16 v[96:99], v[216:219], v[196:199], v[96:99]
    buffer_load_dwordx4 v[176:179], v0, s[44:47], s64 offen offset:1024 sc1
    s_waitcnt lgkmcnt(0)
    s_add_u32 m0, s10, 81920
    s_add_u32 s4, s12, 532480
    buffer_load_dwordx4 v1, s[36:39], s4 offen lds
    v_mfma_f32_16x16x32_bf16 v[100:103], v[220:223], v[196:199], v[100:103]
    s_add_u32 m0, s10, 82944
    s_add_u32 s4, s12, 542720
    buffer_load_dwordx4 v2, s[36:39], s4 offen lds
    s_add_u32 m0, s10, 83968
    s_add_u32 s4, s12, 552960
    buffer_load_dwordx4 v1, s[36:39], s4 offen lds
    v_mfma_f32_16x16x32_bf16 v[104:107], v[224:227], v[196:199], v[104:107]
    s_add_u32 m0, s10, 84992
    s_add_u32 s4, s12, 563200
    buffer_load_dwordx4 v2, s[36:39], s4 offen lds
    s_add_u32 m0, s11, 1024
    s_add_u32 s4, s76, 13312
    buffer_load_dwordx4 v0, s[84:87], s4 offen sc1 lds
    v_mfma_f32_16x16x32_bf16 v[108:111], v[228:231], v[196:199], v[108:111]
    v_mfma_f32_16x16x32_bf16 v[112:115], v[232:235], v[196:199], v[112:115]
    s_waitcnt vmcnt(14)
    v_mfma_f32_16x16x32_bf16 v[36:39], v[236:239], v[200:203], v[36:39]
    buffer_load_dwordx4 v[196:199], v0, s[44:47], s65 offen offset:1024 sc1
    v_mfma_f32_16x16x32_bf16 v[40:43], v[240:243], v[200:203], v[40:43]
    v_mfma_f32_16x16x32_bf16 v[44:47], v[244:247], v[200:203], v[44:47]
    v_mfma_f32_16x16x32_bf16 v[48:51], v[248:251], v[200:203], v[48:51]
    v_mfma_f32_16x16x32_bf16 v[52:55], v[252:255], v[200:203], v[52:55]
    s_waitcnt vmcnt(9)
    v_mfma_f32_16x16x32_bf16 v[56:59], v[236:239], v[204:207], v[56:59]
    ds_read_b64_tr_b16 v[216:217], v4 offset:0
    ds_read_b64_tr_b16 v[218:219], v4 offset:512
    v_mfma_f32_16x16x32_bf16 v[60:63], v[240:243], v[204:207], v[60:63]
    ds_read_b64_tr_b16 v[220:221], v5 offset:0
    ds_read_b64_tr_b16 v[222:223], v5 offset:512
    v_mfma_f32_16x16x32_bf16 v[64:67], v[244:247], v[204:207], v[64:67]
    ds_read_b64_tr_b16 v[224:225], v6 offset:0
    ds_read_b64_tr_b16 v[226:227], v6 offset:512
    v_mfma_f32_16x16x32_bf16 v[68:71], v[248:251], v[204:207], v[68:71]
    ds_read_b64_tr_b16 v[228:229], v7 offset:0
    ds_read_b64_tr_b16 v[230:231], v7 offset:512
    v_mfma_f32_16x16x32_bf16 v[72:75], v[252:255], v[204:207], v[72:75]
    ds_read_b128 v[232:235], v8 offset:2048
    buffer_load_dwordx4 v[180:183], v0, s[44:47], s66 offen offset:1024 sc1
    s_waitcnt vmcnt(9)
    v_mfma_f32_16x16x32_bf16 v[76:79], v[236:239], v[208:211], v[76:79]
    buffer_load_dwordx4 v[12:15], v0, s[44:47], s67 offen offset:1024 sc1
    v_mfma_f32_16x16x32_bf16 v[80:83], v[240:243], v[208:211], v[80:83]
    v_mfma_f32_16x16x32_bf16 v[84:87], v[244:247], v[208:211], v[84:87]
    v_mfma_f32_16x16x32_bf16 v[88:91], v[248:251], v[208:211], v[88:91]
    v_mfma_f32_16x16x32_bf16 v[92:95], v[252:255], v[208:211], v[92:95]
    s_waitcnt vmcnt(9)
    v_mfma_f32_16x16x32_bf16 v[96:99], v[236:239], v[212:215], v[96:99]
    buffer_load_dwordx4 v[16:19], v0, s[44:47], s64 offen offset:2048 sc1
    v_mfma_f32_16x16x32_bf16 v[100:103], v[240:243], v[212:215], v[100:103]
    v_mfma_f32_16x16x32_bf16 v[104:107], v[244:247], v[212:215], v[104:107]
    v_mfma_f32_16x16x32_bf16 v[108:111], v[248:251], v[212:215], v[108:111]
    v_mfma_f32_16x16x32_bf16 v[112:115], v[252:255], v[212:215], v[112:115]
    s_waitcnt vmcnt(9)
    s_waitcnt lgkmcnt(0)
    v_mfma_f32_16x16x32_bf16 v[36:39], v[216:219], v[176:179], v[36:39]
    buffer_load_dwordx4 v[20:23], v0, s[44:47], s64 offen offset:3072 sc1
    v_mfma_f32_16x16x32_bf16 v[40:43], v[220:223], v[176:179], v[40:43]
    v_mfma_f32_16x16x32_bf16 v[44:47], v[224:227], v[176:179], v[44:47]
    v_mfma_f32_16x16x32_bf16 v[48:51], v[228:231], v[176:179], v[48:51]
    v_mfma_f32_16x16x32_bf16 v[52:55], v[232:235], v[176:179], v[52:55]
    s_waitcnt vmcnt(4)
    v_mfma_f32_16x16x32_bf16 v[56:59], v[216:219], v[196:199], v[56:59]
    v_add_u32 v4, 0x4000, v4
    v_add_u32 v5, 0x4000, v5
    v_add_u32 v6, 0x4000, v6
    v_add_u32 v7, 0x4000, v7
    ds_read_b64_tr_b16 v[236:237], v4 offset:32768
    ds_read_b64_tr_b16 v[238:239], v4 offset:33280
    v_mfma_f32_16x16x32_bf16 v[60:63], v[220:223], v[196:199], v[60:63]
    ds_read_b64_tr_b16 v[240:241], v5 offset:32768
    ds_read_b64_tr_b16 v[242:243], v5 offset:33280
    v_mfma_f32_16x16x32_bf16 v[64:67], v[224:227], v[196:199], v[64:67]
    ds_read_b64_tr_b16 v[244:245], v6 offset:32768
    ds_read_b64_tr_b16 v[246:247], v6 offset:33280
    v_mfma_f32_16x16x32_bf16 v[68:71], v[228:231], v[196:199], v[68:71]
    ds_read_b64_tr_b16 v[248:249], v7 offset:32768
    ds_read_b64_tr_b16 v[250:251], v7 offset:33280
    v_mfma_f32_16x16x32_bf16 v[72:75], v[232:235], v[196:199], v[72:75]
    ds_read_b128 v[252:255], v8 offset:3072
    buffer_load_dwordx4 v[24:27], v0, s[44:47], s68 offen offset:0 sc1
    s_waitcnt vmcnt(4)
    v_mfma_f32_16x16x32_bf16 v[76:79], v[216:219], v[180:183], v[76:79]
    ds_read_b64_tr_b16 v[196:197], v4 offset:49152
    ds_read_b64_tr_b16 v[198:199], v4 offset:49664
    v_mfma_f32_16x16x32_bf16 v[80:83], v[220:223], v[180:183], v[80:83]
    ds_read_b64_tr_b16 v[200:201], v5 offset:49152
    ds_read_b64_tr_b16 v[202:203], v5 offset:49664
    v_mfma_f32_16x16x32_bf16 v[84:87], v[224:227], v[180:183], v[84:87]
    ds_read_b64_tr_b16 v[204:205], v6 offset:49152
    ds_read_b64_tr_b16 v[206:207], v6 offset:49664
    v_mfma_f32_16x16x32_bf16 v[88:91], v[228:231], v[180:183], v[88:91]
    ds_read_b64_tr_b16 v[208:209], v7 offset:49152
    ds_read_b64_tr_b16 v[210:211], v7 offset:49664
    v_mfma_f32_16x16x32_bf16 v[92:95], v[232:235], v[180:183], v[92:95]
    s_add_u32 s4, s22, 155648
    v_add_u32 v212, s4, v0
    ds_read_b128 v[212:215], v212
    buffer_load_dwordx4 v[28:31], v0, s[44:47], s72 offen offset:0 sc1
    s_waitcnt vmcnt(4)
    v_mfma_f32_16x16x32_bf16 v[96:99], v[216:219], v[12:15], v[96:99]
    ds_read_b64_tr_b16 v[176:177], v4 offset:16384
    ds_read_b64_tr_b16 v[178:179], v4 offset:16896
    v_mfma_f32_16x16x32_bf16 v[100:103], v[220:223], v[12:15], v[100:103]
    ds_read_b64_tr_b16 v[180:181], v5 offset:16384
    ds_read_b64_tr_b16 v[182:183], v5 offset:16896
    v_mfma_f32_16x16x32_bf16 v[104:107], v[224:227], v[12:15], v[104:107]
    ds_read_b64_tr_b16 v[184:185], v6 offset:16384
    ds_read_b64_tr_b16 v[186:187], v6 offset:16896
    v_mfma_f32_16x16x32_bf16 v[108:111], v[228:231], v[12:15], v[108:111]
    ds_read_b64_tr_b16 v[188:189], v7 offset:16384
    ds_read_b64_tr_b16 v[190:191], v7 offset:16896
    v_mfma_f32_16x16x32_bf16 v[112:115], v[232:235], v[12:15], v[112:115]
    ds_read_b128 v[192:195], v8 offset:0
    buffer_load_dwordx4 v[32:35], v0, s[44:47], s65 offen offset:2048 sc1
    s_waitcnt vmcnt(4)
    s_waitcnt lgkmcnt(15)
    s_add_u32 s4, s10, 65536
    v_add_u32 v2, s4, v0
    v_add_u32 v1, 0x10000, v2
    v_mfma_f32_16x16x32_bf16 v[36:39], v[236:239], v[16:19], v[36:39]
    s_lshl_b32 s4, s9, 2
    v_add_u32 v9, s4, v10
    ds_write_b32 v9, v11 offset:32
    ds_read_b64_tr_b16 v[216:217], v4 offset:0
    v_mfma_f32_16x16x32_bf16 v[40:43], v[240:243], v[16:19], v[40:43]
    ds_read_b64_tr_b16 v[218:219], v4 offset:512
    ds_read_b64_tr_b16 v[220:221], v5 offset:0
    v_mfma_f32_16x16x32_bf16 v[44:47], v[244:247], v[16:19], v[44:47]
    ds_read_b64_tr_b16 v[222:223], v5 offset:512
    ds_read_b64_tr_b16 v[224:225], v6 offset:0
    v_mfma_f32_16x16x32_bf16 v[48:51], v[248:251], v[16:19], v[48:51]
    ds_read_b64_tr_b16 v[226:227], v6 offset:512
    ds_read_b64_tr_b16 v[228:229], v7 offset:0
    v_mfma_f32_16x16x32_bf16 v[52:55], v[252:255], v[16:19], v[52:55]
    ds_read_b64_tr_b16 v[230:231], v7 offset:512
    ds_read_b128 v[232:235], v8 offset:1024
    s_waitcnt vmcnt(3)
    s_waitcnt lgkmcnt(15)
    v_mfma_f32_16x16x32_bf16 v[36:39], v[196:199], v[20:23], v[36:39]
    buffer_load_dwordx4 v[12:15], v0, s[44:47], s65 offen offset:3072 sc1
    buffer_load_dwordx4 v[16:19], v0, s[44:47], s69 offen offset:0 sc1
    v_mfma_f32_16x16x32_bf16 v[40:43], v[200:203], v[20:23], v[40:43]
    v_mfma_f32_16x16x32_bf16 v[44:47], v[204:207], v[20:23], v[44:47]
    v_mfma_f32_16x16x32_bf16 v[48:51], v[208:211], v[20:23], v[48:51]
    v_mfma_f32_16x16x32_bf16 v[52:55], v[212:215], v[20:23], v[52:55]
    s_waitcnt vmcnt(4)
    s_waitcnt lgkmcnt(10)
    v_mfma_f32_16x16x32_bf16 v[36:39], v[176:179], v[24:27], v[36:39]
    buffer_load_dwordx4 v[20:23], v0, s[44:47], s73 offen offset:0 sc1
    v_mfma_f32_16x16x32_bf16 v[40:43], v[180:183], v[24:27], v[40:43]
    v_mfma_f32_16x16x32_bf16 v[44:47], v[184:187], v[24:27], v[44:47]
    v_mfma_f32_16x16x32_bf16 v[48:51], v[188:191], v[24:27], v[48:51]
    v_mfma_f32_16x16x32_bf16 v[52:55], v[192:195], v[24:27], v[52:55]
    s_waitcnt vmcnt(4)
    s_waitcnt lgkmcnt(0)
    v_mfma_f32_16x16x32_bf16 v[36:39], v[216:219], v[28:31], v[36:39]
    buffer_load_dwordx4 v[24:27], v0, s[44:47], s66 offen offset:2048 sc1
    v_mfma_f32_16x16x32_bf16 v[40:43], v[220:223], v[28:31], v[40:43]
    v_mfma_f32_16x16x32_bf16 v[44:47], v[224:227], v[28:31], v[44:47]
    v_mfma_f32_16x16x32_bf16 v[48:51], v[228:231], v[28:31], v[48:51]
    v_mfma_f32_16x16x32_bf16 v[52:55], v[232:235], v[28:31], v[52:55]
    s_waitcnt vmcnt(4)
    v_mfma_f32_16x16x32_bf16 v[56:59], v[236:239], v[32:35], v[56:59]
    buffer_load_dwordx4 v[28:31], v0, s[44:47], s66 offen offset:3072 sc1
    v_mfma_f32_16x16x32_bf16 v[60:63], v[240:243], v[32:35], v[60:63]
    v_mfma_f32_16x16x32_bf16 v[64:67], v[244:247], v[32:35], v[64:67]
    v_mfma_f32_16x16x32_bf16 v[68:71], v[248:251], v[32:35], v[68:71]
    v_mfma_f32_16x16x32_bf16 v[72:75], v[252:255], v[32:35], v[72:75]
    ds_write_b128 v2, v[36:39] offset:0
    s_waitcnt vmcnt(4)
    v_mfma_f32_16x16x32_bf16 v[56:59], v[196:199], v[12:15], v[56:59]
    buffer_load_dwordx4 v[32:35], v0, s[44:47], s70 offen offset:0 sc1
    buffer_load_dwordx2 v[4:5], v3, s[48:51], s15 offen
    ds_write_b128 v2, v[40:43] offset:1024
    v_mfma_f32_16x16x32_bf16 v[60:63], v[200:203], v[12:15], v[60:63]
    ds_write_b128 v2, v[44:47] offset:2048
    v_mfma_f32_16x16x32_bf16 v[64:67], v[204:207], v[12:15], v[64:67]
    ds_write_b128 v2, v[48:51] offset:3072
    v_mfma_f32_16x16x32_bf16 v[68:71], v[208:211], v[12:15], v[68:71]
    ds_write_b128 v1, v[52:55] offset:0
    v_mfma_f32_16x16x32_bf16 v[72:75], v[212:215], v[12:15], v[72:75]
    s_mov_b64 exec, 1
    ds_add_u32 v10, v11 offset:48
    s_mov_b64 exec, -1
    s_waitcnt vmcnt(5)
    v_mfma_f32_16x16x32_bf16 v[56:59], v[176:179], v[16:19], v[56:59]
    buffer_load_dwordx4 v[12:15], v0, s[44:47], s74 offen offset:0 sc1
    v_mfma_f32_16x16x32_bf16 v[60:63], v[180:183], v[16:19], v[60:63]
    v_mfma_f32_16x16x32_bf16 v[64:67], v[184:187], v[16:19], v[64:67]
    v_mfma_f32_16x16x32_bf16 v[68:71], v[188:191], v[16:19], v[68:71]
    v_mfma_f32_16x16x32_bf16 v[72:75], v[192:195], v[16:19], v[72:75]
    s_waitcnt vmcnt(5)
    v_mfma_f32_16x16x32_bf16 v[56:59], v[216:219], v[20:23], v[56:59]
    buffer_load_dwordx4 v[16:19], v0, s[44:47], s67 offen offset:2048 sc1
    v_mfma_f32_16x16x32_bf16 v[60:63], v[220:223], v[20:23], v[60:63]
    v_mfma_f32_16x16x32_bf16 v[64:67], v[224:227], v[20:23], v[64:67]
    v_mfma_f32_16x16x32_bf16 v[68:71], v[228:231], v[20:23], v[68:71]
    v_mfma_f32_16x16x32_bf16 v[72:75], v[232:235], v[20:23], v[72:75]
    s_waitcnt vmcnt(5)
    v_mfma_f32_16x16x32_bf16 v[76:79], v[236:239], v[24:27], v[76:79]
    buffer_load_dwordx4 v[20:23], v0, s[44:47], s67 offen offset:3072 sc1
    v_mfma_f32_16x16x32_bf16 v[80:83], v[240:243], v[24:27], v[80:83]
    v_mfma_f32_16x16x32_bf16 v[84:87], v[244:247], v[24:27], v[84:87]
    v_mfma_f32_16x16x32_bf16 v[88:91], v[248:251], v[24:27], v[88:91]
    v_mfma_f32_16x16x32_bf16 v[92:95], v[252:255], v[24:27], v[92:95]
    ds_write_b128 v2, v[56:59] offset:16384
    s_waitcnt vmcnt(5)
    v_mfma_f32_16x16x32_bf16 v[76:79], v[196:199], v[28:31], v[76:79]
    buffer_load_dwordx4 v[24:27], v0, s[44:47], s71 offen offset:0 sc1
    ds_write_b128 v2, v[60:63] offset:17408
    v_mfma_f32_16x16x32_bf16 v[80:83], v[200:203], v[28:31], v[80:83]
    ds_write_b128 v2, v[64:67] offset:18432
    v_mfma_f32_16x16x32_bf16 v[84:87], v[204:207], v[28:31], v[84:87]
    ds_write_b128 v2, v[68:71] offset:19456
    v_mfma_f32_16x16x32_bf16 v[88:91], v[208:211], v[28:31], v[88:91]
    ds_write_b128 v1, v[72:75] offset:1024
    v_mfma_f32_16x16x32_bf16 v[92:95], v[212:215], v[28:31], v[92:95]
    s_mov_b64 exec, 1
    ds_add_u32 v10, v11 offset:52
    s_mov_b64 exec, -1
    s_waitcnt vmcnt(5)
    v_mfma_f32_16x16x32_bf16 v[76:79], v[176:179], v[32:35], v[76:79]
    buffer_load_dwordx4 v[28:31], v0, s[44:47], s75 offen offset:0 sc1
    v_mfma_f32_16x16x32_bf16 v[80:83], v[180:183], v[32:35], v[80:83]
    v_mfma_f32_16x16x32_bf16 v[84:87], v[184:187], v[32:35], v[84:87]
    v_mfma_f32_16x16x32_bf16 v[88:91], v[188:191], v[32:35], v[88:91]
    v_mfma_f32_16x16x32_bf16 v[92:95], v[192:195], v[32:35], v[92:95]
    s_waitcnt vmcnt(4)
    v_mfma_f32_16x16x32_bf16 v[76:79], v[216:219], v[12:15], v[76:79]
    v_mfma_f32_16x16x32_bf16 v[80:83], v[220:223], v[12:15], v[80:83]
    v_mfma_f32_16x16x32_bf16 v[84:87], v[224:227], v[12:15], v[84:87]
    v_mfma_f32_16x16x32_bf16 v[88:91], v[228:231], v[12:15], v[88:91]
    v_mfma_f32_16x16x32_bf16 v[92:95], v[232:235], v[12:15], v[92:95]
    s_waitcnt vmcnt(3)
    v_mfma_f32_16x16x32_bf16 v[96:99], v[236:239], v[16:19], v[96:99]
    v_mfma_f32_16x16x32_bf16 v[100:103], v[240:243], v[16:19], v[100:103]
    v_mfma_f32_16x16x32_bf16 v[104:107], v[244:247], v[16:19], v[104:107]
    v_mfma_f32_16x16x32_bf16 v[108:111], v[248:251], v[16:19], v[108:111]
    v_mfma_f32_16x16x32_bf16 v[112:115], v[252:255], v[16:19], v[112:115]
    ds_write_b128 v2, v[76:79] offset:32768
    s_waitcnt vmcnt(2)
    v_mfma_f32_16x16x32_bf16 v[96:99], v[196:199], v[20:23], v[96:99]
    ds_write_b128 v2, v[80:83] offset:33792
    v_mfma_f32_16x16x32_bf16 v[100:103], v[200:203], v[20:23], v[100:103]
    ds_write_b128 v2, v[84:87] offset:34816
    v_mfma_f32_16x16x32_bf16 v[104:107], v[204:207], v[20:23], v[104:107]
    ds_write_b128 v2, v[88:91] offset:35840
    v_mfma_f32_16x16x32_bf16 v[108:111], v[208:211], v[20:23], v[108:111]
    ds_write_b128 v1, v[92:95] offset:2048
    v_mfma_f32_16x16x32_bf16 v[112:115], v[212:215], v[20:23], v[112:115]
    s_mov_b64 exec, 1
    ds_add_u32 v10, v11 offset:56
    s_mov_b64 exec, -1
    s_waitcnt vmcnt(1)
    v_mfma_f32_16x16x32_bf16 v[96:99], v[176:179], v[24:27], v[96:99]
    v_mfma_f32_16x16x32_bf16 v[100:103], v[180:183], v[24:27], v[100:103]
    v_mfma_f32_16x16x32_bf16 v[104:107], v[184:187], v[24:27], v[104:107]
    v_mfma_f32_16x16x32_bf16 v[108:111], v[188:191], v[24:27], v[108:111]
    v_mfma_f32_16x16x32_bf16 v[112:115], v[192:195], v[24:27], v[112:115]
    s_waitcnt vmcnt(0)
    v_mfma_f32_16x16x32_bf16 v[96:99], v[216:219], v[28:31], v[96:99]
    v_mfma_f32_16x16x32_bf16 v[100:103], v[220:223], v[28:31], v[100:103]
    v_mfma_f32_16x16x32_bf16 v[104:107], v[224:227], v[28:31], v[104:107]
    v_mfma_f32_16x16x32_bf16 v[108:111], v[228:231], v[28:31], v[108:111]
    v_mfma_f32_16x16x32_bf16 v[112:115], v[232:235], v[28:31], v[112:115]
    s_add_u32 s4, s22, 131072
    v_add_u32 v6, s4, v0
    s_add_u32 s4, s22, 40960
    s_nop 2
    ds_write_b128 v2, v[96:99] offset:49152
    ds_write_b128 v2, v[100:103] offset:50176
    ds_write_b128 v2, v[104:107] offset:51200
    ds_write_b128 v2, v[108:111] offset:52224
    ds_write_b128 v1, v[112:115] offset:3072
    s_mov_b64 exec, 1
    ds_add_u32 v10, v11 offset:60
    s_mov_b64 exec, -1
    v_add_u32 v8, s4, v0
    s_mov_b32 s60, 0xbfb8aa3b
p2_P_s1:
    ds_read_b32 v11, v10 offset:24
    s_waitcnt lgkmcnt(0)
    v_readfirstlane_b32 s4, v11
    s_cmp_lt_u32 s4, 4
    s_cbranch_scc1 p2_P_s1
    s_cmp_gt_u32 s4, 4
    s_cbranch_scc1 p2_end
    ds_read_b128 v[132:135], v8 offset:0
    ds_read_b128 v[136:139], v8 offset:5088
    ds_read_b128 v[140:143], v8 offset:10176
    ds_read_b128 v[144:147], v8 offset:15264
p2_P_s2:
    ds_read_b32 v11, v9 offset:48
    s_waitcnt lgkmcnt(0)
    v_readfirstlane_b32 s4, v11
    s_cmp_lt_u32 s4, 4
    s_cbranch_scc1 p2_P_s2
    ds_read_b128 v[116:119], v6 offset:0
    ds_read_b128 v[120:123], v6 offset:4096
    ds_read_b128 v[124:127], v6 offset:8192
    ds_read_b128 v[128:131], v6 offset:12288
    v_add_f32 v132, v132, v136
    v_add_f32 v140, v140, v144
    v_add_f32 v133, v133, v137
    v_add_f32 v141, v141, v145
    v_add_f32 v134, v134, v138
    v_add_f32 v142, v142, v146
    v_add_f32 v135, v135, v139
    v_add_f32 v143, v143, v147
    v_add_f32 v132, v132, v140
    v_add_f32 v133, v133, v141
    v_add_f32 v134, v134, v142
    v_add_f32 v135, v135, v143
    s_waitcnt lgkmcnt(0)
    v_add_f32 v116, v116, v120
    v_add_f32 v124, v124, v128
    v_add_f32 v117, v117, v121
    v_add_f32 v125, v125, v129
    v_add_f32 v118, v118, v122
    v_add_f32 v126, v126, v130
    v_add_f32 v119, v119, v123
    v_add_f32 v127, v127, v131
    v_add_f32 v116, v116, v124
    v_add_f32 v117, v117, v125
    v_add_f32 v118, v118, v126
    v_add_f32 v119, v119, v127
    s_waitcnt vmcnt(0)
    v_cvt_pk_bf16_f32 v16, v116, v117
    v_lshlrev_b32 v116, 16, v16
    v_and_b32 v117, 0xffff0000, v16
    v_mul_f32 v17, s60, v116
    v_exp_f32 v17, v17
    v_mul_f32 v18, s60, v117
    v_exp_f32 v18, v18
    v_cvt_pk_bf16_f32 v16, v132, v133
    v_lshlrev_b32 v132, 16, v16
    v_and_b32 v133, 0xffff0000, v16
    v_add_f32 v17, 1.0, v17
    v_rcp_f32 v17, v17
    v_add_f32 v18, 1.0, v18
    v_rcp_f32 v18, v18
    s_nop 0
    v_mul_f32 v116, v116, v17
    v_mul_f32 v117, v117, v18
    v_cvt_pk_bf16_f32 v16, v116, v117
    v_lshlrev_b32 v116, 16, v16
    v_and_b32 v117, 0xffff0000, v16
    v_lshlrev_b32 v17, 16, v4
    v_and_b32 v18, 0xffff0000, v4
    v_mul_f32 v132, v132, v116
    v_mul_f32 v133, v133, v117
    v_cvt_pk_bf16_f32 v16, v132, v133
    v_lshlrev_b32 v132, 16, v16
    v_and_b32 v133, 0xffff0000, v16
    v_add_f32 v132, v132, v17
    v_add_f32 v133, v133, v18
    v_cvt_pk_bf16_f32 v14, v132, v133
    v_cvt_pk_bf16_f32 v16, v118, v119
    v_lshlrev_b32 v118, 16, v16
    v_and_b32 v119, 0xffff0000, v16
    v_mul_f32 v17, s60, v118
    v_exp_f32 v17, v17
    v_mul_f32 v18, s60, v119
    v_exp_f32 v18, v18
    v_cvt_pk_bf16_f32 v16, v134, v135
    v_lshlrev_b32 v134, 16, v16
    v_and_b32 v135, 0xffff0000, v16
    v_add_f32 v17, 1.0, v17
    v_rcp_f32 v17, v17
    v_add_f32 v18, 1.0, v18
    v_rcp_f32 v18, v18
    s_nop 0
    v_mul_f32 v118, v118, v17
    v_mul_f32 v119, v119, v18
    v_cvt_pk_bf16_f32 v16, v118, v119
    v_lshlrev_b32 v118, 16, v16
    v_and_b32 v119, 0xffff0000, v16
    v_lshlrev_b32 v17, 16, v5
    v_and_b32 v18, 0xffff0000, v5
    v_mul_f32 v134, v134, v118
    v_mul_f32 v135, v135, v119
    v_cvt_pk_bf16_f32 v16, v134, v135
    v_lshlrev_b32 v134, 16, v16
    v_and_b32 v135, 0xffff0000, v16
    v_add_f32 v134, v134, v17
    v_add_f32 v135, v135, v18
    v_cvt_pk_bf16_f32 v15, v134, v135
    buffer_store_dwordx2 v[14:15], v3, s[52:55], s15 offen
    s_branch p2_end
p2_P_abort:
    v_lshrrev_b32 v9, 2, v0
    v_mov_b32 v11, 0x101
    s_mov_b64 exec, 0xff
    ds_write_b32 v9, v11 offset:61344
    s_mov_b64 exec, -1
    s_waitcnt vmcnt(0)
    s_branch p2_end
p2_Q:
    v_mbcnt_lo_u32_b32 v9, -1, 0
    v_mbcnt_hi_u32_b32 v9, -1, v9
    s_and_b32 s9, s8, 3
    s_bfe_u32 s7, s3, 0x30003
    s_and_b32 s6, s3, 7
    s_lshl_b32 s6, s6, 2
    s_lshr_b32 s4, s3, 6
    s_add_u32 s6, s6, s4
    v_and_b32 v10, 15, v9
    v_lshrrev_b32 v11, 4, v9
    v_lshlrev_b32 v0, 4, v9
    s_lshl_b32 s10, s9, 12
    s_lshl_b32 s22, s9, 10
    s_lshl_b32 s11, s9, 3
    s_lshr_b32 s11, 0x270f0908, s11
    s_and_b32 s11, s11, 255
    s_lshl_b32 s11, s11, 12
    s_mov_b32 s48, s16
    s_mov_b32 s49, s17
    s_and_b32 s49, s49, 0xffff
    s_mov_b32 s50, 2621440
    s_mov_b32 s51, 0x00020000
    s_mov_b32 s52, s30
    s_mov_b32 s53, s31
    s_and_b32 s53, s53, 0xffff
    s_mov_b32 s54, 2621440
    s_mov_b32 s55, 0x00020000
    s_mov_b32 s80, s32
    s_mov_b32 s81, s33
    s_and_b32 s81, s81, 0xffff
    s_mov_b32 s82, 256
    s_mov_b32 s83, 0x00020000
    s_add_u32 s84, s34, 13713408
    s_addc_u32 s85, s35, 0
    s_and_b32 s85, s85, 0xffff
    s_mov_b32 s86, 606208
    s_mov_b32 s87, 0x00020000
    s_mul_i32 s76, s7, 74
    s_mul_i32 s77, s9, 5
    s_add_u32 s77, s77, s76
    s_add_u32 s77, s77, 54
    s_lshl_b32 s77, s77, 10
    s_mov_b32 s36, s20
    s_mov_b32 s37, s21
    s_and_b32 s37, s37, 0xffff
    s_mov_b32 s38, 819200
    s_mov_b32 s39, 0x00020000
    s_add_u32 s40, s34, 1064960
    s_addc_u32 s41, s35, 0
    s_and_b32 s41, s41, 0xffff
    s_mov_b32 s42, 3145728
    s_mov_b32 s43, 0x00020000
    s_add_u32 s44, s34, 11288576
    s_addc_u32 s45, s35, 0
    s_and_b32 s45, s45, 0xffff
    s_mov_b32 s46, 65536
    s_mov_b32 s47, 0x00020000
    v_lshrrev_b32 v12, 2, v10
    v_and_b32 v13, 3, v10
    v_lshl_add_u32 v13, v13, 3, s10
    v_and_b32 v4, 1, v11
    v_lshl_add_u32 v13, v11, 10, v13
    v_lshl_add_u32 v13, v12, 7, v13
    v_lshrrev_b32 v12, 1, v12
    v_lshl_add_u32 v12, v4, 1, v12
    s_add_u32 s4, s9, 0
    s_and_b32 s4, s4, 3
    v_xor_b32 v4, s4, v12
    v_lshl_add_u32 v4, v4, 5, v13
    s_add_u32 s4, s9, 1
    s_and_b32 s4, s4, 3
    v_xor_b32 v5, s4, v12
    v_lshl_add_u32 v5, v5, 5, v13
    s_add_u32 s4, s9, 2
    s_and_b32 s4, s4, 3
    v_xor_b32 v6, s4, v12
    v_lshl_add_u32 v6, v6, 5, v13
    s_add_u32 s4, s9, 3
    s_and_b32 s4, s4, 3
    v_xor_b32 v7, s4, v12
    v_lshl_add_u32 v7, v7, 5, v13
    s_add_u32 s23, s22, 147456
    v_add_u32 v8, s23, v0
    v_mov_b32 v12, 0x7ff00000
    v_cmp_gt_u32 vcc, 3, v11
    s_mul_i32 s12, s9, 5088
    s_add_u32 s12, s12, 40960
    v_lshlrev_b32 v13, 4, v10
    v_lshl_add_u32 v13, v11, 10, v13
    v_lshrrev_b32 v14, 1, v11
    v_lshl_add_u32 v9, v14, 11, v13
    v_lshl_add_u32 v13, v14, 3, v13
    v_cndmask_b32 v1, v12, v9, vcc
    v_cndmask_b32 v19, v12, v13, vcc
    v_mbcnt_lo_u32_b32 v9, -1, 0
    v_mbcnt_hi_u32_b32 v9, -1, v9
    v_mov_b32 v86, 0
    v_mov_b32 v87, 0
    v_mov_b32 v90, 0
    v_mov_b32 v91, 0
    v_mov_b32 v94, 0
    v_mov_b32 v95, 0
    v_mov_b32 v98, 0
    v_mov_b32 v99, 0
    v_min_u32 v12, 2, v11
    v_lshl_add_u32 v12, v12, 5, s12
    s_movk_i32 s4, 80
    v_mad_u32_u24 v2, v10, s4, v12
    v_and_b32 v13, 3, v10
    v_cmp_eq_u32 vcc, 1, v13
    v_lshrrev_b32 v13, 2, v10
    v_add_u32 v13, 16, v13
    v_cndmask_b32 v13, 20, v13, vcc
    v_mad_u32_u24 v3, v13, s4, v12
    s_lshl_b32 s13, s9, 14
    s_lshl_b32 s4, s6, 3
    s_add_u32 s4, s4, s9
    s_mul_i32 s4, s4, 10240
    s_add_u32 s56, s4, 0
    s_add_u32 s58, s4, 5120
    s_add_u32 s57, s4, 40960
    s_add_u32 s59, s4, 46080
    s_mov_b32 s64, -1
    s_movk_i32 s65, 0x3ff
    s_mul_i32 s14, s9, 204800
    v_lshrrev_b32 v25, 3, v9
    v_and_b32 v24, 7, v9
    v_and_b32 v26, 2, v25
    v_xor_b32 v24, v24, v26
    s_lshl_b32 s4, s7, 7
    v_lshl_add_u32 v24, v24, 4, s4
    s_movk_i32 s5, 1280
    v_lshrrev_b32 v20, 2, v25
    v_mad_u32_u24 v20, v20, 16, v25
    v_mad_u32_u24 v20, v20, s5, v24
    v_xor_b32 v21, 64, v20
    v_mul_u32_u24 v13, 20, v25
    v_mad_u32_u24 v13, v13, s5, v24
    v_xor_b32 v14, 64, v13
    s_lshl_b32 s4, s6, 6
    v_add_u32 v12, s4, v10
    v_mul_u32_u24 v12, 1280, v12
    v_lshl_add_u32 v12, v11, 3, v12
    s_lshl_b32 s4, s7, 2
    s_add_u32 s4, s4, s9
    s_lshl_b32 s4, s4, 5
    v_add_u32 v12, s4, v12
    v_mov_b32 v10, 61312
    v_mov_b32 v11, 1
p2_Q_fa:
    ds_read_b32 v9, v10 offset:8
    s_waitcnt lgkmcnt(0)
    v_readfirstlane_b32 s4, v9
    s_bitcmp0_b32 s4, 2
    s_cbranch_scc1 p2_Q_fa
    ds_read_b64_tr_b16 v[116:117], v4 offset:0
    ds_read_b64_tr_b16 v[118:119], v4 offset:512
    ds_read_b64_tr_b16 v[120:121], v5 offset:0
    ds_read_b64_tr_b16 v[122:123], v5 offset:512
    ds_read_b64_tr_b16 v[124:125], v6 offset:0
    ds_read_b64_tr_b16 v[126:127], v6 offset:512
    ds_read_b64_tr_b16 v[128:129], v7 offset:0
    ds_read_b64_tr_b16 v[130:131], v7 offset:512
    ds_read_b128 v[132:135], v8 offset:0
    ds_read_b64_tr_b16 v[136:137], v4 offset:16384
    ds_read_b64_tr_b16 v[138:139], v4 offset:16896
    ds_read_b64_tr_b16 v[140:141], v5 offset:16384
    ds_read_b64_tr_b16 v[142:143], v5 offset:16896
    ds_read_b64_tr_b16 v[144:145], v6 offset:16384
    ds_read_b64_tr_b16 v[146:147], v6 offset:16896
    ds_read_b64_tr_b16 v[148:149], v7 offset:16384
    ds_read_b64_tr_b16 v[150:151], v7 offset:16896
    ds_read_b128 v[152:155], v8 offset:4096
    s_waitcnt lgkmcnt(9)
    s_add_u32 m0, s10, 0
    s_add_u32 s5, s14, 102400
    buffer_load_dwordx4 v20, s[36:39], s5 offen lds
    s_add_u32 m0, s10, 1024
    s_add_u32 s5, s14, 107520
    buffer_load_dwordx4 v21, s[36:39], s5 offen lds
    s_add_u32 m0, s10, 2048
    s_add_u32 s5, s14, 112640
    buffer_load_dwordx4 v20, s[36:39], s5 offen lds
    s_add_u32 m0, s10, 3072
    s_add_u32 s5, s14, 117760
    buffer_load_dwordx4 v21, s[36:39], s5 offen lds
    s_add_u32 m0, s23, 0
    s_add_u32 s5, s77, 2048
    buffer_load_dwordx4 v0, s[84:87], s5 offen sc1 lds
    s_waitcnt lgkmcnt(0)
    s_add_u32 m0, s10, 16384
    s_add_u32 s5, s14, 153600
    buffer_load_dwordx4 v20, s[36:39], s5 offen lds
    s_add_u32 m0, s10, 17408
    s_add_u32 s5, s14, 158720
    buffer_load_dwordx4 v21, s[36:39], s5 offen lds
    s_add_u32 m0, s10, 18432
    s_add_u32 s5, s14, 163840
    buffer_load_dwordx4 v20, s[36:39], s5 offen lds
    s_add_u32 m0, s10, 19456
    s_add_u32 s5, s14, 168960
    buffer_load_dwordx4 v21, s[36:39], s5 offen lds
    s_add_u32 m0, s23, 4096
    s_add_u32 s5, s77, 3072
    buffer_load_dwordx4 v0, s[84:87], s5 offen sc1 lds
    s_cmp_eq_u32 s79, 0
    s_cbranch_scc1 p2_Q_w
    v_mov_b32 v24, 0
    v_mov_b32 v26, 2
    s_mov_b64 exec, 1
    s_cmp_gt_u32 s4, 4
    s_cbranch_scc1 p2_pq_end
    s_cmp_lg_u32 s88, 0
    s_cbranch_scc1 p2_pq_go
    s_add_u32 s68, s34, 11419648
    s_addc_u32 s69, s35, 0
    s_and_b32 s69, s69, 0xffff
    s_mov_b32 s70, 524288
    s_mov_b32 s71, 0x00020000
    s_and_b32 s5, s3, 7
    s_and_b32 s4, s7, 0
    s_lshl_b32 s4, s4, 4
    s_add_u32 s5, s5, s4
    s_add_u32 s5, s5, 8
    s_mul_i32 s5, s5, 4096
    s_movk_i32 s78, 320
    s_mov_b32 s79, 15
p2_pq:
    s_sub_u32 s78, s78, 1
    s_cbranch_scc1 p2_pq_end
    s_and_b32 s4, s78, s79
    s_cbranch_scc0 p2_pq_f
    buffer_load_dword v25, v24, s[68:71], s5 offen sc1
    s_waitcnt vmcnt(0)
    v_readfirstlane_b32 s4, v25
    s_cmp_eq_u32 s4, 68
    s_cbranch_scc1 p2_pq_go
    s_sleep 8
    s_branch p2_pq
p2_pq_f:
    buffer_load_dword v25, v24, s[80:83], 0 offen offset:132 sc1
    s_mov_b32 s79, 3
    s_waitcnt vmcnt(0)
    v_readfirstlane_b32 s4, v25
    s_cmp_lg_u32 s4, 256
    s_cbranch_scc1 p2_pq
p2_pq_go:
    v_mov_b32 v26, 1
p2_pq_end:
    ds_write_b32 v10, v26 offset:20
    s_mov_b64 exec, -1
p2_Q_w:
p2_Q_go:
    ds_read_b32 v9, v10 offset:20
    s_waitcnt lgkmcnt(0)
    v_readfirstlane_b32 s4, v9
    s_cmp_lt_u32 s4, 1
    s_cbranch_scc1 p2_Q_go
    s_cmp_lg_u32 s4, 1
    s_cbranch_scc1 p2_Q_abort
    v_mov_b32 v9, v19
    s_add_u32 m0, s12, 0
    s_add_u32 s4, s13, 0
    buffer_load_dwordx4 v0, s[44:47], s4 offen sc1 lds
    s_mov_b64 exec, s[64:65]
    buffer_load_dwordx4 v0, s[44:47], s4 offen offset:1024 sc1 lds
    s_mov_b64 exec, -1
    buffer_load_dwordx4 v[192:195], v1, s[40:43], s56 offen offset:0 sc1
    buffer_load_dwordx4 v[196:199], v9, s[40:43], s56 offen offset:2048 sc1
    buffer_load_dwordx4 v[200:203], v1, s[40:43], s57 offen offset:0 sc1
    buffer_load_dwordx4 v[204:207], v9, s[40:43], s57 offen offset:2048 sc1
    s_add_u32 m0, s12, 1696
    s_add_u32 s4, s13, 2048
    buffer_load_dwordx4 v0, s[44:47], s4 offen sc1 lds
    s_mov_b64 exec, s[64:65]
    buffer_load_dwordx4 v0, s[44:47], s4 offen offset:1024 sc1 lds
    s_mov_b64 exec, -1
    buffer_load_dwordx4 v[176:179], v1, s[40:43], s56 offen offset:256 sc1
    buffer_load_dwordx4 v[180:183], v9, s[40:43], s56 offen offset:2304 sc1
    buffer_load_dwordx4 v[184:187], v1, s[40:43], s57 offen offset:256 sc1
    buffer_load_dwordx4 v[188:191], v9, s[40:43], s57 offen offset:2304 sc1
    s_add_u32 m0, s12, 3392
    s_add_u32 s4, s13, 4096
    buffer_load_dwordx4 v0, s[44:47], s4 offen sc1 lds
    s_mov_b64 exec, s[64:65]
    buffer_load_dwordx4 v0, s[44:47], s4 offen offset:1024 sc1 lds
    s_mov_b64 exec, -1
    buffer_load_dwordx4 v[208:211], v1, s[40:43], s56 offen offset:512 sc1
    buffer_load_dwordx4 v[212:215], v9, s[40:43], s56 offen offset:2560 sc1
    buffer_load_dwordx4 v[216:219], v1, s[40:43], s57 offen offset:512 sc1
    buffer_load_dwordx4 v[220:223], v9, s[40:43], s57 offen offset:2560 sc1
    buffer_load_dwordx4 v[20:23], v1, s[40:43], s56 offen offset:768 sc1
    buffer_load_dwordx4 v[24:27], v9, s[40:43], s56 offen offset:2816 sc1
    buffer_load_dwordx4 v[28:31], v1, s[40:43], s57 offen offset:768 sc1
    buffer_load_dwordx4 v[32:35], v9, s[40:43], s57 offen offset:2816 sc1
    s_waitcnt vmcnt(20)
    ds_read_b128 v[100:103], v2 offset:0
    ds_read_b128 v[104:107], v2 offset:16
    ds_read_b128 v[108:111], v3 offset:0
    ds_read_b128 v[112:115], v3 offset:16
    s_waitcnt lgkmcnt(0)
    v_cvt_pk_bf16_f32 v84, v100, v101
    v_cvt_pk_bf16_f32 v85, v102, v103
    v_cvt_pk_bf16_f32 v88, v108, v109
    v_cvt_pk_bf16_f32 v89, v110, v111
    s_mov_b32 exec_hi, 0
    v_cvt_pk_bf16_f32 v86, v104, v105
    v_cvt_pk_bf16_f32 v87, v106, v107
    v_cvt_pk_bf16_f32 v90, v112, v113
    v_cvt_pk_bf16_f32 v91, v114, v115
    s_mov_b32 exec_hi, -1
    s_add_u32 m0, s12, 0
    s_add_u32 s4, s13, 6144
    buffer_load_dwordx4 v0, s[44:47], s4 offen sc1 lds
    s_mov_b64 exec, s[64:65]
    buffer_load_dwordx4 v0, s[44:47], s4 offen offset:1024 sc1 lds
    s_mov_b64 exec, -1
    s_waitcnt vmcnt(16)
    ds_read_b128 v[100:103], v2 offset:1696
    ds_read_b128 v[104:107], v2 offset:1712
    ds_read_b128 v[108:111], v3 offset:1696
    ds_read_b128 v[112:115], v3 offset:1712
    v_mfma_f32_16x16x32_bf16 v[56:59], v[88:91], v[192:195], 0
    v_mfma_f32_16x16x32_bf16 v[52:55], v[84:87], v[192:195], 0
    v_mfma_f32_16x16x32_bf16 v[64:67], v[88:91], v[196:199], 0
    v_mfma_f32_16x16x32_bf16 v[60:63], v[84:87], v[196:199], 0
    v_mfma_f32_16x16x32_bf16 v[72:75], v[88:91], v[200:203], 0
    v_mfma_f32_16x16x32_bf16 v[68:71], v[84:87], v[200:203], 0
    v_mfma_f32_16x16x32_bf16 v[80:83], v[88:91], v[204:207], 0
    v_mfma_f32_16x16x32_bf16 v[76:79], v[84:87], v[204:207], 0
    s_waitcnt lgkmcnt(0)
    v_cvt_pk_bf16_f32 v92, v100, v101
    v_cvt_pk_bf16_f32 v93, v102, v103
    v_cvt_pk_bf16_f32 v96, v108, v109
    v_cvt_pk_bf16_f32 v97, v110, v111
    s_mov_b32 exec_hi, 0
    v_cvt_pk_bf16_f32 v94, v104, v105
    v_cvt_pk_bf16_f32 v95, v106, v107
    v_cvt_pk_bf16_f32 v98, v112, v113
    v_cvt_pk_bf16_f32 v99, v114, v115
    s_mov_b32 exec_hi, -1
    s_add_u32 m0, s12, 1696
    s_add_u32 s4, s13, 8192
    buffer_load_dwordx4 v0, s[44:47], s4 offen sc1 lds
    s_mov_b64 exec, s[64:65]
    buffer_load_dwordx4 v0, s[44:47], s4 offen offset:1024 sc1 lds
    s_mov_b64 exec, -1
    s_waitcnt vmcnt(12)
    ds_read_b128 v[100:103], v2 offset:3392
    ds_read_b128 v[104:107], v2 offset:3408
    ds_read_b128 v[108:111], v3 offset:3392
    ds_read_b128 v[112:115], v3 offset:3408
    v_add_f32 v56, 0x358637bd, v56
    v_add_f32 v64, 0x358637bd, v64
    v_add_f32 v72, 0x358637bd, v72
    v_add_f32 v80, 0x358637bd, v80
    v_rcp_f32 v56, v56
    v_rcp_f32 v64, v64
    v_rcp_f32 v72, v72
    v_rcp_f32 v80, v80
    buffer_load_dwordx4 v[224:227], v1, s[40:43], s58 offen offset:0 sc1
    v_mul_f32 v52, v52, v56
    v_mul_f32 v53, v53, v56
    v_mul_f32 v54, v54, v56
    v_mul_f32 v55, v55, v56
    v_mul_f32 v16, v57, v56
    v_cvt_pk_bf16_f32 v192, v52, v53
    v_cvt_pk_bf16_f32 v193, v54, v55
    v_mfma_f32_16x16x32_bf16 v[56:59], v[96:99], v[176:179], 0
    v_mfma_f32_16x16x32_bf16 v[52:55], v[92:95], v[176:179], 0
    buffer_load_dwordx4 v[228:231], v9, s[40:43], s58 offen offset:2048 sc1
    v_mul_f32 v60, v60, v64
    v_mul_f32 v61, v61, v64
    v_mul_f32 v62, v62, v64
    v_mul_f32 v63, v63, v64
    v_mul_f32 v17, v65, v64
    v_cvt_pk_bf16_f32 v196, v60, v61
    v_cvt_pk_bf16_f32 v197, v62, v63
    v_mfma_f32_16x16x32_bf16 v[64:67], v[96:99], v[180:183], 0
    v_mfma_f32_16x16x32_bf16 v[60:63], v[92:95], v[180:183], 0
    buffer_load_dwordx4 v[232:235], v1, s[40:43], s59 offen offset:0 sc1
    v_mul_f32 v68, v68, v72
    v_mul_f32 v69, v69, v72
    v_mul_f32 v70, v70, v72
    v_mul_f32 v71, v71, v72
    v_mul_f32 v18, v73, v72
    v_cvt_pk_bf16_f32 v200, v68, v69
    v_cvt_pk_bf16_f32 v201, v70, v71
    v_mfma_f32_16x16x32_bf16 v[72:75], v[96:99], v[184:187], 0
    v_mfma_f32_16x16x32_bf16 v[68:71], v[92:95], v[184:187], 0
    buffer_load_dwordx4 v[236:239], v9, s[40:43], s59 offen offset:2048 sc1
    v_mul_f32 v76, v76, v80
    v_mul_f32 v77, v77, v80
    v_mul_f32 v78, v78, v80
    v_mul_f32 v79, v79, v80
    v_mul_f32 v19, v81, v80
    v_cvt_pk_bf16_f32 v204, v76, v77
    v_cvt_pk_bf16_f32 v205, v78, v79
    v_mfma_f32_16x16x32_bf16 v[80:83], v[96:99], v[188:191], 0
    v_mfma_f32_16x16x32_bf16 v[76:79], v[92:95], v[188:191], 0
    s_waitcnt lgkmcnt(0)
    v_cvt_pk_bf16_f32 v84, v100, v101
    v_cvt_pk_bf16_f32 v85, v102, v103
    v_cvt_pk_bf16_f32 v88, v108, v109
    v_cvt_pk_bf16_f32 v89, v110, v111
    s_mov_b32 exec_hi, 0
    v_cvt_pk_bf16_f32 v86, v104, v105
    v_cvt_pk_bf16_f32 v87, v106, v107
    v_cvt_pk_bf16_f32 v90, v112, v113
    v_cvt_pk_bf16_f32 v91, v114, v115
    s_mov_b32 exec_hi, -1
    s_add_u32 m0, s12, 3392
    s_add_u32 s4, s13, 10240
    buffer_load_dwordx4 v0, s[44:47], s4 offen sc1 lds
    s_mov_b64 exec, s[64:65]
    buffer_load_dwordx4 v0, s[44:47], s4 offen offset:1024 sc1 lds
    s_mov_b64 exec, -1
    s_waitcnt vmcnt(8)
    ds_read_b128 v[100:103], v2 offset:0
    ds_read_b128 v[104:107], v2 offset:16
    ds_read_b128 v[108:111], v3 offset:0
    ds_read_b128 v[112:115], v3 offset:16
    v_add_f32 v56, 0x358637bd, v56
    v_add_f32 v64, 0x358637bd, v64
    v_add_f32 v72, 0x358637bd, v72
    v_add_f32 v80, 0x358637bd, v80
    v_rcp_f32 v56, v56
    v_rcp_f32 v64, v64
    v_rcp_f32 v72, v72
    v_rcp_f32 v80, v80
    buffer_load_dwordx4 v[36:39], v1, s[40:43], s58 offen offset:256 sc1
    v_mul_f32 v52, v52, v56
    v_mul_f32 v53, v53, v56
    v_mul_f32 v54, v54, v56
    v_mul_f32 v55, v55, v56
    v_mul_f32 v57, v57, v56
    v_cvt_pk_bf16_f32 v194, v52, v53
    v_cvt_pk_bf16_f32 v195, v54, v55
    v_cvt_pk_bf16_f32 v176, v16, v57
    v_mfma_f32_16x16x32_bf16 v[56:59], v[88:91], v[208:211], 0
    v_mfma_f32_16x16x32_bf16 v[52:55], v[84:87], v[208:211], 0
    buffer_load_dwordx4 v[40:43], v9, s[40:43], s58 offen offset:2304 sc1
    v_mul_f32 v60, v60, v64
    v_mul_f32 v61, v61, v64
    v_mul_f32 v62, v62, v64
    v_mul_f32 v63, v63, v64
    v_mul_f32 v65, v65, v64
    v_cvt_pk_bf16_f32 v198, v60, v61
    v_cvt_pk_bf16_f32 v199, v62, v63
    v_cvt_pk_bf16_f32 v180, v17, v65
    v_mfma_f32_16x16x32_bf16 v[64:67], v[88:91], v[212:215], 0
    v_mfma_f32_16x16x32_bf16 v[60:63], v[84:87], v[212:215], 0
    buffer_load_dwordx4 v[44:47], v1, s[40:43], s59 offen offset:256 sc1
    v_mul_f32 v68, v68, v72
    v_mul_f32 v69, v69, v72
    v_mul_f32 v70, v70, v72
    v_mul_f32 v71, v71, v72
    v_mul_f32 v73, v73, v72
    v_cvt_pk_bf16_f32 v202, v68, v69
    v_cvt_pk_bf16_f32 v203, v70, v71
    v_cvt_pk_bf16_f32 v184, v18, v73
    v_mfma_f32_16x16x32_bf16 v[72:75], v[88:91], v[216:219], 0
    v_mfma_f32_16x16x32_bf16 v[68:71], v[84:87], v[216:219], 0
    buffer_load_dwordx4 v[48:51], v9, s[40:43], s59 offen offset:2304 sc1
    v_mul_f32 v76, v76, v80
    v_mul_f32 v77, v77, v80
    v_mul_f32 v78, v78, v80
    v_mul_f32 v79, v79, v80
    v_mul_f32 v81, v81, v80
    v_cvt_pk_bf16_f32 v206, v76, v77
    v_cvt_pk_bf16_f32 v207, v78, v79
    v_cvt_pk_bf16_f32 v188, v19, v81
    v_mfma_f32_16x16x32_bf16 v[80:83], v[88:91], v[220:223], 0
    v_mfma_f32_16x16x32_bf16 v[76:79], v[84:87], v[220:223], 0
    s_waitcnt lgkmcnt(0)
    v_cvt_pk_bf16_f32 v92, v100, v101
    v_cvt_pk_bf16_f32 v93, v102, v103
    v_cvt_pk_bf16_f32 v96, v108, v109
    v_cvt_pk_bf16_f32 v97, v110, v111
    s_mov_b32 exec_hi, 0
    v_cvt_pk_bf16_f32 v94, v104, v105
    v_cvt_pk_bf16_f32 v95, v106, v107
    v_cvt_pk_bf16_f32 v98, v112, v113
    v_cvt_pk_bf16_f32 v99, v114, v115
    s_mov_b32 exec_hi, -1
    s_add_u32 m0, s12, 0
    s_add_u32 s4, s13, 12288
    buffer_load_dwordx4 v0, s[44:47], s4 offen sc1 lds
    s_mov_b64 exec, s[64:65]
    buffer_load_dwordx4 v0, s[44:47], s4 offen offset:1024 sc1 lds
    s_mov_b64 exec, -1
    s_waitcnt vmcnt(12)
    ds_read_b128 v[100:103], v2 offset:1696
    ds_read_b128 v[104:107], v2 offset:1712
    ds_read_b128 v[108:111], v3 offset:1696
    ds_read_b128 v[112:115], v3 offset:1712
    v_add_f32 v56, 0x358637bd, v56
    v_add_f32 v64, 0x358637bd, v64
    v_add_f32 v72, 0x358637bd, v72
    v_add_f32 v80, 0x358637bd, v80
    v_rcp_f32 v56, v56
    v_rcp_f32 v64, v64
    v_rcp_f32 v72, v72
    v_rcp_f32 v80, v80
    buffer_load_dwordx4 v[240:243], v1, s[40:43], s58 offen offset:512 sc1
    v_mul_f32 v52, v52, v56
    v_mul_f32 v53, v53, v56
    v_mul_f32 v54, v54, v56
    v_mul_f32 v55, v55, v56
    v_mul_f32 v16, v57, v56
    v_cvt_pk_bf16_f32 v208, v52, v53
    v_cvt_pk_bf16_f32 v209, v54, v55
    v_mfma_f32_16x16x32_bf16 v[56:59], v[96:99], v[20:23], 0
    v_mfma_f32_16x16x32_bf16 v[52:55], v[92:95], v[20:23], 0
    buffer_load_dwordx4 v[244:247], v9, s[40:43], s58 offen offset:2560 sc1
    v_mul_f32 v60, v60, v64
    v_mul_f32 v61, v61, v64
    v_mul_f32 v62, v62, v64
    v_mul_f32 v63, v63, v64
    v_mul_f32 v17, v65, v64
    v_cvt_pk_bf16_f32 v212, v60, v61
    v_cvt_pk_bf16_f32 v213, v62, v63
    v_mfma_f32_16x16x32_bf16 v[64:67], v[96:99], v[24:27], 0
    v_mfma_f32_16x16x32_bf16 v[60:63], v[92:95], v[24:27], 0
    buffer_load_dwordx4 v[248:251], v1, s[40:43], s59 offen offset:512 sc1
    v_mul_f32 v68, v68, v72
    v_mul_f32 v69, v69, v72
    v_mul_f32 v70, v70, v72
    v_mul_f32 v71, v71, v72
    v_mul_f32 v18, v73, v72
    v_cvt_pk_bf16_f32 v216, v68, v69
    v_cvt_pk_bf16_f32 v217, v70, v71
    v_mfma_f32_16x16x32_bf16 v[72:75], v[96:99], v[28:31], 0
    v_mfma_f32_16x16x32_bf16 v[68:71], v[92:95], v[28:31], 0
    buffer_load_dwordx4 v[252:255], v9, s[40:43], s59 offen offset:2560 sc1
    v_mul_f32 v76, v76, v80
    v_mul_f32 v77, v77, v80
    v_mul_f32 v78, v78, v80
    v_mul_f32 v79, v79, v80
    v_mul_f32 v19, v81, v80
    v_cvt_pk_bf16_f32 v220, v76, v77
    v_cvt_pk_bf16_f32 v221, v78, v79
    v_mfma_f32_16x16x32_bf16 v[80:83], v[96:99], v[32:35], 0
    v_mfma_f32_16x16x32_bf16 v[76:79], v[92:95], v[32:35], 0
    s_waitcnt lgkmcnt(0)
    v_cvt_pk_bf16_f32 v84, v100, v101
    v_cvt_pk_bf16_f32 v85, v102, v103
    v_cvt_pk_bf16_f32 v88, v108, v109
    v_cvt_pk_bf16_f32 v89, v110, v111
    s_mov_b32 exec_hi, 0
    v_cvt_pk_bf16_f32 v86, v104, v105
    v_cvt_pk_bf16_f32 v87, v106, v107
    v_cvt_pk_bf16_f32 v90, v112, v113
    v_cvt_pk_bf16_f32 v91, v114, v115
    s_mov_b32 exec_hi, -1
    s_add_u32 m0, s12, 1696
    s_add_u32 s4, s13, 14336
    buffer_load_dwordx4 v0, s[44:47], s4 offen sc1 lds
    s_mov_b64 exec, s[64:65]
    buffer_load_dwordx4 v0, s[44:47], s4 offen offset:1024 sc1 lds
    s_mov_b64 exec, -1
    s_waitcnt vmcnt(12)
    ds_read_b128 v[100:103], v2 offset:3392
    ds_read_b128 v[104:107], v2 offset:3408
    ds_read_b128 v[108:111], v3 offset:3392
    ds_read_b128 v[112:115], v3 offset:3408
    ds_read_b64_tr_b16 v[156:157], v4 offset:0
    ds_read_b64_tr_b16 v[158:159], v4 offset:512
    ds_read_b64_tr_b16 v[160:161], v5 offset:0
    ds_read_b64_tr_b16 v[162:163], v5 offset:512
    ds_read_b64_tr_b16 v[164:165], v6 offset:0
    ds_read_b64_tr_b16 v[166:167], v6 offset:512
    ds_read_b64_tr_b16 v[168:169], v7 offset:0
    ds_read_b64_tr_b16 v[170:171], v7 offset:512
    ds_read_b128 v[172:175], v8 offset:0
    v_add_f32 v56, 0x358637bd, v56
    v_add_f32 v64, 0x358637bd, v64
    v_add_f32 v72, 0x358637bd, v72
    v_add_f32 v80, 0x358637bd, v80
    v_rcp_f32 v56, v56
    v_rcp_f32 v64, v64
    v_rcp_f32 v72, v72
    v_rcp_f32 v80, v80
    buffer_load_dwordx4 v[20:23], v1, s[40:43], s58 offen offset:768 sc1
    v_mul_f32 v52, v52, v56
    v_mul_f32 v53, v53, v56
    v_mul_f32 v54, v54, v56
    v_mul_f32 v55, v55, v56
    v_mul_f32 v57, v57, v56
    v_cvt_pk_bf16_f32 v210, v52, v53
    v_cvt_pk_bf16_f32 v211, v54, v55
    v_cvt_pk_bf16_f32 v177, v16, v57
    v_mfma_f32_16x16x32_bf16 v[56:59], v[88:91], v[224:227], 0
    v_mfma_f32_16x16x32_bf16 v[52:55], v[84:87], v[224:227], 0
    buffer_load_dwordx4 v[24:27], v9, s[40:43], s58 offen offset:2816 sc1
    v_mul_f32 v60, v60, v64
    v_mul_f32 v61, v61, v64
    v_mul_f32 v62, v62, v64
    v_mul_f32 v63, v63, v64
    v_mul_f32 v65, v65, v64
    v_cvt_pk_bf16_f32 v214, v60, v61
    v_cvt_pk_bf16_f32 v215, v62, v63
    v_cvt_pk_bf16_f32 v181, v17, v65
    v_mfma_f32_16x16x32_bf16 v[64:67], v[88:91], v[228:231], 0
    v_mfma_f32_16x16x32_bf16 v[60:63], v[84:87], v[228:231], 0
    buffer_load_dwordx4 v[28:31], v1, s[40:43], s59 offen offset:768 sc1
    v_mul_f32 v68, v68, v72
    v_mul_f32 v69, v69, v72
    v_mul_f32 v70, v70, v72
    v_mul_f32 v71, v71, v72
    v_mul_f32 v73, v73, v72
    v_cvt_pk_bf16_f32 v218, v68, v69
    v_cvt_pk_bf16_f32 v219, v70, v71
    v_cvt_pk_bf16_f32 v185, v18, v73
    v_mfma_f32_16x16x32_bf16 v[72:75], v[88:91], v[232:235], 0
    v_mfma_f32_16x16x32_bf16 v[68:71], v[84:87], v[232:235], 0
    buffer_load_dwordx4 v[32:35], v9, s[40:43], s59 offen offset:2816 sc1
    v_mul_f32 v76, v76, v80
    v_mul_f32 v77, v77, v80
    v_mul_f32 v78, v78, v80
    v_mul_f32 v79, v79, v80
    v_mul_f32 v81, v81, v80
    v_cvt_pk_bf16_f32 v222, v76, v77
    v_cvt_pk_bf16_f32 v223, v78, v79
    v_cvt_pk_bf16_f32 v189, v19, v81
    v_mfma_f32_16x16x32_bf16 v[80:83], v[88:91], v[236:239], 0
    v_mfma_f32_16x16x32_bf16 v[76:79], v[84:87], v[236:239], 0
    s_waitcnt lgkmcnt(0)
    v_cvt_pk_bf16_f32 v92, v100, v101
    v_cvt_pk_bf16_f32 v93, v102, v103
    v_cvt_pk_bf16_f32 v96, v108, v109
    v_cvt_pk_bf16_f32 v97, v110, v111
    s_mov_b32 exec_hi, 0
    v_cvt_pk_bf16_f32 v94, v104, v105
    v_cvt_pk_bf16_f32 v95, v106, v107
    v_cvt_pk_bf16_f32 v98, v112, v113
    v_cvt_pk_bf16_f32 v99, v114, v115
    s_mov_b32 exec_hi, -1
    s_add_u32 m0, s10, 0
    s_add_u32 s5, s14, 20480
    buffer_load_dwordx4 v13, s[36:39], s5 offen lds
    s_add_u32 m0, s10, 1024
    s_add_u32 s5, s14, 21760
    buffer_load_dwordx4 v14, s[36:39], s5 offen lds
    s_add_u32 m0, s10, 2048
    s_add_u32 s5, s14, 23040
    buffer_load_dwordx4 v13, s[36:39], s5 offen lds
    s_add_u32 m0, s10, 3072
    s_add_u32 s5, s14, 24320
    buffer_load_dwordx4 v14, s[36:39], s5 offen lds
    s_add_u32 m0, s23, 0
    s_add_u32 s5, s77, 4096
    buffer_load_dwordx4 v0, s[84:87], s5 offen sc1 lds
    s_waitcnt vmcnt(15)
    ds_read_b128 v[100:103], v2 offset:0
    ds_read_b128 v[104:107], v2 offset:16
    ds_read_b128 v[108:111], v3 offset:0
    ds_read_b128 v[112:115], v3 offset:16
    v_add_f32 v56, 0x358637bd, v56
    v_add_f32 v64, 0x358637bd, v64
    v_add_f32 v72, 0x358637bd, v72
    v_add_f32 v80, 0x358637bd, v80
    v_rcp_f32 v56, v56
    v_rcp_f32 v64, v64
    v_rcp_f32 v72, v72
    v_rcp_f32 v80, v80
    s_nop 0
    v_mul_f32 v52, v52, v56
    v_mul_f32 v53, v53, v56
    v_mul_f32 v54, v54, v56
    v_mul_f32 v55, v55, v56
    v_mul_f32 v16, v57, v56
    v_cvt_pk_bf16_f32 v224, v52, v53
    v_cvt_pk_bf16_f32 v225, v54, v55
    v_mfma_f32_16x16x32_bf16 v[56:59], v[96:99], v[36:39], 0
    v_mfma_f32_16x16x32_bf16 v[52:55], v[92:95], v[36:39], 0
    s_nop 0
    v_mul_f32 v60, v60, v64
    v_mul_f32 v61, v61, v64
    v_mul_f32 v62, v62, v64
    v_mul_f32 v63, v63, v64
    v_mul_f32 v17, v65, v64
    v_cvt_pk_bf16_f32 v228, v60, v61
    v_cvt_pk_bf16_f32 v229, v62, v63
    v_mfma_f32_16x16x32_bf16 v[64:67], v[96:99], v[40:43], 0
    v_mfma_f32_16x16x32_bf16 v[60:63], v[92:95], v[40:43], 0
    s_nop 0
    v_mul_f32 v68, v68, v72
    v_mul_f32 v69, v69, v72
    v_mul_f32 v70, v70, v72
    v_mul_f32 v71, v71, v72
    v_mul_f32 v18, v73, v72
    v_cvt_pk_bf16_f32 v232, v68, v69
    v_cvt_pk_bf16_f32 v233, v70, v71
    v_mfma_f32_16x16x32_bf16 v[72:75], v[96:99], v[44:47], 0
    v_mfma_f32_16x16x32_bf16 v[68:71], v[92:95], v[44:47], 0
    s_nop 0
    v_mul_f32 v76, v76, v80
    v_mul_f32 v77, v77, v80
    v_mul_f32 v78, v78, v80
    v_mul_f32 v79, v79, v80
    v_mul_f32 v19, v81, v80
    v_cvt_pk_bf16_f32 v236, v76, v77
    v_cvt_pk_bf16_f32 v237, v78, v79
    v_mfma_f32_16x16x32_bf16 v[80:83], v[96:99], v[48:51], 0
    v_mfma_f32_16x16x32_bf16 v[76:79], v[92:95], v[48:51], 0
    s_waitcnt lgkmcnt(0)
    v_cvt_pk_bf16_f32 v84, v100, v101
    v_cvt_pk_bf16_f32 v85, v102, v103
    v_cvt_pk_bf16_f32 v88, v108, v109
    v_cvt_pk_bf16_f32 v89, v110, v111
    s_mov_b32 exec_hi, 0
    v_cvt_pk_bf16_f32 v86, v104, v105
    v_cvt_pk_bf16_f32 v87, v106, v107
    v_cvt_pk_bf16_f32 v90, v112, v113
    v_cvt_pk_bf16_f32 v91, v114, v115
    s_mov_b32 exec_hi, -1
    s_cmp_lg_u32 s8, 0
    s_cbranch_scc1 p2_Q_nd
p2_Q_gp:
    ds_read_b32 v9, v10 offset:16
    s_waitcnt lgkmcnt(0)
    v_readfirstlane_b32 s4, v9
    s_cmp_lt_u32 s4, 1
    s_cbranch_scc1 p2_Q_gp
    s_cmp_lg_u32 s4, 1
    s_cbranch_scc1 p2_Q_nd
    s_lshl_b32 s4, 1, s3
    v_mov_b32 v13, s4
    v_mov_b32 v9, 0
    s_lshr_b32 s4, s3, 5
    s_lshl_b32 s4, s4, 2
    s_mov_b64 exec, 1
    buffer_atomic_or v13, v9, s[80:83], s4 offen offset:160 sc1
    s_mov_b64 exec, -1
p2_Q_nd:
    s_waitcnt vmcnt(9)
    ds_read_b128 v[100:103], v2 offset:1696
    ds_read_b128 v[104:107], v2 offset:1712
    ds_read_b128 v[108:111], v3 offset:1696
    ds_read_b128 v[112:115], v3 offset:1712
    v_add_f32 v56, 0x358637bd, v56
    v_add_f32 v64, 0x358637bd, v64
    v_add_f32 v72, 0x358637bd, v72
    v_add_f32 v80, 0x358637bd, v80
    v_rcp_f32 v56, v56
    v_rcp_f32 v64, v64
    v_rcp_f32 v72, v72
    v_rcp_f32 v80, v80
    s_nop 0
    v_mul_f32 v52, v52, v56
    v_mul_f32 v53, v53, v56
    v_mul_f32 v54, v54, v56
    v_mul_f32 v55, v55, v56
    v_mul_f32 v57, v57, v56
    v_cvt_pk_bf16_f32 v226, v52, v53
    v_cvt_pk_bf16_f32 v227, v54, v55
    v_cvt_pk_bf16_f32 v178, v16, v57
    v_mfma_f32_16x16x32_bf16 v[56:59], v[88:91], v[240:243], 0
    v_mfma_f32_16x16x32_bf16 v[52:55], v[84:87], v[240:243], 0
    s_nop 0
    v_mul_f32 v60, v60, v64
    v_mul_f32 v61, v61, v64
    v_mul_f32 v62, v62, v64
    v_mul_f32 v63, v63, v64
    v_mul_f32 v65, v65, v64
    v_cvt_pk_bf16_f32 v230, v60, v61
    v_cvt_pk_bf16_f32 v231, v62, v63
    v_cvt_pk_bf16_f32 v182, v17, v65
    v_mfma_f32_16x16x32_bf16 v[64:67], v[88:91], v[244:247], 0
    v_mfma_f32_16x16x32_bf16 v[60:63], v[84:87], v[244:247], 0
    s_nop 0
    v_mul_f32 v68, v68, v72
    v_mul_f32 v69, v69, v72
    v_mul_f32 v70, v70, v72
    v_mul_f32 v71, v71, v72
    v_mul_f32 v73, v73, v72
    v_cvt_pk_bf16_f32 v234, v68, v69
    v_cvt_pk_bf16_f32 v235, v70, v71
    v_cvt_pk_bf16_f32 v186, v18, v73
    v_mfma_f32_16x16x32_bf16 v[72:75], v[88:91], v[248:251], 0
    v_mfma_f32_16x16x32_bf16 v[68:71], v[84:87], v[248:251], 0
    s_nop 0
    v_mul_f32 v76, v76, v80
    v_mul_f32 v77, v77, v80
    v_mul_f32 v78, v78, v80
    v_mul_f32 v79, v79, v80
    v_mul_f32 v81, v81, v80
    v_cvt_pk_bf16_f32 v238, v76, v77
    v_cvt_pk_bf16_f32 v239, v78, v79
    v_cvt_pk_bf16_f32 v190, v19, v81
    v_mfma_f32_16x16x32_bf16 v[80:83], v[88:91], v[252:255], 0
    v_mfma_f32_16x16x32_bf16 v[76:79], v[84:87], v[252:255], 0
    s_waitcnt lgkmcnt(0)
    v_cvt_pk_bf16_f32 v92, v100, v101
    v_cvt_pk_bf16_f32 v93, v102, v103
    v_cvt_pk_bf16_f32 v96, v108, v109
    v_cvt_pk_bf16_f32 v97, v110, v111
    s_mov_b32 exec_hi, 0
    v_cvt_pk_bf16_f32 v94, v104, v105
    v_cvt_pk_bf16_f32 v95, v106, v107
    v_cvt_pk_bf16_f32 v98, v112, v113
    v_cvt_pk_bf16_f32 v99, v114, v115
    s_mov_b32 exec_hi, -1
    v_add_f32 v56, 0x358637bd, v56
    v_add_f32 v64, 0x358637bd, v64
    v_add_f32 v72, 0x358637bd, v72
    v_add_f32 v80, 0x358637bd, v80
    v_rcp_f32 v56, v56
    v_rcp_f32 v64, v64
    v_rcp_f32 v72, v72
    v_rcp_f32 v80, v80
    s_nop 0
    v_mul_f32 v52, v52, v56
    v_mul_f32 v53, v53, v56
    v_mul_f32 v54, v54, v56
    v_mul_f32 v55, v55, v56
    v_mul_f32 v16, v57, v56
    v_cvt_pk_bf16_f32 v240, v52, v53
    v_cvt_pk_bf16_f32 v241, v54, v55
    s_waitcnt vmcnt(8)
    v_mfma_f32_16x16x32_bf16 v[56:59], v[96:99], v[20:23], 0
    v_mfma_f32_16x16x32_bf16 v[52:55], v[92:95], v[20:23], 0
    s_nop 0
    v_mul_f32 v60, v60, v64
    v_mul_f32 v61, v61, v64
    v_mul_f32 v62, v62, v64
    v_mul_f32 v63, v63, v64
    v_mul_f32 v17, v65, v64
    v_cvt_pk_bf16_f32 v244, v60, v61
    v_cvt_pk_bf16_f32 v245, v62, v63
    s_waitcnt vmcnt(7)
    v_mfma_f32_16x16x32_bf16 v[64:67], v[96:99], v[24:27], 0
    v_mfma_f32_16x16x32_bf16 v[60:63], v[92:95], v[24:27], 0
    s_nop 0
    v_mul_f32 v68, v68, v72
    v_mul_f32 v69, v69, v72
    v_mul_f32 v70, v70, v72
    v_mul_f32 v71, v71, v72
    v_mul_f32 v18, v73, v72
    v_cvt_pk_bf16_f32 v248, v68, v69
    v_cvt_pk_bf16_f32 v249, v70, v71
    s_waitcnt vmcnt(6)
    v_mfma_f32_16x16x32_bf16 v[72:75], v[96:99], v[28:31], 0
    v_mfma_f32_16x16x32_bf16 v[68:71], v[92:95], v[28:31], 0
    s_nop 0
    v_mul_f32 v76, v76, v80
    v_mul_f32 v77, v77, v80
    v_mul_f32 v78, v78, v80
    v_mul_f32 v79, v79, v80
    v_mul_f32 v19, v81, v80
    v_cvt_pk_bf16_f32 v252, v76, v77
    v_cvt_pk_bf16_f32 v253, v78, v79
    s_waitcnt vmcnt(5)
    v_mfma_f32_16x16x32_bf16 v[80:83], v[96:99], v[32:35], 0
    v_mfma_f32_16x16x32_bf16 v[76:79], v[92:95], v[32:35], 0
    s_nop 7
    v_add_f32 v56, 0x358637bd, v56
    v_add_f32 v64, 0x358637bd, v64
    v_add_f32 v72, 0x358637bd, v72
    v_add_f32 v80, 0x358637bd, v80
    v_rcp_f32 v56, v56
    v_rcp_f32 v64, v64
    v_rcp_f32 v72, v72
    v_rcp_f32 v80, v80
    s_nop 0
    v_mul_f32 v52, v52, v56
    v_mul_f32 v53, v53, v56
    v_mul_f32 v54, v54, v56
    v_mul_f32 v55, v55, v56
    v_mul_f32 v57, v57, v56
    v_cvt_pk_bf16_f32 v242, v52, v53
    v_cvt_pk_bf16_f32 v243, v54, v55
    v_cvt_pk_bf16_f32 v179, v16, v57
    s_nop 0
    v_mul_f32 v60, v60, v64
    v_mul_f32 v61, v61, v64
    v_mul_f32 v62, v62, v64
    v_mul_f32 v63, v63, v64
    v_mul_f32 v65, v65, v64
    v_cvt_pk_bf16_f32 v246, v60, v61
    v_cvt_pk_bf16_f32 v247, v62, v63
    v_cvt_pk_bf16_f32 v183, v17, v65
    s_nop 0
    v_mul_f32 v68, v68, v72
    v_mul_f32 v69, v69, v72
    v_mul_f32 v70, v70, v72
    v_mul_f32 v71, v71, v72
    v_mul_f32 v73, v73, v72
    v_cvt_pk_bf16_f32 v250, v68, v69
    v_cvt_pk_bf16_f32 v251, v70, v71
    v_cvt_pk_bf16_f32 v187, v18, v73
    s_nop 0
    v_mul_f32 v76, v76, v80
    v_mul_f32 v77, v77, v80
    v_mul_f32 v78, v78, v80
    v_mul_f32 v79, v79, v80
    v_mul_f32 v81, v81, v80
    v_cvt_pk_bf16_f32 v254, v76, v77
    v_cvt_pk_bf16_f32 v255, v78, v79
    v_cvt_pk_bf16_f32 v191, v19, v81
    s_mov_b32 s56, 0
    buffer_load_dwordx2 v[100:101], v12, s[48:51], s56 offen
    s_mov_b32 s57, 20480
    buffer_load_dwordx2 v[102:103], v12, s[48:51], s57 offen
    s_mov_b32 s58, 40960
    buffer_load_dwordx2 v[104:105], v12, s[48:51], s58 offen
    s_mov_b32 s59, 61440
    buffer_load_dwordx2 v[106:107], v12, s[48:51], s59 offen
    v_mfma_f32_16x16x32_bf16 v[20:23], v[116:119], v[192:195], 0
    v_mfma_f32_16x16x32_bf16 v[40:43], v[116:119], v[196:199], 0
    v_mfma_f32_16x16x32_bf16 v[60:63], v[116:119], v[200:203], 0
    v_mfma_f32_16x16x32_bf16 v[80:83], v[116:119], v[204:207], 0
    v_mfma_f32_16x16x32_bf16 v[24:27], v[120:123], v[192:195], 0
    v_mfma_f32_16x16x32_bf16 v[44:47], v[120:123], v[196:199], 0
    v_mfma_f32_16x16x32_bf16 v[64:67], v[120:123], v[200:203], 0
    v_mfma_f32_16x16x32_bf16 v[84:87], v[120:123], v[204:207], 0
    v_mfma_f32_16x16x32_bf16 v[28:31], v[124:127], v[192:195], 0
    v_mfma_f32_16x16x32_bf16 v[48:51], v[124:127], v[196:199], 0
    v_mfma_f32_16x16x32_bf16 v[68:71], v[124:127], v[200:203], 0
    v_mfma_f32_16x16x32_bf16 v[88:91], v[124:127], v[204:207], 0
    v_mfma_f32_16x16x32_bf16 v[32:35], v[128:131], v[192:195], 0
    v_mfma_f32_16x16x32_bf16 v[52:55], v[128:131], v[196:199], 0
    v_mfma_f32_16x16x32_bf16 v[72:75], v[128:131], v[200:203], 0
    v_mfma_f32_16x16x32_bf16 v[92:95], v[128:131], v[204:207], 0
    v_mfma_f32_16x16x32_bf16 v[36:39], v[132:135], v[192:195], 0
    v_mfma_f32_16x16x32_bf16 v[56:59], v[132:135], v[196:199], 0
    v_mfma_f32_16x16x32_bf16 v[76:79], v[132:135], v[200:203], 0
    v_mfma_f32_16x16x32_bf16 v[96:99], v[132:135], v[204:207], 0
    v_mfma_f32_16x16x32_bf16 v[20:23], v[136:139], v[208:211], v[20:23]
    ds_read_b64_tr_b16 v[116:117], v4 offset:16384
    v_mfma_f32_16x16x32_bf16 v[40:43], v[136:139], v[212:215], v[40:43]
    ds_read_b64_tr_b16 v[118:119], v4 offset:16896
    v_mfma_f32_16x16x32_bf16 v[60:63], v[136:139], v[216:219], v[60:63]
    ds_read_b64_tr_b16 v[120:121], v5 offset:16384
    v_mfma_f32_16x16x32_bf16 v[80:83], v[136:139], v[220:223], v[80:83]
    ds_read_b64_tr_b16 v[122:123], v5 offset:16896
    v_mfma_f32_16x16x32_bf16 v[24:27], v[140:143], v[208:211], v[24:27]
    ds_read_b64_tr_b16 v[124:125], v6 offset:16384
    v_mfma_f32_16x16x32_bf16 v[44:47], v[140:143], v[212:215], v[44:47]
    ds_read_b64_tr_b16 v[126:127], v6 offset:16896
    v_mfma_f32_16x16x32_bf16 v[64:67], v[140:143], v[216:219], v[64:67]
    ds_read_b64_tr_b16 v[128:129], v7 offset:16384
    v_mfma_f32_16x16x32_bf16 v[84:87], v[140:143], v[220:223], v[84:87]
    ds_read_b64_tr_b16 v[130:131], v7 offset:16896
    v_mfma_f32_16x16x32_bf16 v[28:31], v[144:147], v[208:211], v[28:31]
    ds_read_b128 v[132:135], v8 offset:4096
    v_mfma_f32_16x16x32_bf16 v[48:51], v[144:147], v[212:215], v[48:51]
    v_mfma_f32_16x16x32_bf16 v[68:71], v[144:147], v[216:219], v[68:71]
    v_mfma_f32_16x16x32_bf16 v[88:91], v[144:147], v[220:223], v[88:91]
    v_mfma_f32_16x16x32_bf16 v[32:35], v[148:151], v[208:211], v[32:35]
    v_mfma_f32_16x16x32_bf16 v[52:55], v[148:151], v[212:215], v[52:55]
    v_mfma_f32_16x16x32_bf16 v[72:75], v[148:151], v[216:219], v[72:75]
    v_mfma_f32_16x16x32_bf16 v[92:95], v[148:151], v[220:223], v[92:95]
    v_mfma_f32_16x16x32_bf16 v[36:39], v[152:155], v[208:211], v[36:39]
    v_mfma_f32_16x16x32_bf16 v[56:59], v[152:155], v[212:215], v[56:59]
    v_mfma_f32_16x16x32_bf16 v[76:79], v[152:155], v[216:219], v[76:79]
    v_mfma_f32_16x16x32_bf16 v[96:99], v[152:155], v[220:223], v[96:99]
    s_waitcnt vmcnt(4)
    v_mfma_f32_16x16x32_bf16 v[20:23], v[156:159], v[224:227], v[20:23]
    ds_read_b64_tr_b16 v[136:137], v4 offset:0
    v_mfma_f32_16x16x32_bf16 v[40:43], v[156:159], v[228:231], v[40:43]
    ds_read_b64_tr_b16 v[138:139], v4 offset:512
    v_mfma_f32_16x16x32_bf16 v[60:63], v[156:159], v[232:235], v[60:63]
    ds_read_b64_tr_b16 v[140:141], v5 offset:0
    v_mfma_f32_16x16x32_bf16 v[80:83], v[156:159], v[236:239], v[80:83]
    ds_read_b64_tr_b16 v[142:143], v5 offset:512
    v_mfma_f32_16x16x32_bf16 v[24:27], v[160:163], v[224:227], v[24:27]
    ds_read_b64_tr_b16 v[144:145], v6 offset:0
    v_mfma_f32_16x16x32_bf16 v[44:47], v[160:163], v[228:231], v[44:47]
    ds_read_b64_tr_b16 v[146:147], v6 offset:512
    v_mfma_f32_16x16x32_bf16 v[64:67], v[160:163], v[232:235], v[64:67]
    ds_read_b64_tr_b16 v[148:149], v7 offset:0
    v_mfma_f32_16x16x32_bf16 v[84:87], v[160:163], v[236:239], v[84:87]
    ds_read_b64_tr_b16 v[150:151], v7 offset:512
    v_mfma_f32_16x16x32_bf16 v[28:31], v[164:167], v[224:227], v[28:31]
    ds_read_b128 v[152:155], v8 offset:0
    v_mfma_f32_16x16x32_bf16 v[48:51], v[164:167], v[228:231], v[48:51]
    v_mfma_f32_16x16x32_bf16 v[68:71], v[164:167], v[232:235], v[68:71]
    v_mfma_f32_16x16x32_bf16 v[88:91], v[164:167], v[236:239], v[88:91]
    v_mfma_f32_16x16x32_bf16 v[32:35], v[168:171], v[224:227], v[32:35]
    v_mfma_f32_16x16x32_bf16 v[52:55], v[168:171], v[228:231], v[52:55]
    v_mfma_f32_16x16x32_bf16 v[72:75], v[168:171], v[232:235], v[72:75]
    v_mfma_f32_16x16x32_bf16 v[92:95], v[168:171], v[236:239], v[92:95]
    v_mfma_f32_16x16x32_bf16 v[36:39], v[172:175], v[224:227], v[36:39]
    v_mfma_f32_16x16x32_bf16 v[56:59], v[172:175], v[228:231], v[56:59]
    v_mfma_f32_16x16x32_bf16 v[76:79], v[172:175], v[232:235], v[76:79]
    v_mfma_f32_16x16x32_bf16 v[96:99], v[172:175], v[236:239], v[96:99]
    s_waitcnt lgkmcnt(9)
    v_mfma_f32_16x16x32_bf16 v[20:23], v[116:119], v[240:243], v[20:23]
    v_mfma_f32_16x16x32_bf16 v[40:43], v[116:119], v[244:247], v[40:43]
    v_mfma_f32_16x16x32_bf16 v[60:63], v[116:119], v[248:251], v[60:63]
    v_mfma_f32_16x16x32_bf16 v[80:83], v[116:119], v[252:255], v[80:83]
    v_mfma_f32_16x16x32_bf16 v[24:27], v[120:123], v[240:243], v[24:27]
    v_mfma_f32_16x16x32_bf16 v[44:47], v[120:123], v[244:247], v[44:47]
    v_mfma_f32_16x16x32_bf16 v[64:67], v[120:123], v[248:251], v[64:67]
    v_mfma_f32_16x16x32_bf16 v[84:87], v[120:123], v[252:255], v[84:87]
    v_mfma_f32_16x16x32_bf16 v[28:31], v[124:127], v[240:243], v[28:31]
    v_mfma_f32_16x16x32_bf16 v[48:51], v[124:127], v[244:247], v[48:51]
    v_mfma_f32_16x16x32_bf16 v[68:71], v[124:127], v[248:251], v[68:71]
    v_mfma_f32_16x16x32_bf16 v[88:91], v[124:127], v[252:255], v[88:91]
    v_mfma_f32_16x16x32_bf16 v[32:35], v[128:131], v[240:243], v[32:35]
    v_mfma_f32_16x16x32_bf16 v[52:55], v[128:131], v[244:247], v[52:55]
    v_mfma_f32_16x16x32_bf16 v[72:75], v[128:131], v[248:251], v[72:75]
    v_mfma_f32_16x16x32_bf16 v[92:95], v[128:131], v[252:255], v[92:95]
    v_mfma_f32_16x16x32_bf16 v[36:39], v[132:135], v[240:243], v[36:39]
    v_mfma_f32_16x16x32_bf16 v[56:59], v[132:135], v[244:247], v[56:59]
    v_mfma_f32_16x16x32_bf16 v[76:79], v[132:135], v[248:251], v[76:79]
    v_mfma_f32_16x16x32_bf16 v[96:99], v[132:135], v[252:255], v[96:99]
    s_waitcnt lgkmcnt(0)
    v_mfma_f32_16x16x32_bf16 v[20:23], v[136:139], v[176:179], v[20:23]
    v_mfma_f32_16x16x32_bf16 v[40:43], v[136:139], v[180:183], v[40:43]
    v_mfma_f32_16x16x32_bf16 v[60:63], v[136:139], v[184:187], v[60:63]
    v_mfma_f32_16x16x32_bf16 v[80:83], v[136:139], v[188:191], v[80:83]
    v_mfma_f32_16x16x32_bf16 v[24:27], v[140:143], v[176:179], v[24:27]
    v_mfma_f32_16x16x32_bf16 v[44:47], v[140:143], v[180:183], v[44:47]
    v_mfma_f32_16x16x32_bf16 v[64:67], v[140:143], v[184:187], v[64:67]
    v_mfma_f32_16x16x32_bf16 v[84:87], v[140:143], v[188:191], v[84:87]
    v_mfma_f32_16x16x32_bf16 v[28:31], v[144:147], v[176:179], v[28:31]
    v_mfma_f32_16x16x32_bf16 v[48:51], v[144:147], v[180:183], v[48:51]
    v_mfma_f32_16x16x32_bf16 v[68:71], v[144:147], v[184:187], v[68:71]
    v_mfma_f32_16x16x32_bf16 v[88:91], v[144:147], v[188:191], v[88:91]
    v_mfma_f32_16x16x32_bf16 v[32:35], v[148:151], v[176:179], v[32:35]
    v_mfma_f32_16x16x32_bf16 v[52:55], v[148:151], v[180:183], v[52:55]
    v_mfma_f32_16x16x32_bf16 v[72:75], v[148:151], v[184:187], v[72:75]
    v_mfma_f32_16x16x32_bf16 v[92:95], v[148:151], v[188:191], v[92:95]
    v_mfma_f32_16x16x32_bf16 v[36:39], v[152:155], v[176:179], v[36:39]
    v_mfma_f32_16x16x32_bf16 v[56:59], v[152:155], v[180:183], v[56:59]
    v_mfma_f32_16x16x32_bf16 v[76:79], v[152:155], v[184:187], v[76:79]
    v_mfma_f32_16x16x32_bf16 v[96:99], v[152:155], v[188:191], v[96:99]
    v_add_u32 v1, s12, v0
    v_add_u32 v2, s10, v0
    v_add_u32 v3, s11, v0
    s_lshl_b32 s4, s9, 2
    v_add_u32 v4, s4, v10
    s_sub_u32 s4, s9, 1
    s_and_b32 s4, s4, 3
    s_lshl_b32 s5, s4, 12
    v_add_u32 v5, s5, v0
    s_sub_u32 s4, s9, 2
    s_and_b32 s4, s4, 3
    s_lshl_b32 s5, s4, 12
    v_add_u32 v6, s5, v0
    s_sub_u32 s4, s9, 3
    s_and_b32 s4, s4, 3
    s_lshl_b32 s5, s4, 10
    s_add_u32 s5, s5, 147456
    v_add_u32 v7, s5, v0
    s_lshl_b32 s5, s4, 3
    s_lshr_b32 s5, 0x270f0908, s5
    s_and_b32 s5, s5, 255
    s_lshl_b32 s5, s5, 12
    v_add_u32 v13, s5, v0
    ds_write_b128 v2, v[24:27] offset:0
    ds_write_b128 v2, v[44:47] offset:1024
    ds_write_b128 v2, v[64:67] offset:2048
    ds_write_b128 v2, v[84:87] offset:3072
    ds_write_b128 v2, v[28:31] offset:16384
    ds_write_b128 v2, v[48:51] offset:17408
    ds_write_b128 v2, v[68:71] offset:18432
    ds_write_b128 v2, v[88:91] offset:19456
    ds_write_b128 v8, v[32:35] offset:0
    ds_write_b128 v8, v[52:55] offset:4096
    ds_write_b128 v1, v[36:39] offset:0
    ds_write_b128 v1, v[56:59] offset:1024
    ds_write_b128 v1, v[76:79] offset:2048
    ds_write_b128 v1, v[96:99] offset:3072
p2_Q_s0:
    ds_read_b32 v9, v4 offset:32
    s_waitcnt lgkmcnt(0)
    v_readfirstlane_b32 s4, v9
    s_cmp_lt_u32 s4, 1
    s_cbranch_scc1 p2_Q_s0
    s_cmp_gt_u32 s4, 4
    s_cbranch_scc1 p2_end
    ds_write_b128 v3, v[72:75] offset:2048
    ds_write_b128 v3, v[92:95] offset:3072
    s_mov_b64 exec, 1
    ds_add_u32 v10, v11 offset:24
    s_mov_b64 exec, -1
    s_add_u32 s4, s22, 65536
    v_add_u32 v1, s4, v0
    s_mov_b32 s60, 0xbfb8aa3b
p2_Q_s1:
    ds_read_b32 v9, v10 offset:24
    s_waitcnt lgkmcnt(0)
    v_readfirstlane_b32 s4, v9
    s_cmp_lt_u32 s4, 4
    s_cbranch_scc1 p2_Q_s1
    ds_read_b128 v[128:131], v5 offset:0
    ds_read_b128 v[132:135], v5 offset:1024
    ds_read_b128 v[136:139], v5 offset:2048
    ds_read_b128 v[140:143], v5 offset:3072
    ds_read_b128 v[144:147], v6 offset:16384
    ds_read_b128 v[148:151], v6 offset:17408
    ds_read_b128 v[152:155], v6 offset:18432
    ds_read_b128 v[156:159], v6 offset:19456
    ds_read_b128 v[160:163], v7 offset:0
    ds_read_b128 v[164:167], v7 offset:4096
    ds_read_b128 v[168:171], v13 offset:2048
    ds_read_b128 v[172:175], v13 offset:3072
    s_waitcnt lgkmcnt(0)
    v_add_f32 v128, v128, v144
    v_add_f32 v20, v20, v160
    v_add_f32 v129, v129, v145
    v_add_f32 v21, v21, v161
    v_add_f32 v130, v130, v146
    v_add_f32 v22, v22, v162
    v_add_f32 v131, v131, v147
    v_add_f32 v23, v23, v163
    v_add_f32 v20, v20, v128
    v_add_f32 v21, v21, v129
    v_add_f32 v22, v22, v130
    v_add_f32 v23, v23, v131
    v_add_f32 v132, v132, v148
    v_add_f32 v40, v40, v164
    v_add_f32 v133, v133, v149
    v_add_f32 v41, v41, v165
    v_add_f32 v134, v134, v150
    v_add_f32 v42, v42, v166
    v_add_f32 v135, v135, v151
    v_add_f32 v43, v43, v167
    v_add_f32 v40, v40, v132
    v_add_f32 v41, v41, v133
    v_add_f32 v42, v42, v134
    v_add_f32 v43, v43, v135
    v_add_f32 v136, v136, v152
    v_add_f32 v60, v60, v168
    v_add_f32 v137, v137, v153
    v_add_f32 v61, v61, v169
    v_add_f32 v138, v138, v154
    v_add_f32 v62, v62, v170
    v_add_f32 v139, v139, v155
    v_add_f32 v63, v63, v171
    v_add_f32 v60, v60, v136
    v_add_f32 v61, v61, v137
    v_add_f32 v62, v62, v138
    v_add_f32 v63, v63, v139
    v_add_f32 v140, v140, v156
    v_add_f32 v80, v80, v172
    v_add_f32 v141, v141, v157
    v_add_f32 v81, v81, v173
    v_add_f32 v142, v142, v158
    v_add_f32 v82, v82, v174
    v_add_f32 v143, v143, v159
    v_add_f32 v83, v83, v175
    v_add_f32 v80, v80, v140
    v_add_f32 v81, v81, v141
    v_add_f32 v82, v82, v142
    v_add_f32 v83, v83, v143
    s_waitcnt vmcnt(0)
p2_Q_c0:
    ds_read_b32 v9, v10 offset:48
    s_waitcnt lgkmcnt(0)
    v_readfirstlane_b32 s4, v9
    s_cmp_lt_u32 s4, 4
    s_cbranch_scc1 p2_Q_c0
    ds_read_b128 v[128:131], v1 offset:0
    ds_read_b128 v[132:135], v1 offset:4096
    ds_read_b128 v[136:139], v1 offset:8192
    ds_read_b128 v[140:143], v1 offset:12288
    s_waitcnt lgkmcnt(2)
    v_add_f32 v128, v128, v132
    v_add_f32 v129, v129, v133
    v_add_f32 v130, v130, v134
    v_add_f32 v131, v131, v135
    s_waitcnt lgkmcnt(0)
    v_add_f32 v136, v136, v140
    v_add_f32 v137, v137, v141
    v_add_f32 v138, v138, v142
    v_add_f32 v139, v139, v143
    v_add_f32 v128, v128, v136
    v_add_f32 v129, v129, v137
    v_add_f32 v130, v130, v138
    v_add_f32 v131, v131, v139
    v_cvt_pk_bf16_f32 v136, v128, v129
    v_lshlrev_b32 v128, 16, v136
    v_and_b32 v129, 0xffff0000, v136
    v_mul_f32 v137, s60, v128
    v_exp_f32 v137, v137
    v_mul_f32 v138, s60, v129
    v_exp_f32 v138, v138
    v_cvt_pk_bf16_f32 v136, v20, v21
    v_lshlrev_b32 v20, 16, v136
    v_and_b32 v21, 0xffff0000, v136
    v_add_f32 v137, 1.0, v137
    v_rcp_f32 v137, v137
    v_add_f32 v138, 1.0, v138
    v_rcp_f32 v138, v138
    s_nop 0
    v_mul_f32 v128, v128, v137
    v_mul_f32 v129, v129, v138
    v_cvt_pk_bf16_f32 v136, v128, v129
    v_lshlrev_b32 v128, 16, v136
    v_and_b32 v129, 0xffff0000, v136
    v_lshlrev_b32 v137, 16, v100
    v_and_b32 v138, 0xffff0000, v100
    v_mul_f32 v20, v20, v128
    v_mul_f32 v21, v21, v129
    v_cvt_pk_bf16_f32 v136, v20, v21
    v_lshlrev_b32 v20, 16, v136
    v_and_b32 v21, 0xffff0000, v136
    v_add_f32 v20, v20, v137
    v_add_f32 v21, v21, v138
    v_cvt_pk_bf16_f32 v132, v20, v21
    v_cvt_pk_bf16_f32 v136, v130, v131
    v_lshlrev_b32 v130, 16, v136
    v_and_b32 v131, 0xffff0000, v136
    v_mul_f32 v137, s60, v130
    v_exp_f32 v137, v137
    v_mul_f32 v138, s60, v131
    v_exp_f32 v138, v138
    v_cvt_pk_bf16_f32 v136, v22, v23
    v_lshlrev_b32 v22, 16, v136
    v_and_b32 v23, 0xffff0000, v136
    v_add_f32 v137, 1.0, v137
    v_rcp_f32 v137, v137
    v_add_f32 v138, 1.0, v138
    v_rcp_f32 v138, v138
    s_nop 0
    v_mul_f32 v130, v130, v137
    v_mul_f32 v131, v131, v138
    v_cvt_pk_bf16_f32 v136, v130, v131
    v_lshlrev_b32 v130, 16, v136
    v_and_b32 v131, 0xffff0000, v136
    v_lshlrev_b32 v137, 16, v101
    v_and_b32 v138, 0xffff0000, v101
    v_mul_f32 v22, v22, v130
    v_mul_f32 v23, v23, v131
    v_cvt_pk_bf16_f32 v136, v22, v23
    v_lshlrev_b32 v22, 16, v136
    v_and_b32 v23, 0xffff0000, v136
    v_add_f32 v22, v22, v137
    v_add_f32 v23, v23, v138
    v_cvt_pk_bf16_f32 v133, v22, v23
    buffer_store_dwordx2 v[132:133], v12, s[52:55], s56 offen
p2_Q_c1:
    ds_read_b32 v9, v10 offset:52
    s_waitcnt lgkmcnt(0)
    v_readfirstlane_b32 s4, v9
    s_cmp_lt_u32 s4, 4
    s_cbranch_scc1 p2_Q_c1
    ds_read_b128 v[144:147], v1 offset:16384
    ds_read_b128 v[148:151], v1 offset:20480
    ds_read_b128 v[152:155], v1 offset:24576
    ds_read_b128 v[156:159], v1 offset:28672
    s_waitcnt lgkmcnt(2)
    v_add_f32 v144, v144, v148
    v_add_f32 v145, v145, v149
    v_add_f32 v146, v146, v150
    v_add_f32 v147, v147, v151
    s_waitcnt lgkmcnt(0)
    v_add_f32 v152, v152, v156
    v_add_f32 v153, v153, v157
    v_add_f32 v154, v154, v158
    v_add_f32 v155, v155, v159
    v_add_f32 v144, v144, v152
    v_add_f32 v145, v145, v153
    v_add_f32 v146, v146, v154
    v_add_f32 v147, v147, v155
    v_cvt_pk_bf16_f32 v152, v144, v145
    v_lshlrev_b32 v144, 16, v152
    v_and_b32 v145, 0xffff0000, v152
    v_mul_f32 v153, s60, v144
    v_exp_f32 v153, v153
    v_mul_f32 v154, s60, v145
    v_exp_f32 v154, v154
    v_cvt_pk_bf16_f32 v152, v40, v41
    v_lshlrev_b32 v40, 16, v152
    v_and_b32 v41, 0xffff0000, v152
    v_add_f32 v153, 1.0, v153
    v_rcp_f32 v153, v153
    v_add_f32 v154, 1.0, v154
    v_rcp_f32 v154, v154
    s_nop 0
    v_mul_f32 v144, v144, v153
    v_mul_f32 v145, v145, v154
    v_cvt_pk_bf16_f32 v152, v144, v145
    v_lshlrev_b32 v144, 16, v152
    v_and_b32 v145, 0xffff0000, v152
    v_lshlrev_b32 v153, 16, v102
    v_and_b32 v154, 0xffff0000, v102
    v_mul_f32 v40, v40, v144
    v_mul_f32 v41, v41, v145
    v_cvt_pk_bf16_f32 v152, v40, v41
    v_lshlrev_b32 v40, 16, v152
    v_and_b32 v41, 0xffff0000, v152
    v_add_f32 v40, v40, v153
    v_add_f32 v41, v41, v154
    v_cvt_pk_bf16_f32 v148, v40, v41
    v_cvt_pk_bf16_f32 v152, v146, v147
    v_lshlrev_b32 v146, 16, v152
    v_and_b32 v147, 0xffff0000, v152
    v_mul_f32 v153, s60, v146
    v_exp_f32 v153, v153
    v_mul_f32 v154, s60, v147
    v_exp_f32 v154, v154
    v_cvt_pk_bf16_f32 v152, v42, v43
    v_lshlrev_b32 v42, 16, v152
    v_and_b32 v43, 0xffff0000, v152
    v_add_f32 v153, 1.0, v153
    v_rcp_f32 v153, v153
    v_add_f32 v154, 1.0, v154
    v_rcp_f32 v154, v154
    s_nop 0
    v_mul_f32 v146, v146, v153
    v_mul_f32 v147, v147, v154
    v_cvt_pk_bf16_f32 v152, v146, v147
    v_lshlrev_b32 v146, 16, v152
    v_and_b32 v147, 0xffff0000, v152
    v_lshlrev_b32 v153, 16, v103
    v_and_b32 v154, 0xffff0000, v103
    v_mul_f32 v42, v42, v146
    v_mul_f32 v43, v43, v147
    v_cvt_pk_bf16_f32 v152, v42, v43
    v_lshlrev_b32 v42, 16, v152
    v_and_b32 v43, 0xffff0000, v152
    v_add_f32 v42, v42, v153
    v_add_f32 v43, v43, v154
    v_cvt_pk_bf16_f32 v149, v42, v43
    buffer_store_dwordx2 v[148:149], v12, s[52:55], s57 offen
p2_Q_c2:
    ds_read_b32 v9, v10 offset:56
    s_waitcnt lgkmcnt(0)
    v_readfirstlane_b32 s4, v9
    s_cmp_lt_u32 s4, 4
    s_cbranch_scc1 p2_Q_c2
    ds_read_b128 v[160:163], v1 offset:32768
    ds_read_b128 v[164:167], v1 offset:36864
    ds_read_b128 v[168:171], v1 offset:40960
    ds_read_b128 v[172:175], v1 offset:45056
    s_waitcnt lgkmcnt(2)
    v_add_f32 v160, v160, v164
    v_add_f32 v161, v161, v165
    v_add_f32 v162, v162, v166
    v_add_f32 v163, v163, v167
    s_waitcnt lgkmcnt(0)
    v_add_f32 v168, v168, v172
    v_add_f32 v169, v169, v173
    v_add_f32 v170, v170, v174
    v_add_f32 v171, v171, v175
    v_add_f32 v160, v160, v168
    v_add_f32 v161, v161, v169
    v_add_f32 v162, v162, v170
    v_add_f32 v163, v163, v171
    v_cvt_pk_bf16_f32 v168, v160, v161
    v_lshlrev_b32 v160, 16, v168
    v_and_b32 v161, 0xffff0000, v168
    v_mul_f32 v169, s60, v160
    v_exp_f32 v169, v169
    v_mul_f32 v170, s60, v161
    v_exp_f32 v170, v170
    v_cvt_pk_bf16_f32 v168, v60, v61
    v_lshlrev_b32 v60, 16, v168
    v_and_b32 v61, 0xffff0000, v168
    v_add_f32 v169, 1.0, v169
    v_rcp_f32 v169, v169
    v_add_f32 v170, 1.0, v170
    v_rcp_f32 v170, v170
    s_nop 0
    v_mul_f32 v160, v160, v169
    v_mul_f32 v161, v161, v170
    v_cvt_pk_bf16_f32 v168, v160, v161
    v_lshlrev_b32 v160, 16, v168
    v_and_b32 v161, 0xffff0000, v168
    v_lshlrev_b32 v169, 16, v104
    v_and_b32 v170, 0xffff0000, v104
    v_mul_f32 v60, v60, v160
    v_mul_f32 v61, v61, v161
    v_cvt_pk_bf16_f32 v168, v60, v61
    v_lshlrev_b32 v60, 16, v168
    v_and_b32 v61, 0xffff0000, v168
    v_add_f32 v60, v60, v169
    v_add_f32 v61, v61, v170
    v_cvt_pk_bf16_f32 v164, v60, v61
    v_cvt_pk_bf16_f32 v168, v162, v163
    v_lshlrev_b32 v162, 16, v168
    v_and_b32 v163, 0xffff0000, v168
    v_mul_f32 v169, s60, v162
    v_exp_f32 v169, v169
    v_mul_f32 v170, s60, v163
    v_exp_f32 v170, v170
    v_cvt_pk_bf16_f32 v168, v62, v63
    v_lshlrev_b32 v62, 16, v168
    v_and_b32 v63, 0xffff0000, v168
    v_add_f32 v169, 1.0, v169
    v_rcp_f32 v169, v169
    v_add_f32 v170, 1.0, v170
    v_rcp_f32 v170, v170
    s_nop 0
    v_mul_f32 v162, v162, v169
    v_mul_f32 v163, v163, v170
    v_cvt_pk_bf16_f32 v168, v162, v163
    v_lshlrev_b32 v162, 16, v168
    v_and_b32 v163, 0xffff0000, v168
    v_lshlrev_b32 v169, 16, v105
    v_and_b32 v170, 0xffff0000, v105
    v_mul_f32 v62, v62, v162
    v_mul_f32 v63, v63, v163
    v_cvt_pk_bf16_f32 v168, v62, v63
    v_lshlrev_b32 v62, 16, v168
    v_and_b32 v63, 0xffff0000, v168
    v_add_f32 v62, v62, v169
    v_add_f32 v63, v63, v170
    v_cvt_pk_bf16_f32 v165, v62, v63
    buffer_store_dwordx2 v[164:165], v12, s[52:55], s58 offen
p2_Q_c3:
    ds_read_b32 v9, v10 offset:60
    s_waitcnt lgkmcnt(0)
    v_readfirstlane_b32 s4, v9
    s_cmp_lt_u32 s4, 4
    s_cbranch_scc1 p2_Q_c3
    ds_read_b128 v[176:179], v1 offset:49152
    ds_read_b128 v[180:183], v1 offset:53248
    ds_read_b128 v[184:187], v1 offset:57344
    ds_read_b128 v[188:191], v1 offset:61440
    s_waitcnt lgkmcnt(2)
    v_add_f32 v176, v176, v180
    v_add_f32 v177, v177, v181
    v_add_f32 v178, v178, v182
    v_add_f32 v179, v179, v183
    s_waitcnt lgkmcnt(0)
    v_add_f32 v184, v184, v188
    v_add_f32 v185, v185, v189
    v_add_f32 v186, v186, v190
    v_add_f32 v187, v187, v191
    v_add_f32 v176, v176, v184
    v_add_f32 v177, v177, v185
    v_add_f32 v178, v178, v186
    v_add_f32 v179, v179, v187
    v_cvt_pk_bf16_f32 v184, v176, v177
    v_lshlrev_b32 v176, 16, v184
    v_and_b32 v177, 0xffff0000, v184
    v_mul_f32 v185, s60, v176
    v_exp_f32 v185, v185
    v_mul_f32 v186, s60, v177
    v_exp_f32 v186, v186
    v_cvt_pk_bf16_f32 v184, v80, v81
    v_lshlrev_b32 v80, 16, v184
    v_and_b32 v81, 0xffff0000, v184
    v_add_f32 v185, 1.0, v185
    v_rcp_f32 v185, v185
    v_add_f32 v186, 1.0, v186
    v_rcp_f32 v186, v186
    s_nop 0
    v_mul_f32 v176, v176, v185
    v_mul_f32 v177, v177, v186
    v_cvt_pk_bf16_f32 v184, v176, v177
    v_lshlrev_b32 v176, 16, v184
    v_and_b32 v177, 0xffff0000, v184
    v_lshlrev_b32 v185, 16, v106
    v_and_b32 v186, 0xffff0000, v106
    v_mul_f32 v80, v80, v176
    v_mul_f32 v81, v81, v177
    v_cvt_pk_bf16_f32 v184, v80, v81
    v_lshlrev_b32 v80, 16, v184
    v_and_b32 v81, 0xffff0000, v184
    v_add_f32 v80, v80, v185
    v_add_f32 v81, v81, v186
    v_cvt_pk_bf16_f32 v180, v80, v81
    v_cvt_pk_bf16_f32 v184, v178, v179
    v_lshlrev_b32 v178, 16, v184
    v_and_b32 v179, 0xffff0000, v184
    v_mul_f32 v185, s60, v178
    v_exp_f32 v185, v185
    v_mul_f32 v186, s60, v179
    v_exp_f32 v186, v186
    v_cvt_pk_bf16_f32 v184, v82, v83
    v_lshlrev_b32 v82, 16, v184
    v_and_b32 v83, 0xffff0000, v184
    v_add_f32 v185, 1.0, v185
    v_rcp_f32 v185, v185
    v_add_f32 v186, 1.0, v186
    v_rcp_f32 v186, v186
    s_nop 0
    v_mul_f32 v178, v178, v185
    v_mul_f32 v179, v179, v186
    v_cvt_pk_bf16_f32 v184, v178, v179
    v_lshlrev_b32 v178, 16, v184
    v_and_b32 v179, 0xffff0000, v184
    v_lshlrev_b32 v185, 16, v107
    v_and_b32 v186, 0xffff0000, v107
    v_mul_f32 v82, v82, v178
    v_mul_f32 v83, v83, v179
    v_cvt_pk_bf16_f32 v184, v82, v83
    v_lshlrev_b32 v82, 16, v184
    v_and_b32 v83, 0xffff0000, v184
    v_add_f32 v82, v82, v185
    v_add_f32 v83, v83, v186
    v_cvt_pk_bf16_f32 v181, v82, v83
    buffer_store_dwordx2 v[180:181], v12, s[52:55], s59 offen
    s_branch p2_end
p2_Q_abort:
    v_mov_b32 v11, 0x101
    ds_write_b32 v10, v11 offset:24
    s_waitcnt vmcnt(0)
p2_end:
    s_setprio 0
    v_mov_b32 v10, 61312
    s_cmp_lg_u32 s88, 0
    s_cbranch_scc1 p2_sweep
    s_cmp_ge_u32 s8, 4
    s_cbranch_scc1 p2_e1
    s_waitcnt vmcnt(0)
    v_readfirstlane_b32 s4, v15
    s_cmp_lg_u32 s4, 255
    s_cbranch_scc1 p2_e1
    v_lshrrev_b32 v2, 2, v0
    s_mov_b64 exec, 0xff
    buffer_load_dword v1, v2, s[80:83], 0 offen offset:160 sc1
    v_mov_b32 v3, 1
    ds_write_b32 v10, v3 offset:28
    s_waitcnt vmcnt(0)
    ds_write_b32 v2, v1 offset:61376
    s_mov_b64 exec, -1
    s_waitcnt lgkmcnt(0)
p2_e1:
    s_barrier
    ds_read_b32 v1, v10 offset:28
    s_waitcnt lgkmcnt(0)
    v_readfirstlane_b32 s88, v1
    s_cmp_eq_u32 s88, 0
    s_cbranch_scc1 g1_exit
p2_sweep:
    s_add_u32 s88, s88, 1
    s_cmp_gt_u32 s88, 300
    s_cbranch_scc1 g1_exit
    s_waitcnt vmcnt(0) lgkmcnt(0)
    s_barrier
    v_lshrrev_b32 v2, 2, v0
    v_and_b32 v2, 28, v2
    ds_read_b32 v1, v2 offset:61376
    s_waitcnt lgkmcnt(0)
    v_cmp_ne_u32 vcc, -1, v1
    s_barrier
    s_ff1_i32_b32 s4, vcc_lo
    s_cmp_lt_i32 s4, 0
    s_cbranch_scc1 g1_exit
    s_mov_b32 m0, s4
    s_nop 0
    v_readlane_b32 s5, v1, m0
    s_ff0_i32_b32 s3, s5
    s_bitset1_b32 s5, s3
    s_lshl_b32 s4, s4, 2
    v_mov_b32 v1, s5
    v_mov_b32 v2, s4
    ds_write_b32 v2, v1 offset:61376
    s_lshl_b32 s4, s4, 3
    s_add_u32 s3, s3, s4
    s_branch p2_entry
g1_exit:
    s_endpgm
code_end:
    .section .rodata,"a"
.p2align 6
.amdhsa_kernel g1_kernel
  .amdhsa_next_free_vgpr 256
  .amdhsa_next_free_sgpr 102
  .amdhsa_accum_offset 256
  .amdhsa_group_segment_fixed_size 0
  .amdhsa_kernarg_size 80
  .amdhsa_user_sgpr_count 2
  .amdhsa_user_sgpr_kernarg_segment_ptr 1
  .amdhsa_system_sgpr_workgroup_id_x 1
.end_amdhsa_kernel
```
